```python
import torch

def _softmax(x, axis=-1):
    return torch.softmax(x, dim=axis)
def _gelu(x):
    return torch.nn.functional.gelu(x, approximate="tanh")
def _silu(x):
    return torch.nn.functional.silu(x)
def _sigmoid(x):
    return torch.sigmoid(x)
def _layernorm(x, axis=-1, eps=1e-5):
    m = x.mean(dim=axis, keepdim=True)
    v = x.var(dim=axis, keepdim=True, unbiased=False)
    return (x - m) / torch.sqrt(v + eps)
def _scatter_add(tgt, idx, src, axis=0):
    return tgt.clone().index_add_(axis, idx, src)
def _segment_sum(src, seg, n):
    out = torch.zeros((n,) + src.shape[1:], dtype=src.dtype)
    return out.index_add_(0, seg, src)
def _pad(x, pw):
    flat = tuple(v for pair in reversed(pw) for v in pair)
    return torch.nn.functional.pad(x, flat)

kernel_name = 'concat_heads__mha_block__grouped_kv_mqa__prompt'

def setup_inputs():

    _w = (lambda a: (lambda t: t.to(torch.bfloat16) if t.is_floating_point() else t)(torch.as_tensor(a)))
    def _A_setup():
        B, S, D, H = 1, 2048, 640, 32
        return {
            "x": _w((lambda *s: torch.randn(*s, dtype=torch.bfloat16) * 0.2)(B, S, D)),
            "wqkv": _w((lambda *s: torch.randn(*s, dtype=torch.bfloat16) * 0.2)(D, 3 * D)),
            "wo": _w((lambda *s: torch.randn(*s, dtype=torch.bfloat16) * 0.05)(D, D)),
        }
    _A_in = _A_setup()

    def _B_setup():
        B, S, D, H = 1, 2048, 640, 32
        Dh = D // H
        return {
            "x": _w((lambda *s: torch.randn(*s, dtype=torch.bfloat16) * 0.05)(B, S, D)),
            "wq": _w((lambda *s: torch.randn(*s, dtype=torch.bfloat16) * 0.8)(D, H * Dh)),
            "wk": _w((lambda *s: torch.randn(*s, dtype=torch.bfloat16) * 0.8)(D, Dh)),
            "wv": _w((lambda *s: torch.randn(*s, dtype=torch.bfloat16) * 0.1)(D, Dh)),
            "wo": _w((lambda *s: torch.randn(*s, dtype=torch.bfloat16) * 0.1)(H * Dh, D)),
        }
    _B_in = _B_setup()

    return {
        "A_x": _A_in["x"],
        "A_wqkv": _A_in["wqkv"],
        "A_wo": _A_in["wo"],
        "B_x": _B_in["x"],
        "B_wq": _B_in["wq"],
        "B_wk": _B_in["wk"],
        "B_wv": _B_in["wv"],
        "B_wo": _B_in["wo"],
    }

def reference(A_x, A_wqkv, A_wo, B_x, B_wq, B_wk, B_wv, B_wo):
    def _A_ref(x, wqkv, wo):
        B, S, D = x.shape
        H = 32
        Dh = D // H
        qkv = (lambda x, *d: x.permute(*d))((x @ wqkv).reshape(B, S, 3, H, Dh), 2, 0, 3, 1, 4)
        q, k, v = qkv[0], qkv[1], qkv[2]
        scores = torch.einsum("bhqd,bhkd->bhqk", q, k) * (Dh ** -0.5)
        p = _softmax(scores, axis=-1)
        o = torch.einsum("bhqk,bhkd->bhqd", p, v)
        return (lambda x, *d: x.permute(*d))(o, 0, 2, 1, 3).reshape(B, S, D) @ wo

    def _B_ref(x, wq, wk, wv, wo):
        B, S, D = x.shape
        H = 32
        Dh = D // H
        q = (lambda x, *d: x.permute(*d))((x @ wq).reshape(B, S, H, Dh), 0, 2, 1, 3)
        k = x @ wk
        v = x @ wv
        scores = torch.einsum("bhqd,bkd->bhqk", q, k) * (Dh ** -0.5)
        p = _softmax(scores, axis=-1)
        o = torch.einsum("bhqk,bkd->bhqd", p, v)
        return (lambda x, *d: x.permute(*d))(o, 0, 2, 1, 3).reshape(B, S, H * Dh) @ wo

    a = _A_ref(A_x, A_wqkv, A_wo)
    b = _B_ref(B_x, B_wq, B_wk, B_wv, B_wo)
    return torch.concatenate([a, b], axis=-1)
```

```asm
; @launch grid=(256,1,1) block=(512,1,1) lds=163840
.amdgcn_target "amdgcn-amd-amdhsa--gfx950"
.text
.globl concat_heads__mha_block__grouped_kv_mqa__prompt_kernel
.p2align 8
.type concat_heads__mha_block__grouped_kv_mqa__prompt_kernel,@function
concat_heads__mha_block__grouped_kv_mqa__prompt_kernel:
s_cmp_ge_u32 s2, 256
s_cbranch_scc1 concat_heads__mha_block__grouped_kv_mqa__prompt_kernel_end
s_load_dwordx16 s[16:31], s[0:1], 0
s_load_dwordx2 s[4:5], s[0:1], 80
v_lshrrev_b32 v4, 6, v0
s_and_b32 s6, s2, 7
v_readfirstlane_b32 s11, v4
s_lshr_b32 s7, s2, 3
s_getpc_b64 s[70:71]
concat_heads__mha_block__grouped_kv_mqa__prompt_kernel_pc0:
s_and_b32 s8, s7, 7
s_cmp_lg_u32 s8, s11
s_cbranch_scc1 concat_heads__mha_block__grouped_kv_mqa__prompt_kernel_nw0
v_lshlrev_b32 v2, 7, v0
v_min_u32 v2, attn_last-concat_heads__mha_block__grouped_kv_mqa__prompt_kernel_pc0, v2
global_load_dword v247, v2, s[70:71]
concat_heads__mha_block__grouped_kv_mqa__prompt_kernel_nw0:
s_andn2_b32 s8, 1, s6
s_lshr_b32 s9, s6, 2
s_lshl1_add_u32 s8, s8, s9
s_bfe_u32 s9, s6, 0x10001
s_lshl_b32 s9, s9, 3
s_lshr_b32 s10, s7, 2
s_add_u32 s9, s9, s10
s_and_b32 s10, s7, 3
v_and_b32 v1, 63, v0
s_cmp_lt_u32 s11, 4
s_cbranch_scc1 concat_heads__mha_block__grouped_kv_mqa__prompt_kernel_compute
s_sub_u32 s11, s11, 4
v_and_b32 v0, 255, v0
v_lshrrev_b32 v2, 3, v1
s_cmp_eq_u32 s8, 2
s_cselect_b32 s52, 4, 0
v_and_b32 v3, s52, v2
v_add_u32 v2, v2, v3
v_mul_u32_u24 v2, 1280, v2
v_lshrrev_b32 v3, 4, v1
v_xor_b32 v3, v3, v1
v_and_b32 v3, 7, v3
v_lshl_add_u32 v5, v3, 4, v2
s_lshl_b32 s56, s9, 2
s_add_u32 s56, s56, s11
s_mul_i32 s56, s56, 40960
s_lshl_b32 s61, s11, 12
s_lshl_b32 s64, s10, 2
s_lshr_b32 s64, 34096, s64
s_and_b32 s64, s64, 15
s_lshr_b32 s65, s7, 2
s_add_u32 s64, s64, s65
s_lshr_b32 s65, s7, 4
s_add_u32 s64, s64, s65
s_sub_u32 s65, s64, 10
s_cmp_ge_u32 s64, 10
s_cselect_b32 s64, s65, s64
s_mov_b32 s65, s64
s_mov_b32 s35, 0x00020000
s_mov_b32 s34, 2621440
s_cmp_eq_u32 s8, 2
s_movk_i32 s52, 10240
s_cmovk_i32 s52, 20480
s_movk_i32 s53, 20480
s_cmovk_i32 s53, 5120
v_xor_b32 v6, 64, v5
v_add_u32 v6, s52, v6
v_add_u32 v7, s53, v5
v_add_u32 v8, s53, v6
s_cmp_eq_u32 s8, 3
s_cselect_b32 s58, 1, 3
s_mul_i32 s58, s58, 1280
s_cselect_b32 s59, 0, s8
s_cselect_b32 s42, 25600, 0
s_waitcnt lgkmcnt(0)
s_cselect_b32 s32, s22, s16
s_cselect_b32 s33, s23, s17
s_cselect_b32 s36, s24, s18
s_cselect_b32 s37, s25, s19
s_and_b32 s33, s33, 0xffff
s_lshl_b32 s57, s64, 7
s_add_u32 s57, s57, s56
s_add_u32 m0, s61, 0
s_nop 0
buffer_load_dwordx4 v5, s[32:35], s57 offen lds
s_add_u32 m0, s61, 1024
s_nop 0
buffer_load_dwordx4 v6, s[32:35], s57 offen lds
s_add_u32 m0, s61, 2048
s_nop 0
buffer_load_dwordx4 v7, s[32:35], s57 offen lds
s_add_u32 m0, s61, 3072
s_nop 0
buffer_load_dwordx4 v8, s[32:35], s57 offen lds
s_and_b32 s37, s37, 0xffff
s_mul_i32 s38, s58, 640
s_mov_b32 s39, 0x00020000
s_mov_b32 s43, 0x00020000
s_mul_i32 s59, s59, 1280
s_mul_i32 s60, s10, 320
s_add_u32 s59, s59, s60
s_lshl_b32 s60, s58, 6
s_lshl_b32 s62, s11, 10
s_bitcmp1_b32 s10, 0
s_cselect_b32 s40, s28, s26
s_cselect_b32 s41, s29, s27
s_and_b32 s41, s41, 0xffff
v_lshlrev_b32 v14, 4, v0
v_cmp_gt_u32 vcc, 160, v0
v_mov_b32 v17, 0x7fff0000
s_nop 0
v_cndmask_b32 v14, v17, v14, vcc
s_mul_i32 s55, s65, s60
s_add_u32 s55, s55, s59
v_mul_u32_u24 v17, 52429, v0
v_lshrrev_b32 v17, 19, v17
v_mul_u32_u24 v19, 10, v17
v_sub_u32 v19, v0, v19
v_lshrrev_b32 v18, 1, v17
v_xor_b32 v18, v18, v17
v_bfe_u32 v18, v18, 2, 1
v_mul_u32_u24 v18, 12, v18
v_xor_b32 v18, v18, v17
v_and_b32 v18, 63, v18
v_mul_u32_u24 v18, s58, v18
v_lshrrev_b32 v17, 6, v17
v_mul_u32_u24 v17, 160, v17
v_lshl_add_u32 v18, v19, 4, v18
v_add_u32 v9, v17, v18
s_add_u32 m0, s62, 16384
s_nop 0
buffer_load_dwordx4 v9, s[36:39], s55 offen lds
v_add_u32 v20, 256, v0
v_mul_u32_u24 v17, 52429, v20
v_lshrrev_b32 v17, 19, v17
v_mul_u32_u24 v19, 10, v17
v_sub_u32 v19, v20, v19
v_lshrrev_b32 v18, 1, v17
v_xor_b32 v18, v18, v17
v_bfe_u32 v18, v18, 2, 1
v_mul_u32_u24 v18, 12, v18
v_xor_b32 v18, v18, v17
v_and_b32 v18, 63, v18
v_mul_u32_u24 v18, s58, v18
v_lshrrev_b32 v17, 6, v17
v_mul_u32_u24 v17, 160, v17
v_lshl_add_u32 v18, v19, 4, v18
v_add_u32 v10, v17, v18
s_add_u32 m0, s62, 20480
s_nop 0
buffer_load_dwordx4 v10, s[36:39], s55 offen lds
v_add_u32 v20, 512, v0
v_mul_u32_u24 v17, 52429, v20
v_lshrrev_b32 v17, 19, v17
v_mul_u32_u24 v19, 10, v17
v_sub_u32 v19, v20, v19
v_lshrrev_b32 v18, 1, v17
v_xor_b32 v18, v18, v17
v_bfe_u32 v18, v18, 2, 1
v_mul_u32_u24 v18, 12, v18
v_xor_b32 v18, v18, v17
v_and_b32 v18, 63, v18
v_mul_u32_u24 v18, s58, v18
v_lshrrev_b32 v17, 6, v17
v_mul_u32_u24 v17, 160, v17
v_lshl_add_u32 v18, v19, 4, v18
v_add_u32 v11, v17, v18
s_add_u32 m0, s62, 24576
s_nop 0
buffer_load_dwordx4 v11, s[36:39], s55 offen lds
v_add_u32 v20, 768, v0
v_mul_u32_u24 v17, 52429, v20
v_lshrrev_b32 v17, 19, v17
v_mul_u32_u24 v19, 10, v17
v_sub_u32 v19, v20, v19
v_lshrrev_b32 v18, 1, v17
v_xor_b32 v18, v18, v17
v_bfe_u32 v18, v18, 2, 1
v_mul_u32_u24 v18, 12, v18
v_xor_b32 v18, v18, v17
v_and_b32 v18, 63, v18
v_mul_u32_u24 v18, s58, v18
v_lshrrev_b32 v17, 6, v17
v_mul_u32_u24 v17, 160, v17
v_lshl_add_u32 v18, v19, 4, v18
v_add_u32 v12, v17, v18
s_add_u32 m0, s62, 28672
s_nop 0
buffer_load_dwordx4 v12, s[36:39], s55 offen lds
v_add_u32 v20, 1024, v0
v_mul_u32_u24 v17, 52429, v20
v_lshrrev_b32 v17, 19, v17
v_mul_u32_u24 v19, 10, v17
v_sub_u32 v19, v20, v19
v_lshrrev_b32 v18, 1, v17
v_xor_b32 v18, v18, v17
v_bfe_u32 v18, v18, 2, 1
v_mul_u32_u24 v18, 12, v18
v_xor_b32 v18, v18, v17
v_and_b32 v18, 63, v18
v_mul_u32_u24 v18, s58, v18
v_lshrrev_b32 v17, 6, v17
v_mul_u32_u24 v17, 160, v17
v_lshl_add_u32 v18, v19, 4, v18
v_add_u32 v13, v17, v18
s_add_u32 m0, s62, 32768
s_nop 0
buffer_load_dwordx4 v13, s[36:39], s55 offen lds
s_add_u32 m0, s62, 36864
s_mul_i32 s63, s65, 2560
buffer_load_dwordx4 v14, s[40:43], s63 offen lds
s_cmp_eq_u32 s8, 3
s_cbranch_scc1 concat_heads__mha_block__grouped_kv_mqa__prompt_kernel_ldB
s_add_u32 s64, s64, 1
s_cmp_eq_u32 s64, 10
s_cselect_b32 s64, 0, s64
s_lshl_b32 s57, s64, 7
s_add_u32 s57, s57, s56
s_add_u32 m0, s61, 40960
s_nop 0
buffer_load_dwordx4 v5, s[32:35], s57 offen lds
s_add_u32 m0, s61, 41984
s_nop 0
buffer_load_dwordx4 v6, s[32:35], s57 offen lds
s_add_u32 m0, s61, 43008
s_nop 0
buffer_load_dwordx4 v7, s[32:35], s57 offen lds
s_add_u32 m0, s61, 44032
s_nop 0
buffer_load_dwordx4 v8, s[32:35], s57 offen lds
s_waitcnt vmcnt(4)
s_barrier
s_add_u32 s65, s65, 1
s_cmp_eq_u32 s65, 10
s_cselect_b32 s65, 0, s65
s_mul_i32 s55, s65, s60
s_add_u32 s55, s55, s59
s_add_u32 m0, s62, 57344
s_nop 0
buffer_load_dwordx4 v9, s[36:39], s55 offen lds
s_add_u32 m0, s62, 61440
s_nop 0
buffer_load_dwordx4 v10, s[36:39], s55 offen lds
s_add_u32 m0, s62, 65536
s_nop 0
buffer_load_dwordx4 v11, s[36:39], s55 offen lds
s_add_u32 m0, s62, 69632
s_nop 0
buffer_load_dwordx4 v12, s[36:39], s55 offen lds
s_add_u32 m0, s62, 73728
s_nop 0
buffer_load_dwordx4 v13, s[36:39], s55 offen lds
s_add_u32 s64, s64, 1
s_cmp_eq_u32 s64, 10
s_cselect_b32 s64, 0, s64
s_lshl_b32 s57, s64, 7
s_add_u32 s57, s57, s56
s_add_u32 m0, s61, 81920
s_nop 0
buffer_load_dwordx4 v5, s[32:35], s57 offen lds
s_add_u32 m0, s61, 82944
s_nop 0
buffer_load_dwordx4 v6, s[32:35], s57 offen lds
s_add_u32 m0, s61, 83968
s_nop 0
buffer_load_dwordx4 v7, s[32:35], s57 offen lds
s_add_u32 m0, s61, 84992
s_nop 0
buffer_load_dwordx4 v8, s[32:35], s57 offen lds
s_waitcnt vmcnt(4)
s_barrier
s_add_u32 s65, s65, 1
s_cmp_eq_u32 s65, 10
s_cselect_b32 s65, 0, s65
s_mul_i32 s55, s65, s60
s_add_u32 s55, s55, s59
s_add_u32 m0, s62, 98304
s_nop 0
buffer_load_dwordx4 v9, s[36:39], s55 offen lds
s_add_u32 m0, s62, 102400
s_nop 0
buffer_load_dwordx4 v10, s[36:39], s55 offen lds
s_add_u32 m0, s62, 106496
s_nop 0
buffer_load_dwordx4 v11, s[36:39], s55 offen lds
s_add_u32 m0, s62, 110592
s_nop 0
buffer_load_dwordx4 v12, s[36:39], s55 offen lds
s_add_u32 m0, s62, 114688
s_nop 0
buffer_load_dwordx4 v13, s[36:39], s55 offen lds
s_add_u32 s64, s64, 1
s_cmp_eq_u32 s64, 10
s_cselect_b32 s64, 0, s64
s_lshl_b32 s57, s64, 7
s_add_u32 s57, s57, s56
s_add_u32 m0, s61, 122880
s_nop 0
buffer_load_dwordx4 v5, s[32:35], s57 offen lds
s_add_u32 m0, s61, 123904
s_nop 0
buffer_load_dwordx4 v6, s[32:35], s57 offen lds
s_add_u32 m0, s61, 124928
s_nop 0
buffer_load_dwordx4 v7, s[32:35], s57 offen lds
s_add_u32 m0, s61, 125952
s_nop 0
buffer_load_dwordx4 v8, s[32:35], s57 offen lds
s_waitcnt vmcnt(4)
s_barrier
s_add_u32 s65, s65, 1
s_cmp_eq_u32 s65, 10
s_cselect_b32 s65, 0, s65
s_mul_i32 s55, s65, s60
s_add_u32 s55, s55, s59
s_add_u32 m0, s62, 139264
s_nop 0
buffer_load_dwordx4 v9, s[36:39], s55 offen lds
s_add_u32 m0, s62, 143360
s_nop 0
buffer_load_dwordx4 v10, s[36:39], s55 offen lds
s_add_u32 m0, s62, 147456
s_nop 0
buffer_load_dwordx4 v11, s[36:39], s55 offen lds
s_add_u32 m0, s62, 151552
s_nop 0
buffer_load_dwordx4 v12, s[36:39], s55 offen lds
s_add_u32 m0, s62, 155648
s_nop 0
buffer_load_dwordx4 v13, s[36:39], s55 offen lds
s_add_u32 s64, s64, 1
s_cmp_eq_u32 s64, 10
s_cselect_b32 s64, 0, s64
s_lshl_b32 s57, s64, 7
s_add_u32 s57, s57, s56
s_add_u32 m0, s61, 0
s_nop 0
buffer_load_dwordx4 v5, s[32:35], s57 offen lds
s_add_u32 m0, s61, 1024
s_nop 0
buffer_load_dwordx4 v6, s[32:35], s57 offen lds
s_add_u32 m0, s61, 2048
s_nop 0
buffer_load_dwordx4 v7, s[32:35], s57 offen lds
s_add_u32 m0, s61, 3072
s_nop 0
buffer_load_dwordx4 v8, s[32:35], s57 offen lds
s_add_u32 s65, s65, 1
s_cmp_eq_u32 s65, 10
s_cselect_b32 s65, 0, s65
s_mul_i32 s55, s65, s60
s_add_u32 s55, s55, s59
s_add_u32 m0, s62, 16384
s_nop 0
buffer_load_dwordx4 v9, s[36:39], s55 offen lds
s_add_u32 m0, s62, 20480
s_nop 0
buffer_load_dwordx4 v10, s[36:39], s55 offen lds
s_add_u32 m0, s62, 24576
s_nop 0
buffer_load_dwordx4 v11, s[36:39], s55 offen lds
s_add_u32 m0, s62, 28672
s_nop 0
buffer_load_dwordx4 v12, s[36:39], s55 offen lds
s_add_u32 m0, s62, 32768
s_nop 0
buffer_load_dwordx4 v13, s[36:39], s55 offen lds
s_waitcnt vmcnt(9)
s_barrier
s_add_u32 s64, s64, 1
s_cmp_eq_u32 s64, 10
s_cselect_b32 s64, 0, s64
s_lshl_b32 s57, s64, 7
s_add_u32 s57, s57, s56
s_add_u32 m0, s61, 40960
s_nop 0
buffer_load_dwordx4 v5, s[32:35], s57 offen lds
s_add_u32 m0, s61, 41984
s_nop 0
buffer_load_dwordx4 v6, s[32:35], s57 offen lds
s_add_u32 m0, s61, 43008
s_nop 0
buffer_load_dwordx4 v7, s[32:35], s57 offen lds
s_add_u32 m0, s61, 44032
s_nop 0
buffer_load_dwordx4 v8, s[32:35], s57 offen lds
s_add_u32 s65, s65, 1
s_cmp_eq_u32 s65, 10
s_cselect_b32 s65, 0, s65
s_mul_i32 s55, s65, s60
s_add_u32 s55, s55, s59
s_add_u32 m0, s62, 57344
s_nop 0
buffer_load_dwordx4 v9, s[36:39], s55 offen lds
s_add_u32 m0, s62, 61440
s_nop 0
buffer_load_dwordx4 v10, s[36:39], s55 offen lds
s_add_u32 m0, s62, 65536
s_nop 0
buffer_load_dwordx4 v11, s[36:39], s55 offen lds
s_add_u32 m0, s62, 69632
s_nop 0
buffer_load_dwordx4 v12, s[36:39], s55 offen lds
s_add_u32 m0, s62, 73728
s_nop 0
buffer_load_dwordx4 v13, s[36:39], s55 offen lds
s_waitcnt vmcnt(9)
s_barrier
s_add_u32 s64, s64, 1
s_cmp_eq_u32 s64, 10
s_cselect_b32 s64, 0, s64
s_lshl_b32 s57, s64, 7
s_add_u32 s57, s57, s56
s_add_u32 m0, s61, 81920
s_nop 0
buffer_load_dwordx4 v5, s[32:35], s57 offen lds
s_add_u32 m0, s61, 82944
s_nop 0
buffer_load_dwordx4 v6, s[32:35], s57 offen lds
s_add_u32 m0, s61, 83968
s_nop 0
buffer_load_dwordx4 v7, s[32:35], s57 offen lds
s_add_u32 m0, s61, 84992
s_nop 0
buffer_load_dwordx4 v8, s[32:35], s57 offen lds
s_add_u32 s65, s65, 1
s_cmp_eq_u32 s65, 10
s_cselect_b32 s65, 0, s65
s_mul_i32 s55, s65, s60
s_add_u32 s55, s55, s59
s_add_u32 m0, s62, 98304
s_nop 0
buffer_load_dwordx4 v9, s[36:39], s55 offen lds
s_add_u32 m0, s62, 102400
s_nop 0
buffer_load_dwordx4 v10, s[36:39], s55 offen lds
s_add_u32 m0, s62, 106496
s_nop 0
buffer_load_dwordx4 v11, s[36:39], s55 offen lds
s_add_u32 m0, s62, 110592
s_nop 0
buffer_load_dwordx4 v12, s[36:39], s55 offen lds
s_add_u32 m0, s62, 114688
s_nop 0
buffer_load_dwordx4 v13, s[36:39], s55 offen lds
s_waitcnt vmcnt(9)
s_barrier
s_add_u32 s64, s64, 1
s_cmp_eq_u32 s64, 10
s_cselect_b32 s64, 0, s64
s_lshl_b32 s57, s64, 7
s_add_u32 s57, s57, s56
s_add_u32 m0, s61, 122880
s_nop 0
buffer_load_dwordx4 v5, s[32:35], s57 offen lds
s_add_u32 m0, s61, 123904
s_nop 0
buffer_load_dwordx4 v6, s[32:35], s57 offen lds
s_add_u32 m0, s61, 124928
s_nop 0
buffer_load_dwordx4 v7, s[32:35], s57 offen lds
s_add_u32 m0, s61, 125952
s_nop 0
buffer_load_dwordx4 v8, s[32:35], s57 offen lds
s_add_u32 s65, s65, 1
s_cmp_eq_u32 s65, 10
s_cselect_b32 s65, 0, s65
s_mul_i32 s55, s65, s60
s_add_u32 s55, s55, s59
s_add_u32 m0, s62, 139264
s_nop 0
buffer_load_dwordx4 v9, s[36:39], s55 offen lds
s_add_u32 m0, s62, 143360
s_nop 0
buffer_load_dwordx4 v10, s[36:39], s55 offen lds
s_add_u32 m0, s62, 147456
s_nop 0
buffer_load_dwordx4 v11, s[36:39], s55 offen lds
s_add_u32 m0, s62, 151552
s_nop 0
buffer_load_dwordx4 v12, s[36:39], s55 offen lds
s_add_u32 m0, s62, 155648
s_nop 0
buffer_load_dwordx4 v13, s[36:39], s55 offen lds
s_waitcnt vmcnt(9)
s_barrier
s_add_u32 s64, s64, 1
s_cmp_eq_u32 s64, 10
s_cselect_b32 s64, 0, s64
s_lshl_b32 s57, s64, 7
s_add_u32 s57, s57, s56
s_add_u32 m0, s61, 0
s_nop 0
buffer_load_dwordx4 v5, s[32:35], s57 offen lds
s_add_u32 m0, s61, 1024
s_nop 0
buffer_load_dwordx4 v6, s[32:35], s57 offen lds
s_add_u32 m0, s61, 2048
s_nop 0
buffer_load_dwordx4 v7, s[32:35], s57 offen lds
s_add_u32 m0, s61, 3072
s_nop 0
buffer_load_dwordx4 v8, s[32:35], s57 offen lds
s_add_u32 s65, s65, 1
s_cmp_eq_u32 s65, 10
s_cselect_b32 s65, 0, s65
s_mul_i32 s55, s65, s60
s_add_u32 s55, s55, s59
s_add_u32 m0, s62, 16384
s_nop 0
buffer_load_dwordx4 v9, s[36:39], s55 offen lds
s_add_u32 m0, s62, 20480
s_nop 0
buffer_load_dwordx4 v10, s[36:39], s55 offen lds
s_add_u32 m0, s62, 24576
s_nop 0
buffer_load_dwordx4 v11, s[36:39], s55 offen lds
s_add_u32 m0, s62, 28672
s_nop 0
buffer_load_dwordx4 v12, s[36:39], s55 offen lds
s_add_u32 m0, s62, 32768
s_nop 0
buffer_load_dwordx4 v13, s[36:39], s55 offen lds
s_waitcnt vmcnt(9)
s_barrier
s_add_u32 s64, s64, 1
s_cmp_eq_u32 s64, 10
s_cselect_b32 s64, 0, s64
s_lshl_b32 s57, s64, 7
s_add_u32 s57, s57, s56
s_add_u32 m0, s61, 40960
s_nop 0
buffer_load_dwordx4 v5, s[32:35], s57 offen lds
s_add_u32 m0, s61, 41984
s_nop 0
buffer_load_dwordx4 v6, s[32:35], s57 offen lds
s_add_u32 m0, s61, 43008
s_nop 0
buffer_load_dwordx4 v7, s[32:35], s57 offen lds
s_add_u32 m0, s61, 44032
s_nop 0
buffer_load_dwordx4 v8, s[32:35], s57 offen lds
s_add_u32 s65, s65, 1
s_cmp_eq_u32 s65, 10
s_cselect_b32 s65, 0, s65
s_mul_i32 s55, s65, s60
s_add_u32 s55, s55, s59
s_add_u32 m0, s62, 57344
s_nop 0
buffer_load_dwordx4 v9, s[36:39], s55 offen lds
s_add_u32 m0, s62, 61440
s_nop 0
buffer_load_dwordx4 v10, s[36:39], s55 offen lds
s_add_u32 m0, s62, 65536
s_nop 0
buffer_load_dwordx4 v11, s[36:39], s55 offen lds
s_add_u32 m0, s62, 69632
s_nop 0
buffer_load_dwordx4 v12, s[36:39], s55 offen lds
s_add_u32 m0, s62, 73728
s_nop 0
buffer_load_dwordx4 v13, s[36:39], s55 offen lds
s_waitcnt vmcnt(9)
s_barrier
s_waitcnt vmcnt(0)
s_barrier
s_branch concat_heads__mha_block__grouped_kv_mqa__prompt_kernel_ldE
concat_heads__mha_block__grouped_kv_mqa__prompt_kernel_ldB:
s_add_u32 s64, s64, 1
s_cmp_eq_u32 s64, 10
s_cselect_b32 s64, 0, s64
s_lshl_b32 s57, s64, 7
s_add_u32 s57, s57, s56
s_add_u32 m0, s61, 40960
s_nop 0
buffer_load_dwordx4 v5, s[32:35], s57 offen lds
s_add_u32 m0, s61, 41984
s_nop 0
buffer_load_dwordx4 v6, s[32:35], s57 offen lds
s_add_u32 m0, s61, 43008
s_nop 0
buffer_load_dwordx4 v7, s[32:35], s57 offen lds
s_add_u32 m0, s61, 44032
s_nop 0
buffer_load_dwordx4 v8, s[32:35], s57 offen lds
s_waitcnt vmcnt(4)
s_barrier
s_add_u32 s65, s65, 1
s_cmp_eq_u32 s65, 10
s_cselect_b32 s65, 0, s65
s_mul_i32 s55, s65, s60
s_add_u32 s55, s55, s59
s_add_u32 m0, s62, 57344
s_nop 0
buffer_load_dwordx4 v9, s[36:39], s55 offen lds
s_add_u32 m0, s62, 61440
s_nop 0
buffer_load_dwordx4 v10, s[36:39], s55 offen lds
s_add_u32 m0, s62, 65536
s_nop 0
buffer_load_dwordx4 v11, s[36:39], s55 offen lds
s_add_u32 m0, s62, 69632
s_nop 0
buffer_load_dwordx4 v12, s[36:39], s55 offen lds
s_add_u32 m0, s62, 73728
s_nop 0
buffer_load_dwordx4 v13, s[36:39], s55 offen lds
s_add_u32 m0, s62, 77824
s_mul_i32 s63, s65, 2560
buffer_load_dwordx4 v14, s[40:43], s63 offen lds
s_add_u32 s64, s64, 1
s_cmp_eq_u32 s64, 10
s_cselect_b32 s64, 0, s64
s_lshl_b32 s57, s64, 7
s_add_u32 s57, s57, s56
s_add_u32 m0, s61, 81920
s_nop 0
buffer_load_dwordx4 v5, s[32:35], s57 offen lds
s_add_u32 m0, s61, 82944
s_nop 0
buffer_load_dwordx4 v6, s[32:35], s57 offen lds
s_add_u32 m0, s61, 83968
s_nop 0
buffer_load_dwordx4 v7, s[32:35], s57 offen lds
s_add_u32 m0, s61, 84992
s_nop 0
buffer_load_dwordx4 v8, s[32:35], s57 offen lds
s_waitcnt vmcnt(4)
s_barrier
s_add_u32 s65, s65, 1
s_cmp_eq_u32 s65, 10
s_cselect_b32 s65, 0, s65
s_mul_i32 s55, s65, s60
s_add_u32 s55, s55, s59
s_add_u32 m0, s62, 98304
s_nop 0
buffer_load_dwordx4 v9, s[36:39], s55 offen lds
s_add_u32 m0, s62, 102400
s_nop 0
buffer_load_dwordx4 v10, s[36:39], s55 offen lds
s_add_u32 m0, s62, 106496
s_nop 0
buffer_load_dwordx4 v11, s[36:39], s55 offen lds
s_add_u32 m0, s62, 110592
s_nop 0
buffer_load_dwordx4 v12, s[36:39], s55 offen lds
s_add_u32 m0, s62, 114688
s_nop 0
buffer_load_dwordx4 v13, s[36:39], s55 offen lds
s_add_u32 m0, s62, 118784
s_mul_i32 s63, s65, 2560
buffer_load_dwordx4 v14, s[40:43], s63 offen lds
s_add_u32 s64, s64, 1
s_cmp_eq_u32 s64, 10
s_cselect_b32 s64, 0, s64
s_lshl_b32 s57, s64, 7
s_add_u32 s57, s57, s56
s_add_u32 m0, s61, 122880
s_nop 0
buffer_load_dwordx4 v5, s[32:35], s57 offen lds
s_add_u32 m0, s61, 123904
s_nop 0
buffer_load_dwordx4 v6, s[32:35], s57 offen lds
s_add_u32 m0, s61, 124928
s_nop 0
buffer_load_dwordx4 v7, s[32:35], s57 offen lds
s_add_u32 m0, s61, 125952
s_nop 0
buffer_load_dwordx4 v8, s[32:35], s57 offen lds
s_waitcnt vmcnt(4)
s_barrier
s_add_u32 s65, s65, 1
s_cmp_eq_u32 s65, 10
s_cselect_b32 s65, 0, s65
s_mul_i32 s55, s65, s60
s_add_u32 s55, s55, s59
s_add_u32 m0, s62, 139264
s_nop 0
buffer_load_dwordx4 v9, s[36:39], s55 offen lds
s_add_u32 m0, s62, 143360
s_nop 0
buffer_load_dwordx4 v10, s[36:39], s55 offen lds
s_add_u32 m0, s62, 147456
s_nop 0
buffer_load_dwordx4 v11, s[36:39], s55 offen lds
s_add_u32 m0, s62, 151552
s_nop 0
buffer_load_dwordx4 v12, s[36:39], s55 offen lds
s_add_u32 m0, s62, 155648
s_nop 0
buffer_load_dwordx4 v13, s[36:39], s55 offen lds
s_add_u32 m0, s62, 159744
s_mul_i32 s63, s65, 2560
buffer_load_dwordx4 v14, s[40:43], s63 offen lds
s_add_u32 s64, s64, 1
s_cmp_eq_u32 s64, 10
s_cselect_b32 s64, 0, s64
s_lshl_b32 s57, s64, 7
s_add_u32 s57, s57, s56
s_add_u32 m0, s61, 0
s_nop 0
buffer_load_dwordx4 v5, s[32:35], s57 offen lds
s_add_u32 m0, s61, 1024
s_nop 0
buffer_load_dwordx4 v6, s[32:35], s57 offen lds
s_add_u32 m0, s61, 2048
s_nop 0
buffer_load_dwordx4 v7, s[32:35], s57 offen lds
s_add_u32 m0, s61, 3072
s_nop 0
buffer_load_dwordx4 v8, s[32:35], s57 offen lds
s_add_u32 s65, s65, 1
s_cmp_eq_u32 s65, 10
s_cselect_b32 s65, 0, s65
s_mul_i32 s55, s65, s60
s_add_u32 s55, s55, s59
s_add_u32 m0, s62, 16384
s_nop 0
buffer_load_dwordx4 v9, s[36:39], s55 offen lds
s_add_u32 m0, s62, 20480
s_nop 0
buffer_load_dwordx4 v10, s[36:39], s55 offen lds
s_add_u32 m0, s62, 24576
s_nop 0
buffer_load_dwordx4 v11, s[36:39], s55 offen lds
s_add_u32 m0, s62, 28672
s_nop 0
buffer_load_dwordx4 v12, s[36:39], s55 offen lds
s_add_u32 m0, s62, 32768
s_nop 0
buffer_load_dwordx4 v13, s[36:39], s55 offen lds
s_add_u32 m0, s62, 36864
s_mul_i32 s63, s65, 2560
buffer_load_dwordx4 v14, s[40:43], s63 offen lds
s_waitcnt vmcnt(10)
s_barrier
s_add_u32 s64, s64, 1
s_cmp_eq_u32 s64, 10
s_cselect_b32 s64, 0, s64
s_lshl_b32 s57, s64, 7
s_add_u32 s57, s57, s56
s_add_u32 m0, s61, 40960
s_nop 0
buffer_load_dwordx4 v5, s[32:35], s57 offen lds
s_add_u32 m0, s61, 41984
s_nop 0
buffer_load_dwordx4 v6, s[32:35], s57 offen lds
s_add_u32 m0, s61, 43008
s_nop 0
buffer_load_dwordx4 v7, s[32:35], s57 offen lds
s_add_u32 m0, s61, 44032
s_nop 0
buffer_load_dwordx4 v8, s[32:35], s57 offen lds
s_add_u32 s65, s65, 1
s_cmp_eq_u32 s65, 10
s_cselect_b32 s65, 0, s65
s_mul_i32 s55, s65, s60
s_add_u32 s55, s55, s59
s_add_u32 m0, s62, 57344
s_nop 0
buffer_load_dwordx4 v9, s[36:39], s55 offen lds
s_add_u32 m0, s62, 61440
s_nop 0
buffer_load_dwordx4 v10, s[36:39], s55 offen lds
s_add_u32 m0, s62, 65536
s_nop 0
buffer_load_dwordx4 v11, s[36:39], s55 offen lds
s_add_u32 m0, s62, 69632
s_nop 0
buffer_load_dwordx4 v12, s[36:39], s55 offen lds
s_add_u32 m0, s62, 73728
s_nop 0
buffer_load_dwordx4 v13, s[36:39], s55 offen lds
s_add_u32 m0, s62, 77824
s_mul_i32 s63, s65, 2560
buffer_load_dwordx4 v14, s[40:43], s63 offen lds
s_waitcnt vmcnt(10)
s_barrier
s_add_u32 s64, s64, 1
s_cmp_eq_u32 s64, 10
s_cselect_b32 s64, 0, s64
s_lshl_b32 s57, s64, 7
s_add_u32 s57, s57, s56
s_add_u32 m0, s61, 81920
s_nop 0
buffer_load_dwordx4 v5, s[32:35], s57 offen lds
s_add_u32 m0, s61, 82944
s_nop 0
buffer_load_dwordx4 v6, s[32:35], s57 offen lds
s_add_u32 m0, s61, 83968
s_nop 0
buffer_load_dwordx4 v7, s[32:35], s57 offen lds
s_add_u32 m0, s61, 84992
s_nop 0
buffer_load_dwordx4 v8, s[32:35], s57 offen lds
s_add_u32 s65, s65, 1
s_cmp_eq_u32 s65, 10
s_cselect_b32 s65, 0, s65
s_mul_i32 s55, s65, s60
s_add_u32 s55, s55, s59
s_add_u32 m0, s62, 98304
s_nop 0
buffer_load_dwordx4 v9, s[36:39], s55 offen lds
s_add_u32 m0, s62, 102400
s_nop 0
buffer_load_dwordx4 v10, s[36:39], s55 offen lds
s_add_u32 m0, s62, 106496
s_nop 0
buffer_load_dwordx4 v11, s[36:39], s55 offen lds
s_add_u32 m0, s62, 110592
s_nop 0
buffer_load_dwordx4 v12, s[36:39], s55 offen lds
s_add_u32 m0, s62, 114688
s_nop 0
buffer_load_dwordx4 v13, s[36:39], s55 offen lds
s_add_u32 m0, s62, 118784
s_mul_i32 s63, s65, 2560
buffer_load_dwordx4 v14, s[40:43], s63 offen lds
s_waitcnt vmcnt(10)
s_barrier
s_add_u32 s64, s64, 1
s_cmp_eq_u32 s64, 10
s_cselect_b32 s64, 0, s64
s_lshl_b32 s57, s64, 7
s_add_u32 s57, s57, s56
s_add_u32 m0, s61, 122880
s_nop 0
buffer_load_dwordx4 v5, s[32:35], s57 offen lds
s_add_u32 m0, s61, 123904
s_nop 0
buffer_load_dwordx4 v6, s[32:35], s57 offen lds
s_add_u32 m0, s61, 124928
s_nop 0
buffer_load_dwordx4 v7, s[32:35], s57 offen lds
s_add_u32 m0, s61, 125952
s_nop 0
buffer_load_dwordx4 v8, s[32:35], s57 offen lds
s_add_u32 s65, s65, 1
s_cmp_eq_u32 s65, 10
s_cselect_b32 s65, 0, s65
s_mul_i32 s55, s65, s60
s_add_u32 s55, s55, s59
s_add_u32 m0, s62, 139264
s_nop 0
buffer_load_dwordx4 v9, s[36:39], s55 offen lds
s_add_u32 m0, s62, 143360
s_nop 0
buffer_load_dwordx4 v10, s[36:39], s55 offen lds
s_add_u32 m0, s62, 147456
s_nop 0
buffer_load_dwordx4 v11, s[36:39], s55 offen lds
s_add_u32 m0, s62, 151552
s_nop 0
buffer_load_dwordx4 v12, s[36:39], s55 offen lds
s_add_u32 m0, s62, 155648
s_nop 0
buffer_load_dwordx4 v13, s[36:39], s55 offen lds
s_add_u32 m0, s62, 159744
s_mul_i32 s63, s65, 2560
buffer_load_dwordx4 v14, s[40:43], s63 offen lds
s_waitcnt vmcnt(10)
s_barrier
s_add_u32 s64, s64, 1
s_cmp_eq_u32 s64, 10
s_cselect_b32 s64, 0, s64
s_lshl_b32 s57, s64, 7
s_add_u32 s57, s57, s56
s_add_u32 m0, s61, 0
s_nop 0
buffer_load_dwordx4 v5, s[32:35], s57 offen lds
s_add_u32 m0, s61, 1024
s_nop 0
buffer_load_dwordx4 v6, s[32:35], s57 offen lds
s_add_u32 m0, s61, 2048
s_nop 0
buffer_load_dwordx4 v7, s[32:35], s57 offen lds
s_add_u32 m0, s61, 3072
s_nop 0
buffer_load_dwordx4 v8, s[32:35], s57 offen lds
s_add_u32 s65, s65, 1
s_cmp_eq_u32 s65, 10
s_cselect_b32 s65, 0, s65
s_mul_i32 s55, s65, s60
s_add_u32 s55, s55, s59
s_add_u32 m0, s62, 16384
s_nop 0
buffer_load_dwordx4 v9, s[36:39], s55 offen lds
s_add_u32 m0, s62, 20480
s_nop 0
buffer_load_dwordx4 v10, s[36:39], s55 offen lds
s_add_u32 m0, s62, 24576
s_nop 0
buffer_load_dwordx4 v11, s[36:39], s55 offen lds
s_add_u32 m0, s62, 28672
s_nop 0
buffer_load_dwordx4 v12, s[36:39], s55 offen lds
s_add_u32 m0, s62, 32768
s_nop 0
buffer_load_dwordx4 v13, s[36:39], s55 offen lds
s_add_u32 m0, s62, 36864
s_mul_i32 s63, s65, 2560
buffer_load_dwordx4 v14, s[40:43], s63 offen lds
s_waitcnt vmcnt(10)
s_barrier
s_add_u32 s64, s64, 1
s_cmp_eq_u32 s64, 10
s_cselect_b32 s64, 0, s64
s_lshl_b32 s57, s64, 7
s_add_u32 s57, s57, s56
s_add_u32 m0, s61, 40960
s_nop 0
buffer_load_dwordx4 v5, s[32:35], s57 offen lds
s_add_u32 m0, s61, 41984
s_nop 0
buffer_load_dwordx4 v6, s[32:35], s57 offen lds
s_add_u32 m0, s61, 43008
s_nop 0
buffer_load_dwordx4 v7, s[32:35], s57 offen lds
s_add_u32 m0, s61, 44032
s_nop 0
buffer_load_dwordx4 v8, s[32:35], s57 offen lds
s_add_u32 s65, s65, 1
s_cmp_eq_u32 s65, 10
s_cselect_b32 s65, 0, s65
s_mul_i32 s55, s65, s60
s_add_u32 s55, s55, s59
s_add_u32 m0, s62, 57344
s_nop 0
buffer_load_dwordx4 v9, s[36:39], s55 offen lds
s_add_u32 m0, s62, 61440
s_nop 0
buffer_load_dwordx4 v10, s[36:39], s55 offen lds
s_add_u32 m0, s62, 65536
s_nop 0
buffer_load_dwordx4 v11, s[36:39], s55 offen lds
s_add_u32 m0, s62, 69632
s_nop 0
buffer_load_dwordx4 v12, s[36:39], s55 offen lds
s_add_u32 m0, s62, 73728
s_nop 0
buffer_load_dwordx4 v13, s[36:39], s55 offen lds
s_add_u32 m0, s62, 77824
s_mul_i32 s63, s65, 2560
buffer_load_dwordx4 v14, s[40:43], s63 offen lds
s_waitcnt vmcnt(10)
s_barrier
s_waitcnt vmcnt(0)
s_barrier
concat_heads__mha_block__grouped_kv_mqa__prompt_kernel_ldE:
v_or_b32 v0, 0x100, v0
s_branch attn
concat_heads__mha_block__grouped_kv_mqa__prompt_kernel_compute:
v_and_b32 v2, 15, v0
v_lshrrev_b32 v3, 4, v1
s_and_b32 s12, s11, 1
s_lshr_b32 s13, s11, 1
v_lshrrev_b32 v17, 1, v2
v_xor_b32 v17, v17, v3
v_lshlrev_b32 v17, 4, v17
v_lshl_add_u32 v17, v2, 7, v17
s_lshl_b32 s14, s12, 13
v_add_u32 v5, s14, v17
v_xor_b32 v6, 64, v5
v_lshrrev_b32 v17, 1, v3
v_lshlrev_b32 v17, 4, v17
v_and_b32 v18, 1, v3
v_lshl_add_u32 v17, v18, 2, v17
v_bfe_u32 v19, v1, 2, 2
v_add_u32 v17, v17, v19
v_mul_u32_u24 v17, 160, v17
v_and_b32 v18, 3, v1
v_mul_u32_u24 v20, 40, v18
s_mul_i32 s14, s13, 10240
v_add3_u32 v9, v17, v20, s14
s_and_b32 s15, s10, 2
s_add_u32 s15, s15, s13
s_lshl_b32 s14, s15, 11
v_add_u32 v11, s14, v5
v_add_u32 v12, s14, v6
v_lshl_add_u32 v17, v3, 3, v19
v_mul_u32_u24 v17, 40, v17
v_lshl_add_u32 v15, v18, 3, v17
v_add_u32 v7, 81920, v5
v_add_u32 v8, 81920, v6
v_add_u32 v10, 81920, v9
v_add_u32 v13, 81920, v11
v_add_u32 v14, 81920, v12
v_add_u32 v16, 81920, v15
s_lshl_b32 s56, s9, 2
s_lshl_b32 s57, s12, 1
s_add_u32 s56, s56, s57
s_lshl_b32 s58, s10, 3
s_lshl_b32 s57, s13, 2
s_add_u32 s58, s58, s57
s_mov_b32 s46, 0x10000000
s_mov_b32 s47, 0x00020000
s_waitcnt lgkmcnt(0)
s_mov_b32 s44, s4
s_and_b32 s45, s5, 0xffff
s_lshl2_add_u32 s3, s8, s10
s_lshl4_add_u32 s3, s3, s9
s_lshl_b32 s3, s3, 7
s_add_u32 s3, s3, 19398656
v_mov_b32 v17, 121856
v_mov_b32 v19, 0
ds_write_b32 v17, v19
s_or_b32 s50, s2, s11
s_cmp_lg_u32 s50, 0
s_cbranch_scc1 concat_heads__mha_block__grouped_kv_mqa__prompt_kernel_noclr
s_load_dwordx2 s[48:49], s[0:1], 72
s_memrealtime s[52:53]
s_movk_i32 s50, 256
s_mov_b32 s51, 0x00020000
v_mov_b32 v17, 0
s_waitcnt lgkmcnt(0)
s_and_b32 s49, s49, 0xffff
s_or_b32 s54, s52, 1
v_mov_b32 v19, s54
s_mov_b64 exec, 1
buffer_store_dword v19, v17, s[48:51], 0 offen sc1
s_mov_b64 exec, -1
concat_heads__mha_block__grouped_kv_mqa__prompt_kernel_noclr:
s_cmp_eq_u32 s8, 2
s_cbranch_scc1 concat_heads__mha_block__grouped_kv_mqa__prompt_kernel_V
s_cmp_lt_u32 s8, 2
s_cbranch_scc1 concat_heads__mha_block__grouped_kv_mqa__prompt_kernel_QK0
s_bitcmp1_b32 s10, 0
s_cbranch_scc1 concat_heads__mha_block__grouped_kv_mqa__prompt_kernel_QK2
concat_heads__mha_block__grouped_kv_mqa__prompt_kernel_QK1:
v_add_u32 v15, 36864, v15
v_add_u32 v16, 36864, v16
v_lshl_add_u32 v15, v18, 3, v15
v_lshl_add_u32 v16, v18, 3, v16
s_barrier
ds_read_b64_tr_b16 v[128:129], v9 offset:16384
ds_read_b64_tr_b16 v[130:131], v9 offset:17664
ds_read_b128 v[112:115], v5 offset:0
ds_read_b128 v[116:119], v5 offset:2048
ds_read_b128 v[120:123], v5 offset:4096
ds_read_b128 v[124:127], v5 offset:6144
ds_read_b64_tr_b16 v[132:133], v9 offset:16392
ds_read_b64_tr_b16 v[134:135], v9 offset:17672
ds_read_b64_tr_b16 v[136:137], v9 offset:16400
ds_read_b64_tr_b16 v[138:139], v9 offset:17680
ds_read_b64_tr_b16 v[140:141], v9 offset:16408
ds_read_b64_tr_b16 v[142:143], v9 offset:17688
ds_read_b64_tr_b16 v[144:145], v9 offset:16416
ds_read_b64_tr_b16 v[146:147], v9 offset:17696
s_waitcnt lgkmcnt(8)
ds_read_b128 v[148:151], v11 offset:0
ds_read_b64_tr_b16 v[152:153], v15 offset:0
ds_read_b64_tr_b16 v[154:155], v15 offset:160
ds_read_b64_tr_b16 v[156:157], v15 offset:8
ds_read_b64_tr_b16 v[158:159], v15 offset:168
s_waitcnt lgkmcnt(13)
v_mfma_f32_16x16x32_bf16 v[24:27], v[128:131], v[112:115], 0
v_mfma_f32_16x16x32_bf16 v[44:47], v[128:131], v[116:119], 0
v_mfma_f32_16x16x32_bf16 v[64:67], v[128:131], v[120:123], 0
v_mfma_f32_16x16x32_bf16 v[84:87], v[128:131], v[124:127], 0
s_waitcnt lgkmcnt(0)
ds_read_b64_tr_b16 v[176:177], v9 offset:21504
ds_read_b64_tr_b16 v[178:179], v9 offset:22784
v_mfma_f32_16x16x32_bf16 v[28:31], v[132:135], v[112:115], 0
ds_read_b128 v[160:163], v6 offset:0
v_mfma_f32_16x16x32_bf16 v[48:51], v[132:135], v[116:119], 0
ds_read_b128 v[164:167], v6 offset:2048
v_mfma_f32_16x16x32_bf16 v[68:71], v[132:135], v[120:123], 0
ds_read_b128 v[168:171], v6 offset:4096
v_mfma_f32_16x16x32_bf16 v[88:91], v[132:135], v[124:127], 0
ds_read_b128 v[172:175], v6 offset:6144
v_mfma_f32_16x16x32_bf16 v[32:35], v[136:139], v[112:115], 0
ds_read_b64_tr_b16 v[180:181], v9 offset:21512
v_mfma_f32_16x16x32_bf16 v[52:55], v[136:139], v[116:119], 0
ds_read_b64_tr_b16 v[182:183], v9 offset:22792
v_mfma_f32_16x16x32_bf16 v[72:75], v[136:139], v[120:123], 0
ds_read_b64_tr_b16 v[184:185], v9 offset:21520
v_mfma_f32_16x16x32_bf16 v[92:95], v[136:139], v[124:127], 0
ds_read_b64_tr_b16 v[186:187], v9 offset:22800
v_mfma_f32_16x16x32_bf16 v[36:39], v[140:143], v[112:115], 0
ds_read_b64_tr_b16 v[188:189], v9 offset:21528
v_mfma_f32_16x16x32_bf16 v[56:59], v[140:143], v[116:119], 0
ds_read_b64_tr_b16 v[190:191], v9 offset:22808
v_mfma_f32_16x16x32_bf16 v[76:79], v[140:143], v[120:123], 0
ds_read_b64_tr_b16 v[192:193], v9 offset:21536
v_mfma_f32_16x16x32_bf16 v[96:99], v[140:143], v[124:127], 0
ds_read_b64_tr_b16 v[194:195], v9 offset:22816
v_mfma_f32_16x16x32_bf16 v[40:43], v[144:147], v[112:115], 0
s_waitcnt lgkmcnt(8)
v_mfma_f32_16x16x32_bf16 v[60:63], v[144:147], v[116:119], 0
ds_read_b128 v[196:199], v12 offset:0
v_mfma_f32_16x16x32_bf16 v[80:83], v[144:147], v[120:123], 0
ds_read_b64_tr_b16 v[200:201], v15 offset:1280
v_mfma_f32_16x16x32_bf16 v[100:103], v[144:147], v[124:127], 0
ds_read_b64_tr_b16 v[202:203], v15 offset:1440
v_mfma_f32_16x16x32_bf16 v[104:107], v[152:155], v[148:151], 0
ds_read_b64_tr_b16 v[204:205], v15 offset:1288
v_mfma_f32_16x16x32_bf16 v[108:111], v[156:159], v[148:151], 0
ds_read_b64_tr_b16 v[206:207], v15 offset:1448
s_waitcnt lgkmcnt(13)
v_mfma_f32_16x16x32_bf16 v[24:27], v[176:179], v[160:163], v[24:27]
v_mfma_f32_16x16x32_bf16 v[44:47], v[176:179], v[164:167], v[44:47]
v_mfma_f32_16x16x32_bf16 v[64:67], v[176:179], v[168:171], v[64:67]
v_mfma_f32_16x16x32_bf16 v[84:87], v[176:179], v[172:175], v[84:87]
s_waitcnt lgkmcnt(0)
s_barrier
ds_read_b64_tr_b16 v[128:129], v9 offset:57344
ds_read_b64_tr_b16 v[130:131], v9 offset:58624
v_mfma_f32_16x16x32_bf16 v[28:31], v[180:183], v[160:163], v[28:31]
ds_read_b128 v[112:115], v5 offset:40960
v_mfma_f32_16x16x32_bf16 v[48:51], v[180:183], v[164:167], v[48:51]
ds_read_b128 v[116:119], v5 offset:43008
v_mfma_f32_16x16x32_bf16 v[68:71], v[180:183], v[168:171], v[68:71]
ds_read_b128 v[120:123], v5 offset:45056
v_mfma_f32_16x16x32_bf16 v[88:91], v[180:183], v[172:175], v[88:91]
ds_read_b128 v[124:127], v5 offset:47104
v_mfma_f32_16x16x32_bf16 v[32:35], v[184:187], v[160:163], v[32:35]
ds_read_b64_tr_b16 v[132:133], v9 offset:57352
v_mfma_f32_16x16x32_bf16 v[52:55], v[184:187], v[164:167], v[52:55]
ds_read_b64_tr_b16 v[134:135], v9 offset:58632
v_mfma_f32_16x16x32_bf16 v[72:75], v[184:187], v[168:171], v[72:75]
ds_read_b64_tr_b16 v[136:137], v9 offset:57360
v_mfma_f32_16x16x32_bf16 v[92:95], v[184:187], v[172:175], v[92:95]
ds_read_b64_tr_b16 v[138:139], v9 offset:58640
v_mfma_f32_16x16x32_bf16 v[36:39], v[188:191], v[160:163], v[36:39]
ds_read_b64_tr_b16 v[140:141], v9 offset:57368
v_mfma_f32_16x16x32_bf16 v[56:59], v[188:191], v[164:167], v[56:59]
ds_read_b64_tr_b16 v[142:143], v9 offset:58648
v_mfma_f32_16x16x32_bf16 v[76:79], v[188:191], v[168:171], v[76:79]
ds_read_b64_tr_b16 v[144:145], v9 offset:57376
v_mfma_f32_16x16x32_bf16 v[96:99], v[188:191], v[172:175], v[96:99]
ds_read_b64_tr_b16 v[146:147], v9 offset:58656
v_mfma_f32_16x16x32_bf16 v[40:43], v[192:195], v[160:163], v[40:43]
s_waitcnt lgkmcnt(8)
v_mfma_f32_16x16x32_bf16 v[60:63], v[192:195], v[164:167], v[60:63]
ds_read_b128 v[148:151], v11 offset:40960
v_mfma_f32_16x16x32_bf16 v[80:83], v[192:195], v[168:171], v[80:83]
ds_read_b64_tr_b16 v[152:153], v15 offset:40960
v_mfma_f32_16x16x32_bf16 v[100:103], v[192:195], v[172:175], v[100:103]
ds_read_b64_tr_b16 v[154:155], v15 offset:41120
v_mfma_f32_16x16x32_bf16 v[104:107], v[200:203], v[196:199], v[104:107]
ds_read_b64_tr_b16 v[156:157], v15 offset:40968
v_mfma_f32_16x16x32_bf16 v[108:111], v[204:207], v[196:199], v[108:111]
ds_read_b64_tr_b16 v[158:159], v15 offset:41128
s_waitcnt lgkmcnt(13)
v_mfma_f32_16x16x32_bf16 v[24:27], v[128:131], v[112:115], v[24:27]
v_mfma_f32_16x16x32_bf16 v[44:47], v[128:131], v[116:119], v[44:47]
v_mfma_f32_16x16x32_bf16 v[64:67], v[128:131], v[120:123], v[64:67]
v_mfma_f32_16x16x32_bf16 v[84:87], v[128:131], v[124:127], v[84:87]
s_waitcnt lgkmcnt(0)
ds_read_b64_tr_b16 v[176:177], v9 offset:62464
ds_read_b64_tr_b16 v[178:179], v9 offset:63744
v_mfma_f32_16x16x32_bf16 v[28:31], v[132:135], v[112:115], v[28:31]
ds_read_b128 v[160:163], v6 offset:40960
v_mfma_f32_16x16x32_bf16 v[48:51], v[132:135], v[116:119], v[48:51]
ds_read_b128 v[164:167], v6 offset:43008
v_mfma_f32_16x16x32_bf16 v[68:71], v[132:135], v[120:123], v[68:71]
ds_read_b128 v[168:171], v6 offset:45056
v_mfma_f32_16x16x32_bf16 v[88:91], v[132:135], v[124:127], v[88:91]
ds_read_b128 v[172:175], v6 offset:47104
v_mfma_f32_16x16x32_bf16 v[32:35], v[136:139], v[112:115], v[32:35]
ds_read_b64_tr_b16 v[180:181], v9 offset:62472
v_mfma_f32_16x16x32_bf16 v[52:55], v[136:139], v[116:119], v[52:55]
ds_read_b64_tr_b16 v[182:183], v9 offset:63752
v_mfma_f32_16x16x32_bf16 v[72:75], v[136:139], v[120:123], v[72:75]
ds_read_b64_tr_b16 v[184:185], v9 offset:62480
v_mfma_f32_16x16x32_bf16 v[92:95], v[136:139], v[124:127], v[92:95]
ds_read_b64_tr_b16 v[186:187], v9 offset:63760
v_mfma_f32_16x16x32_bf16 v[36:39], v[140:143], v[112:115], v[36:39]
ds_read_b64_tr_b16 v[188:189], v9 offset:62488
v_mfma_f32_16x16x32_bf16 v[56:59], v[140:143], v[116:119], v[56:59]
ds_read_b64_tr_b16 v[190:191], v9 offset:63768
v_mfma_f32_16x16x32_bf16 v[76:79], v[140:143], v[120:123], v[76:79]
ds_read_b64_tr_b16 v[192:193], v9 offset:62496
v_mfma_f32_16x16x32_bf16 v[96:99], v[140:143], v[124:127], v[96:99]
ds_read_b64_tr_b16 v[194:195], v9 offset:63776
v_mfma_f32_16x16x32_bf16 v[40:43], v[144:147], v[112:115], v[40:43]
s_waitcnt lgkmcnt(8)
v_mfma_f32_16x16x32_bf16 v[60:63], v[144:147], v[116:119], v[60:63]
ds_read_b128 v[196:199], v12 offset:40960
v_mfma_f32_16x16x32_bf16 v[80:83], v[144:147], v[120:123], v[80:83]
ds_read_b64_tr_b16 v[200:201], v15 offset:42240
v_mfma_f32_16x16x32_bf16 v[100:103], v[144:147], v[124:127], v[100:103]
ds_read_b64_tr_b16 v[202:203], v15 offset:42400
v_mfma_f32_16x16x32_bf16 v[104:107], v[152:155], v[148:151], v[104:107]
ds_read_b64_tr_b16 v[204:205], v15 offset:42248
v_mfma_f32_16x16x32_bf16 v[108:111], v[156:159], v[148:151], v[108:111]
ds_read_b64_tr_b16 v[206:207], v15 offset:42408
s_waitcnt lgkmcnt(13)
v_mfma_f32_16x16x32_bf16 v[24:27], v[176:179], v[160:163], v[24:27]
v_mfma_f32_16x16x32_bf16 v[44:47], v[176:179], v[164:167], v[44:47]
v_mfma_f32_16x16x32_bf16 v[64:67], v[176:179], v[168:171], v[64:67]
v_mfma_f32_16x16x32_bf16 v[84:87], v[176:179], v[172:175], v[84:87]
s_waitcnt lgkmcnt(0)
s_barrier
ds_read_b64_tr_b16 v[128:129], v10 offset:16384
ds_read_b64_tr_b16 v[130:131], v10 offset:17664
v_mfma_f32_16x16x32_bf16 v[28:31], v[180:183], v[160:163], v[28:31]
ds_read_b128 v[112:115], v7 offset:0
v_mfma_f32_16x16x32_bf16 v[48:51], v[180:183], v[164:167], v[48:51]
ds_read_b128 v[116:119], v7 offset:2048
v_mfma_f32_16x16x32_bf16 v[68:71], v[180:183], v[168:171], v[68:71]
ds_read_b128 v[120:123], v7 offset:4096
v_mfma_f32_16x16x32_bf16 v[88:91], v[180:183], v[172:175], v[88:91]
ds_read_b128 v[124:127], v7 offset:6144
v_mfma_f32_16x16x32_bf16 v[32:35], v[184:187], v[160:163], v[32:35]
ds_read_b64_tr_b16 v[132:133], v10 offset:16392
v_mfma_f32_16x16x32_bf16 v[52:55], v[184:187], v[164:167], v[52:55]
ds_read_b64_tr_b16 v[134:135], v10 offset:17672
v_mfma_f32_16x16x32_bf16 v[72:75], v[184:187], v[168:171], v[72:75]
ds_read_b64_tr_b16 v[136:137], v10 offset:16400
v_mfma_f32_16x16x32_bf16 v[92:95], v[184:187], v[172:175], v[92:95]
ds_read_b64_tr_b16 v[138:139], v10 offset:17680
v_mfma_f32_16x16x32_bf16 v[36:39], v[188:191], v[160:163], v[36:39]
ds_read_b64_tr_b16 v[140:141], v10 offset:16408
v_mfma_f32_16x16x32_bf16 v[56:59], v[188:191], v[164:167], v[56:59]
ds_read_b64_tr_b16 v[142:143], v10 offset:17688
v_mfma_f32_16x16x32_bf16 v[76:79], v[188:191], v[168:171], v[76:79]
ds_read_b64_tr_b16 v[144:145], v10 offset:16416
v_mfma_f32_16x16x32_bf16 v[96:99], v[188:191], v[172:175], v[96:99]
ds_read_b64_tr_b16 v[146:147], v10 offset:17696
v_mfma_f32_16x16x32_bf16 v[40:43], v[192:195], v[160:163], v[40:43]
s_waitcnt lgkmcnt(8)
v_mfma_f32_16x16x32_bf16 v[60:63], v[192:195], v[164:167], v[60:63]
ds_read_b128 v[148:151], v13 offset:0
v_mfma_f32_16x16x32_bf16 v[80:83], v[192:195], v[168:171], v[80:83]
ds_read_b64_tr_b16 v[152:153], v16 offset:0
v_mfma_f32_16x16x32_bf16 v[100:103], v[192:195], v[172:175], v[100:103]
ds_read_b64_tr_b16 v[154:155], v16 offset:160
v_mfma_f32_16x16x32_bf16 v[104:107], v[200:203], v[196:199], v[104:107]
ds_read_b64_tr_b16 v[156:157], v16 offset:8
v_mfma_f32_16x16x32_bf16 v[108:111], v[204:207], v[196:199], v[108:111]
ds_read_b64_tr_b16 v[158:159], v16 offset:168
s_waitcnt lgkmcnt(13)
v_mfma_f32_16x16x32_bf16 v[24:27], v[128:131], v[112:115], v[24:27]
v_mfma_f32_16x16x32_bf16 v[44:47], v[128:131], v[116:119], v[44:47]
v_mfma_f32_16x16x32_bf16 v[64:67], v[128:131], v[120:123], v[64:67]
v_mfma_f32_16x16x32_bf16 v[84:87], v[128:131], v[124:127], v[84:87]
s_waitcnt lgkmcnt(0)
ds_read_b64_tr_b16 v[176:177], v10 offset:21504
ds_read_b64_tr_b16 v[178:179], v10 offset:22784
v_mfma_f32_16x16x32_bf16 v[28:31], v[132:135], v[112:115], v[28:31]
ds_read_b128 v[160:163], v8 offset:0
v_mfma_f32_16x16x32_bf16 v[48:51], v[132:135], v[116:119], v[48:51]
ds_read_b128 v[164:167], v8 offset:2048
v_mfma_f32_16x16x32_bf16 v[68:71], v[132:135], v[120:123], v[68:71]
ds_read_b128 v[168:171], v8 offset:4096
v_mfma_f32_16x16x32_bf16 v[88:91], v[132:135], v[124:127], v[88:91]
ds_read_b128 v[172:175], v8 offset:6144
v_mfma_f32_16x16x32_bf16 v[32:35], v[136:139], v[112:115], v[32:35]
ds_read_b64_tr_b16 v[180:181], v10 offset:21512
v_mfma_f32_16x16x32_bf16 v[52:55], v[136:139], v[116:119], v[52:55]
ds_read_b64_tr_b16 v[182:183], v10 offset:22792
v_mfma_f32_16x16x32_bf16 v[72:75], v[136:139], v[120:123], v[72:75]
ds_read_b64_tr_b16 v[184:185], v10 offset:21520
v_mfma_f32_16x16x32_bf16 v[92:95], v[136:139], v[124:127], v[92:95]
ds_read_b64_tr_b16 v[186:187], v10 offset:22800
v_mfma_f32_16x16x32_bf16 v[36:39], v[140:143], v[112:115], v[36:39]
ds_read_b64_tr_b16 v[188:189], v10 offset:21528
v_mfma_f32_16x16x32_bf16 v[56:59], v[140:143], v[116:119], v[56:59]
ds_read_b64_tr_b16 v[190:191], v10 offset:22808
v_mfma_f32_16x16x32_bf16 v[76:79], v[140:143], v[120:123], v[76:79]
ds_read_b64_tr_b16 v[192:193], v10 offset:21536
v_mfma_f32_16x16x32_bf16 v[96:99], v[140:143], v[124:127], v[96:99]
ds_read_b64_tr_b16 v[194:195], v10 offset:22816
v_mfma_f32_16x16x32_bf16 v[40:43], v[144:147], v[112:115], v[40:43]
s_waitcnt lgkmcnt(8)
v_mfma_f32_16x16x32_bf16 v[60:63], v[144:147], v[116:119], v[60:63]
ds_read_b128 v[196:199], v14 offset:0
v_mfma_f32_16x16x32_bf16 v[80:83], v[144:147], v[120:123], v[80:83]
ds_read_b64_tr_b16 v[200:201], v16 offset:1280
v_mfma_f32_16x16x32_bf16 v[100:103], v[144:147], v[124:127], v[100:103]
ds_read_b64_tr_b16 v[202:203], v16 offset:1440
v_mfma_f32_16x16x32_bf16 v[104:107], v[152:155], v[148:151], v[104:107]
ds_read_b64_tr_b16 v[204:205], v16 offset:1288
v_mfma_f32_16x16x32_bf16 v[108:111], v[156:159], v[148:151], v[108:111]
ds_read_b64_tr_b16 v[206:207], v16 offset:1448
s_waitcnt lgkmcnt(13)
v_mfma_f32_16x16x32_bf16 v[24:27], v[176:179], v[160:163], v[24:27]
v_mfma_f32_16x16x32_bf16 v[44:47], v[176:179], v[164:167], v[44:47]
v_mfma_f32_16x16x32_bf16 v[64:67], v[176:179], v[168:171], v[64:67]
v_mfma_f32_16x16x32_bf16 v[84:87], v[176:179], v[172:175], v[84:87]
s_waitcnt lgkmcnt(0)
s_barrier
ds_read_b64_tr_b16 v[128:129], v10 offset:57344
ds_read_b64_tr_b16 v[130:131], v10 offset:58624
v_mfma_f32_16x16x32_bf16 v[28:31], v[180:183], v[160:163], v[28:31]
ds_read_b128 v[112:115], v7 offset:40960
v_mfma_f32_16x16x32_bf16 v[48:51], v[180:183], v[164:167], v[48:51]
ds_read_b128 v[116:119], v7 offset:43008
v_mfma_f32_16x16x32_bf16 v[68:71], v[180:183], v[168:171], v[68:71]
ds_read_b128 v[120:123], v7 offset:45056
v_mfma_f32_16x16x32_bf16 v[88:91], v[180:183], v[172:175], v[88:91]
ds_read_b128 v[124:127], v7 offset:47104
v_mfma_f32_16x16x32_bf16 v[32:35], v[184:187], v[160:163], v[32:35]
ds_read_b64_tr_b16 v[132:133], v10 offset:57352
v_mfma_f32_16x16x32_bf16 v[52:55], v[184:187], v[164:167], v[52:55]
ds_read_b64_tr_b16 v[134:135], v10 offset:58632
v_mfma_f32_16x16x32_bf16 v[72:75], v[184:187], v[168:171], v[72:75]
ds_read_b64_tr_b16 v[136:137], v10 offset:57360
v_mfma_f32_16x16x32_bf16 v[92:95], v[184:187], v[172:175], v[92:95]
ds_read_b64_tr_b16 v[138:139], v10 offset:58640
v_mfma_f32_16x16x32_bf16 v[36:39], v[188:191], v[160:163], v[36:39]
ds_read_b64_tr_b16 v[140:141], v10 offset:57368
v_mfma_f32_16x16x32_bf16 v[56:59], v[188:191], v[164:167], v[56:59]
ds_read_b64_tr_b16 v[142:143], v10 offset:58648
v_mfma_f32_16x16x32_bf16 v[76:79], v[188:191], v[168:171], v[76:79]
ds_read_b64_tr_b16 v[144:145], v10 offset:57376
v_mfma_f32_16x16x32_bf16 v[96:99], v[188:191], v[172:175], v[96:99]
ds_read_b64_tr_b16 v[146:147], v10 offset:58656
v_mfma_f32_16x16x32_bf16 v[40:43], v[192:195], v[160:163], v[40:43]
s_waitcnt lgkmcnt(8)
v_mfma_f32_16x16x32_bf16 v[60:63], v[192:195], v[164:167], v[60:63]
ds_read_b128 v[148:151], v13 offset:40960
v_mfma_f32_16x16x32_bf16 v[80:83], v[192:195], v[168:171], v[80:83]
ds_read_b64_tr_b16 v[152:153], v16 offset:40960
v_mfma_f32_16x16x32_bf16 v[100:103], v[192:195], v[172:175], v[100:103]
ds_read_b64_tr_b16 v[154:155], v16 offset:41120
v_mfma_f32_16x16x32_bf16 v[104:107], v[200:203], v[196:199], v[104:107]
ds_read_b64_tr_b16 v[156:157], v16 offset:40968
v_mfma_f32_16x16x32_bf16 v[108:111], v[204:207], v[196:199], v[108:111]
ds_read_b64_tr_b16 v[158:159], v16 offset:41128
s_waitcnt lgkmcnt(13)
v_mfma_f32_16x16x32_bf16 v[24:27], v[128:131], v[112:115], v[24:27]
v_mfma_f32_16x16x32_bf16 v[44:47], v[128:131], v[116:119], v[44:47]
v_mfma_f32_16x16x32_bf16 v[64:67], v[128:131], v[120:123], v[64:67]
v_mfma_f32_16x16x32_bf16 v[84:87], v[128:131], v[124:127], v[84:87]
s_waitcnt lgkmcnt(0)
ds_read_b64_tr_b16 v[176:177], v10 offset:62464
ds_read_b64_tr_b16 v[178:179], v10 offset:63744
v_mfma_f32_16x16x32_bf16 v[28:31], v[132:135], v[112:115], v[28:31]
ds_read_b128 v[160:163], v8 offset:40960
v_mfma_f32_16x16x32_bf16 v[48:51], v[132:135], v[116:119], v[48:51]
ds_read_b128 v[164:167], v8 offset:43008
v_mfma_f32_16x16x32_bf16 v[68:71], v[132:135], v[120:123], v[68:71]
ds_read_b128 v[168:171], v8 offset:45056
v_mfma_f32_16x16x32_bf16 v[88:91], v[132:135], v[124:127], v[88:91]
ds_read_b128 v[172:175], v8 offset:47104
v_mfma_f32_16x16x32_bf16 v[32:35], v[136:139], v[112:115], v[32:35]
ds_read_b64_tr_b16 v[180:181], v10 offset:62472
v_mfma_f32_16x16x32_bf16 v[52:55], v[136:139], v[116:119], v[52:55]
ds_read_b64_tr_b16 v[182:183], v10 offset:63752
v_mfma_f32_16x16x32_bf16 v[72:75], v[136:139], v[120:123], v[72:75]
ds_read_b64_tr_b16 v[184:185], v10 offset:62480
v_mfma_f32_16x16x32_bf16 v[92:95], v[136:139], v[124:127], v[92:95]
ds_read_b64_tr_b16 v[186:187], v10 offset:63760
v_mfma_f32_16x16x32_bf16 v[36:39], v[140:143], v[112:115], v[36:39]
ds_read_b64_tr_b16 v[188:189], v10 offset:62488
v_mfma_f32_16x16x32_bf16 v[56:59], v[140:143], v[116:119], v[56:59]
ds_read_b64_tr_b16 v[190:191], v10 offset:63768
v_mfma_f32_16x16x32_bf16 v[76:79], v[140:143], v[120:123], v[76:79]
ds_read_b64_tr_b16 v[192:193], v10 offset:62496
v_mfma_f32_16x16x32_bf16 v[96:99], v[140:143], v[124:127], v[96:99]
ds_read_b64_tr_b16 v[194:195], v10 offset:63776
v_mfma_f32_16x16x32_bf16 v[40:43], v[144:147], v[112:115], v[40:43]
s_waitcnt lgkmcnt(8)
v_mfma_f32_16x16x32_bf16 v[60:63], v[144:147], v[116:119], v[60:63]
ds_read_b128 v[196:199], v14 offset:40960
v_mfma_f32_16x16x32_bf16 v[80:83], v[144:147], v[120:123], v[80:83]
ds_read_b64_tr_b16 v[200:201], v16 offset:42240
v_mfma_f32_16x16x32_bf16 v[100:103], v[144:147], v[124:127], v[100:103]
ds_read_b64_tr_b16 v[202:203], v16 offset:42400
v_mfma_f32_16x16x32_bf16 v[104:107], v[152:155], v[148:151], v[104:107]
ds_read_b64_tr_b16 v[204:205], v16 offset:42248
v_mfma_f32_16x16x32_bf16 v[108:111], v[156:159], v[148:151], v[108:111]
ds_read_b64_tr_b16 v[206:207], v16 offset:42408
s_waitcnt lgkmcnt(13)
v_mfma_f32_16x16x32_bf16 v[24:27], v[176:179], v[160:163], v[24:27]
v_mfma_f32_16x16x32_bf16 v[44:47], v[176:179], v[164:167], v[44:47]
v_mfma_f32_16x16x32_bf16 v[64:67], v[176:179], v[168:171], v[64:67]
v_mfma_f32_16x16x32_bf16 v[84:87], v[176:179], v[172:175], v[84:87]
s_waitcnt lgkmcnt(0)
s_barrier
ds_read_b64_tr_b16 v[128:129], v9 offset:16384
ds_read_b64_tr_b16 v[130:131], v9 offset:17664
v_mfma_f32_16x16x32_bf16 v[28:31], v[180:183], v[160:163], v[28:31]
ds_read_b128 v[112:115], v5 offset:0
v_mfma_f32_16x16x32_bf16 v[48:51], v[180:183], v[164:167], v[48:51]
ds_read_b128 v[116:119], v5 offset:2048
v_mfma_f32_16x16x32_bf16 v[68:71], v[180:183], v[168:171], v[68:71]
ds_read_b128 v[120:123], v5 offset:4096
v_mfma_f32_16x16x32_bf16 v[88:91], v[180:183], v[172:175], v[88:91]
ds_read_b128 v[124:127], v5 offset:6144
v_mfma_f32_16x16x32_bf16 v[32:35], v[184:187], v[160:163], v[32:35]
ds_read_b64_tr_b16 v[132:133], v9 offset:16392
v_mfma_f32_16x16x32_bf16 v[52:55], v[184:187], v[164:167], v[52:55]
ds_read_b64_tr_b16 v[134:135], v9 offset:17672
v_mfma_f32_16x16x32_bf16 v[72:75], v[184:187], v[168:171], v[72:75]
ds_read_b64_tr_b16 v[136:137], v9 offset:16400
v_mfma_f32_16x16x32_bf16 v[92:95], v[184:187], v[172:175], v[92:95]
ds_read_b64_tr_b16 v[138:139], v9 offset:17680
v_mfma_f32_16x16x32_bf16 v[36:39], v[188:191], v[160:163], v[36:39]
ds_read_b64_tr_b16 v[140:141], v9 offset:16408
v_mfma_f32_16x16x32_bf16 v[56:59], v[188:191], v[164:167], v[56:59]
ds_read_b64_tr_b16 v[142:143], v9 offset:17688
v_mfma_f32_16x16x32_bf16 v[76:79], v[188:191], v[168:171], v[76:79]
ds_read_b64_tr_b16 v[144:145], v9 offset:16416
v_mfma_f32_16x16x32_bf16 v[96:99], v[188:191], v[172:175], v[96:99]
ds_read_b64_tr_b16 v[146:147], v9 offset:17696
v_mfma_f32_16x16x32_bf16 v[40:43], v[192:195], v[160:163], v[40:43]
s_waitcnt lgkmcnt(8)
v_mfma_f32_16x16x32_bf16 v[60:63], v[192:195], v[164:167], v[60:63]
ds_read_b128 v[148:151], v11 offset:0
v_mfma_f32_16x16x32_bf16 v[80:83], v[192:195], v[168:171], v[80:83]
ds_read_b64_tr_b16 v[152:153], v15 offset:0
v_mfma_f32_16x16x32_bf16 v[100:103], v[192:195], v[172:175], v[100:103]
ds_read_b64_tr_b16 v[154:155], v15 offset:160
v_mfma_f32_16x16x32_bf16 v[104:107], v[200:203], v[196:199], v[104:107]
ds_read_b64_tr_b16 v[156:157], v15 offset:8
v_mfma_f32_16x16x32_bf16 v[108:111], v[204:207], v[196:199], v[108:111]
ds_read_b64_tr_b16 v[158:159], v15 offset:168
s_waitcnt lgkmcnt(13)
v_mfma_f32_16x16x32_bf16 v[24:27], v[128:131], v[112:115], v[24:27]
v_mfma_f32_16x16x32_bf16 v[44:47], v[128:131], v[116:119], v[44:47]
v_mfma_f32_16x16x32_bf16 v[64:67], v[128:131], v[120:123], v[64:67]
v_mfma_f32_16x16x32_bf16 v[84:87], v[128:131], v[124:127], v[84:87]
s_waitcnt lgkmcnt(0)
ds_read_b64_tr_b16 v[176:177], v9 offset:21504
ds_read_b64_tr_b16 v[178:179], v9 offset:22784
v_mfma_f32_16x16x32_bf16 v[28:31], v[132:135], v[112:115], v[28:31]
ds_read_b128 v[160:163], v6 offset:0
v_mfma_f32_16x16x32_bf16 v[48:51], v[132:135], v[116:119], v[48:51]
ds_read_b128 v[164:167], v6 offset:2048
v_mfma_f32_16x16x32_bf16 v[68:71], v[132:135], v[120:123], v[68:71]
ds_read_b128 v[168:171], v6 offset:4096
v_mfma_f32_16x16x32_bf16 v[88:91], v[132:135], v[124:127], v[88:91]
ds_read_b128 v[172:175], v6 offset:6144
v_mfma_f32_16x16x32_bf16 v[32:35], v[136:139], v[112:115], v[32:35]
ds_read_b64_tr_b16 v[180:181], v9 offset:21512
v_mfma_f32_16x16x32_bf16 v[52:55], v[136:139], v[116:119], v[52:55]
ds_read_b64_tr_b16 v[182:183], v9 offset:22792
v_mfma_f32_16x16x32_bf16 v[72:75], v[136:139], v[120:123], v[72:75]
ds_read_b64_tr_b16 v[184:185], v9 offset:21520
v_mfma_f32_16x16x32_bf16 v[92:95], v[136:139], v[124:127], v[92:95]
ds_read_b64_tr_b16 v[186:187], v9 offset:22800
v_mfma_f32_16x16x32_bf16 v[36:39], v[140:143], v[112:115], v[36:39]
ds_read_b64_tr_b16 v[188:189], v9 offset:21528
v_mfma_f32_16x16x32_bf16 v[56:59], v[140:143], v[116:119], v[56:59]
ds_read_b64_tr_b16 v[190:191], v9 offset:22808
v_mfma_f32_16x16x32_bf16 v[76:79], v[140:143], v[120:123], v[76:79]
ds_read_b64_tr_b16 v[192:193], v9 offset:21536
v_mfma_f32_16x16x32_bf16 v[96:99], v[140:143], v[124:127], v[96:99]
ds_read_b64_tr_b16 v[194:195], v9 offset:22816
v_mfma_f32_16x16x32_bf16 v[40:43], v[144:147], v[112:115], v[40:43]
s_waitcnt lgkmcnt(8)
v_mfma_f32_16x16x32_bf16 v[60:63], v[144:147], v[116:119], v[60:63]
ds_read_b128 v[196:199], v12 offset:0
v_mfma_f32_16x16x32_bf16 v[80:83], v[144:147], v[120:123], v[80:83]
ds_read_b64_tr_b16 v[200:201], v15 offset:1280
v_mfma_f32_16x16x32_bf16 v[100:103], v[144:147], v[124:127], v[100:103]
ds_read_b64_tr_b16 v[202:203], v15 offset:1440
v_mfma_f32_16x16x32_bf16 v[104:107], v[152:155], v[148:151], v[104:107]
ds_read_b64_tr_b16 v[204:205], v15 offset:1288
v_mfma_f32_16x16x32_bf16 v[108:111], v[156:159], v[148:151], v[108:111]
ds_read_b64_tr_b16 v[206:207], v15 offset:1448
s_waitcnt lgkmcnt(13)
v_mfma_f32_16x16x32_bf16 v[24:27], v[176:179], v[160:163], v[24:27]
v_mfma_f32_16x16x32_bf16 v[44:47], v[176:179], v[164:167], v[44:47]
v_mfma_f32_16x16x32_bf16 v[64:67], v[176:179], v[168:171], v[64:67]
v_mfma_f32_16x16x32_bf16 v[84:87], v[176:179], v[172:175], v[84:87]
s_waitcnt lgkmcnt(0)
s_barrier
ds_read_b64_tr_b16 v[128:129], v9 offset:57344
ds_read_b64_tr_b16 v[130:131], v9 offset:58624
v_mfma_f32_16x16x32_bf16 v[28:31], v[180:183], v[160:163], v[28:31]
ds_read_b128 v[112:115], v5 offset:40960
v_mfma_f32_16x16x32_bf16 v[48:51], v[180:183], v[164:167], v[48:51]
ds_read_b128 v[116:119], v5 offset:43008
v_mfma_f32_16x16x32_bf16 v[68:71], v[180:183], v[168:171], v[68:71]
ds_read_b128 v[120:123], v5 offset:45056
v_mfma_f32_16x16x32_bf16 v[88:91], v[180:183], v[172:175], v[88:91]
ds_read_b128 v[124:127], v5 offset:47104
v_mfma_f32_16x16x32_bf16 v[32:35], v[184:187], v[160:163], v[32:35]
ds_read_b64_tr_b16 v[132:133], v9 offset:57352
v_mfma_f32_16x16x32_bf16 v[52:55], v[184:187], v[164:167], v[52:55]
ds_read_b64_tr_b16 v[134:135], v9 offset:58632
v_mfma_f32_16x16x32_bf16 v[72:75], v[184:187], v[168:171], v[72:75]
ds_read_b64_tr_b16 v[136:137], v9 offset:57360
v_mfma_f32_16x16x32_bf16 v[92:95], v[184:187], v[172:175], v[92:95]
ds_read_b64_tr_b16 v[138:139], v9 offset:58640
v_mfma_f32_16x16x32_bf16 v[36:39], v[188:191], v[160:163], v[36:39]
ds_read_b64_tr_b16 v[140:141], v9 offset:57368
v_mfma_f32_16x16x32_bf16 v[56:59], v[188:191], v[164:167], v[56:59]
ds_read_b64_tr_b16 v[142:143], v9 offset:58648
v_mfma_f32_16x16x32_bf16 v[76:79], v[188:191], v[168:171], v[76:79]
ds_read_b64_tr_b16 v[144:145], v9 offset:57376
v_mfma_f32_16x16x32_bf16 v[96:99], v[188:191], v[172:175], v[96:99]
ds_read_b64_tr_b16 v[146:147], v9 offset:58656
v_mfma_f32_16x16x32_bf16 v[40:43], v[192:195], v[160:163], v[40:43]
s_waitcnt lgkmcnt(8)
v_mfma_f32_16x16x32_bf16 v[60:63], v[192:195], v[164:167], v[60:63]
ds_read_b128 v[148:151], v11 offset:40960
v_mfma_f32_16x16x32_bf16 v[80:83], v[192:195], v[168:171], v[80:83]
ds_read_b64_tr_b16 v[152:153], v15 offset:40960
v_mfma_f32_16x16x32_bf16 v[100:103], v[192:195], v[172:175], v[100:103]
ds_read_b64_tr_b16 v[154:155], v15 offset:41120
v_mfma_f32_16x16x32_bf16 v[104:107], v[200:203], v[196:199], v[104:107]
ds_read_b64_tr_b16 v[156:157], v15 offset:40968
v_mfma_f32_16x16x32_bf16 v[108:111], v[204:207], v[196:199], v[108:111]
ds_read_b64_tr_b16 v[158:159], v15 offset:41128
s_waitcnt lgkmcnt(13)
v_mfma_f32_16x16x32_bf16 v[24:27], v[128:131], v[112:115], v[24:27]
v_mfma_f32_16x16x32_bf16 v[44:47], v[128:131], v[116:119], v[44:47]
v_mfma_f32_16x16x32_bf16 v[64:67], v[128:131], v[120:123], v[64:67]
v_mfma_f32_16x16x32_bf16 v[84:87], v[128:131], v[124:127], v[84:87]
s_waitcnt lgkmcnt(0)
ds_read_b64_tr_b16 v[176:177], v9 offset:62464
ds_read_b64_tr_b16 v[178:179], v9 offset:63744
v_mfma_f32_16x16x32_bf16 v[28:31], v[132:135], v[112:115], v[28:31]
ds_read_b128 v[160:163], v6 offset:40960
v_mfma_f32_16x16x32_bf16 v[48:51], v[132:135], v[116:119], v[48:51]
ds_read_b128 v[164:167], v6 offset:43008
v_mfma_f32_16x16x32_bf16 v[68:71], v[132:135], v[120:123], v[68:71]
ds_read_b128 v[168:171], v6 offset:45056
v_mfma_f32_16x16x32_bf16 v[88:91], v[132:135], v[124:127], v[88:91]
ds_read_b128 v[172:175], v6 offset:47104
v_mfma_f32_16x16x32_bf16 v[32:35], v[136:139], v[112:115], v[32:35]
ds_read_b64_tr_b16 v[180:181], v9 offset:62472
v_mfma_f32_16x16x32_bf16 v[52:55], v[136:139], v[116:119], v[52:55]
ds_read_b64_tr_b16 v[182:183], v9 offset:63752
v_mfma_f32_16x16x32_bf16 v[72:75], v[136:139], v[120:123], v[72:75]
ds_read_b64_tr_b16 v[184:185], v9 offset:62480
v_mfma_f32_16x16x32_bf16 v[92:95], v[136:139], v[124:127], v[92:95]
ds_read_b64_tr_b16 v[186:187], v9 offset:63760
v_mfma_f32_16x16x32_bf16 v[36:39], v[140:143], v[112:115], v[36:39]
ds_read_b64_tr_b16 v[188:189], v9 offset:62488
v_mfma_f32_16x16x32_bf16 v[56:59], v[140:143], v[116:119], v[56:59]
ds_read_b64_tr_b16 v[190:191], v9 offset:63768
v_mfma_f32_16x16x32_bf16 v[76:79], v[140:143], v[120:123], v[76:79]
ds_read_b64_tr_b16 v[192:193], v9 offset:62496
v_mfma_f32_16x16x32_bf16 v[96:99], v[140:143], v[124:127], v[96:99]
ds_read_b64_tr_b16 v[194:195], v9 offset:63776
v_mfma_f32_16x16x32_bf16 v[40:43], v[144:147], v[112:115], v[40:43]
s_waitcnt lgkmcnt(8)
v_mfma_f32_16x16x32_bf16 v[60:63], v[144:147], v[116:119], v[60:63]
ds_read_b128 v[196:199], v12 offset:40960
v_mfma_f32_16x16x32_bf16 v[80:83], v[144:147], v[120:123], v[80:83]
ds_read_b64_tr_b16 v[200:201], v15 offset:42240
v_mfma_f32_16x16x32_bf16 v[100:103], v[144:147], v[124:127], v[100:103]
ds_read_b64_tr_b16 v[202:203], v15 offset:42400
v_mfma_f32_16x16x32_bf16 v[104:107], v[152:155], v[148:151], v[104:107]
ds_read_b64_tr_b16 v[204:205], v15 offset:42248
v_mfma_f32_16x16x32_bf16 v[108:111], v[156:159], v[148:151], v[108:111]
ds_read_b64_tr_b16 v[206:207], v15 offset:42408
s_waitcnt lgkmcnt(13)
v_mfma_f32_16x16x32_bf16 v[24:27], v[176:179], v[160:163], v[24:27]
v_mfma_f32_16x16x32_bf16 v[44:47], v[176:179], v[164:167], v[44:47]
v_mfma_f32_16x16x32_bf16 v[64:67], v[176:179], v[168:171], v[64:67]
v_mfma_f32_16x16x32_bf16 v[84:87], v[176:179], v[172:175], v[84:87]
s_waitcnt lgkmcnt(0)
s_barrier
ds_read_b64_tr_b16 v[128:129], v10 offset:16384
ds_read_b64_tr_b16 v[130:131], v10 offset:17664
v_mfma_f32_16x16x32_bf16 v[28:31], v[180:183], v[160:163], v[28:31]
ds_read_b128 v[112:115], v7 offset:0
v_mfma_f32_16x16x32_bf16 v[48:51], v[180:183], v[164:167], v[48:51]
ds_read_b128 v[116:119], v7 offset:2048
v_mfma_f32_16x16x32_bf16 v[68:71], v[180:183], v[168:171], v[68:71]
ds_read_b128 v[120:123], v7 offset:4096
v_mfma_f32_16x16x32_bf16 v[88:91], v[180:183], v[172:175], v[88:91]
ds_read_b128 v[124:127], v7 offset:6144
v_mfma_f32_16x16x32_bf16 v[32:35], v[184:187], v[160:163], v[32:35]
ds_read_b64_tr_b16 v[132:133], v10 offset:16392
v_mfma_f32_16x16x32_bf16 v[52:55], v[184:187], v[164:167], v[52:55]
ds_read_b64_tr_b16 v[134:135], v10 offset:17672
v_mfma_f32_16x16x32_bf16 v[72:75], v[184:187], v[168:171], v[72:75]
ds_read_b64_tr_b16 v[136:137], v10 offset:16400
v_mfma_f32_16x16x32_bf16 v[92:95], v[184:187], v[172:175], v[92:95]
ds_read_b64_tr_b16 v[138:139], v10 offset:17680
v_mfma_f32_16x16x32_bf16 v[36:39], v[188:191], v[160:163], v[36:39]
ds_read_b64_tr_b16 v[140:141], v10 offset:16408
v_mfma_f32_16x16x32_bf16 v[56:59], v[188:191], v[164:167], v[56:59]
ds_read_b64_tr_b16 v[142:143], v10 offset:17688
v_mfma_f32_16x16x32_bf16 v[76:79], v[188:191], v[168:171], v[76:79]
ds_read_b64_tr_b16 v[144:145], v10 offset:16416
v_mfma_f32_16x16x32_bf16 v[96:99], v[188:191], v[172:175], v[96:99]
ds_read_b64_tr_b16 v[146:147], v10 offset:17696
v_mfma_f32_16x16x32_bf16 v[40:43], v[192:195], v[160:163], v[40:43]
s_waitcnt lgkmcnt(8)
v_mfma_f32_16x16x32_bf16 v[60:63], v[192:195], v[164:167], v[60:63]
ds_read_b128 v[148:151], v13 offset:0
v_mfma_f32_16x16x32_bf16 v[80:83], v[192:195], v[168:171], v[80:83]
ds_read_b64_tr_b16 v[152:153], v16 offset:0
v_mfma_f32_16x16x32_bf16 v[100:103], v[192:195], v[172:175], v[100:103]
ds_read_b64_tr_b16 v[154:155], v16 offset:160
v_mfma_f32_16x16x32_bf16 v[104:107], v[200:203], v[196:199], v[104:107]
ds_read_b64_tr_b16 v[156:157], v16 offset:8
v_mfma_f32_16x16x32_bf16 v[108:111], v[204:207], v[196:199], v[108:111]
ds_read_b64_tr_b16 v[158:159], v16 offset:168
s_waitcnt lgkmcnt(13)
v_mfma_f32_16x16x32_bf16 v[24:27], v[128:131], v[112:115], v[24:27]
v_mfma_f32_16x16x32_bf16 v[44:47], v[128:131], v[116:119], v[44:47]
v_mfma_f32_16x16x32_bf16 v[64:67], v[128:131], v[120:123], v[64:67]
v_mfma_f32_16x16x32_bf16 v[84:87], v[128:131], v[124:127], v[84:87]
s_waitcnt lgkmcnt(0)
ds_read_b64_tr_b16 v[176:177], v10 offset:21504
ds_read_b64_tr_b16 v[178:179], v10 offset:22784
v_mfma_f32_16x16x32_bf16 v[28:31], v[132:135], v[112:115], v[28:31]
ds_read_b128 v[160:163], v8 offset:0
v_mfma_f32_16x16x32_bf16 v[48:51], v[132:135], v[116:119], v[48:51]
ds_read_b128 v[164:167], v8 offset:2048
v_mfma_f32_16x16x32_bf16 v[68:71], v[132:135], v[120:123], v[68:71]
ds_read_b128 v[168:171], v8 offset:4096
v_mfma_f32_16x16x32_bf16 v[88:91], v[132:135], v[124:127], v[88:91]
ds_read_b128 v[172:175], v8 offset:6144
v_mfma_f32_16x16x32_bf16 v[32:35], v[136:139], v[112:115], v[32:35]
ds_read_b64_tr_b16 v[180:181], v10 offset:21512
v_mfma_f32_16x16x32_bf16 v[52:55], v[136:139], v[116:119], v[52:55]
ds_read_b64_tr_b16 v[182:183], v10 offset:22792
v_mfma_f32_16x16x32_bf16 v[72:75], v[136:139], v[120:123], v[72:75]
ds_read_b64_tr_b16 v[184:185], v10 offset:21520
v_mfma_f32_16x16x32_bf16 v[92:95], v[136:139], v[124:127], v[92:95]
ds_read_b64_tr_b16 v[186:187], v10 offset:22800
v_mfma_f32_16x16x32_bf16 v[36:39], v[140:143], v[112:115], v[36:39]
ds_read_b64_tr_b16 v[188:189], v10 offset:21528
v_mfma_f32_16x16x32_bf16 v[56:59], v[140:143], v[116:119], v[56:59]
ds_read_b64_tr_b16 v[190:191], v10 offset:22808
v_mfma_f32_16x16x32_bf16 v[76:79], v[140:143], v[120:123], v[76:79]
ds_read_b64_tr_b16 v[192:193], v10 offset:21536
v_mfma_f32_16x16x32_bf16 v[96:99], v[140:143], v[124:127], v[96:99]
ds_read_b64_tr_b16 v[194:195], v10 offset:22816
v_mfma_f32_16x16x32_bf16 v[40:43], v[144:147], v[112:115], v[40:43]
s_waitcnt lgkmcnt(8)
v_mfma_f32_16x16x32_bf16 v[60:63], v[144:147], v[116:119], v[60:63]
ds_read_b128 v[196:199], v14 offset:0
v_mfma_f32_16x16x32_bf16 v[80:83], v[144:147], v[120:123], v[80:83]
ds_read_b64_tr_b16 v[200:201], v16 offset:1280
v_mfma_f32_16x16x32_bf16 v[100:103], v[144:147], v[124:127], v[100:103]
ds_read_b64_tr_b16 v[202:203], v16 offset:1440
v_mfma_f32_16x16x32_bf16 v[104:107], v[152:155], v[148:151], v[104:107]
ds_read_b64_tr_b16 v[204:205], v16 offset:1288
v_mfma_f32_16x16x32_bf16 v[108:111], v[156:159], v[148:151], v[108:111]
ds_read_b64_tr_b16 v[206:207], v16 offset:1448
s_waitcnt lgkmcnt(13)
v_mfma_f32_16x16x32_bf16 v[24:27], v[176:179], v[160:163], v[24:27]
v_mfma_f32_16x16x32_bf16 v[44:47], v[176:179], v[164:167], v[44:47]
v_mfma_f32_16x16x32_bf16 v[64:67], v[176:179], v[168:171], v[64:67]
v_mfma_f32_16x16x32_bf16 v[84:87], v[176:179], v[172:175], v[84:87]
s_waitcnt lgkmcnt(0)
s_barrier
ds_read_b64_tr_b16 v[128:129], v10 offset:57344
ds_read_b64_tr_b16 v[130:131], v10 offset:58624
v_mfma_f32_16x16x32_bf16 v[28:31], v[180:183], v[160:163], v[28:31]
ds_read_b128 v[112:115], v7 offset:40960
v_mfma_f32_16x16x32_bf16 v[48:51], v[180:183], v[164:167], v[48:51]
ds_read_b128 v[116:119], v7 offset:43008
v_mfma_f32_16x16x32_bf16 v[68:71], v[180:183], v[168:171], v[68:71]
ds_read_b128 v[120:123], v7 offset:45056
v_mfma_f32_16x16x32_bf16 v[88:91], v[180:183], v[172:175], v[88:91]
ds_read_b128 v[124:127], v7 offset:47104
v_mfma_f32_16x16x32_bf16 v[32:35], v[184:187], v[160:163], v[32:35]
ds_read_b64_tr_b16 v[132:133], v10 offset:57352
v_mfma_f32_16x16x32_bf16 v[52:55], v[184:187], v[164:167], v[52:55]
ds_read_b64_tr_b16 v[134:135], v10 offset:58632
v_mfma_f32_16x16x32_bf16 v[72:75], v[184:187], v[168:171], v[72:75]
ds_read_b64_tr_b16 v[136:137], v10 offset:57360
v_mfma_f32_16x16x32_bf16 v[92:95], v[184:187], v[172:175], v[92:95]
ds_read_b64_tr_b16 v[138:139], v10 offset:58640
v_mfma_f32_16x16x32_bf16 v[36:39], v[188:191], v[160:163], v[36:39]
ds_read_b64_tr_b16 v[140:141], v10 offset:57368
v_mfma_f32_16x16x32_bf16 v[56:59], v[188:191], v[164:167], v[56:59]
ds_read_b64_tr_b16 v[142:143], v10 offset:58648
v_mfma_f32_16x16x32_bf16 v[76:79], v[188:191], v[168:171], v[76:79]
ds_read_b64_tr_b16 v[144:145], v10 offset:57376
v_mfma_f32_16x16x32_bf16 v[96:99], v[188:191], v[172:175], v[96:99]
ds_read_b64_tr_b16 v[146:147], v10 offset:58656
v_mfma_f32_16x16x32_bf16 v[40:43], v[192:195], v[160:163], v[40:43]
s_waitcnt lgkmcnt(8)
v_mfma_f32_16x16x32_bf16 v[60:63], v[192:195], v[164:167], v[60:63]
ds_read_b128 v[148:151], v13 offset:40960
v_mfma_f32_16x16x32_bf16 v[80:83], v[192:195], v[168:171], v[80:83]
ds_read_b64_tr_b16 v[152:153], v16 offset:40960
v_mfma_f32_16x16x32_bf16 v[100:103], v[192:195], v[172:175], v[100:103]
ds_read_b64_tr_b16 v[154:155], v16 offset:41120
v_mfma_f32_16x16x32_bf16 v[104:107], v[200:203], v[196:199], v[104:107]
ds_read_b64_tr_b16 v[156:157], v16 offset:40968
v_mfma_f32_16x16x32_bf16 v[108:111], v[204:207], v[196:199], v[108:111]
ds_read_b64_tr_b16 v[158:159], v16 offset:41128
s_waitcnt lgkmcnt(13)
v_mfma_f32_16x16x32_bf16 v[24:27], v[128:131], v[112:115], v[24:27]
v_mfma_f32_16x16x32_bf16 v[44:47], v[128:131], v[116:119], v[44:47]
v_mfma_f32_16x16x32_bf16 v[64:67], v[128:131], v[120:123], v[64:67]
v_mfma_f32_16x16x32_bf16 v[84:87], v[128:131], v[124:127], v[84:87]
s_waitcnt lgkmcnt(0)
ds_read_b64_tr_b16 v[176:177], v10 offset:62464
ds_read_b64_tr_b16 v[178:179], v10 offset:63744
v_mfma_f32_16x16x32_bf16 v[28:31], v[132:135], v[112:115], v[28:31]
ds_read_b128 v[160:163], v8 offset:40960
v_mfma_f32_16x16x32_bf16 v[48:51], v[132:135], v[116:119], v[48:51]
ds_read_b128 v[164:167], v8 offset:43008
v_mfma_f32_16x16x32_bf16 v[68:71], v[132:135], v[120:123], v[68:71]
ds_read_b128 v[168:171], v8 offset:45056
v_mfma_f32_16x16x32_bf16 v[88:91], v[132:135], v[124:127], v[88:91]
ds_read_b128 v[172:175], v8 offset:47104
v_mfma_f32_16x16x32_bf16 v[32:35], v[136:139], v[112:115], v[32:35]
ds_read_b64_tr_b16 v[180:181], v10 offset:62472
v_mfma_f32_16x16x32_bf16 v[52:55], v[136:139], v[116:119], v[52:55]
ds_read_b64_tr_b16 v[182:183], v10 offset:63752
v_mfma_f32_16x16x32_bf16 v[72:75], v[136:139], v[120:123], v[72:75]
ds_read_b64_tr_b16 v[184:185], v10 offset:62480
v_mfma_f32_16x16x32_bf16 v[92:95], v[136:139], v[124:127], v[92:95]
ds_read_b64_tr_b16 v[186:187], v10 offset:63760
v_mfma_f32_16x16x32_bf16 v[36:39], v[140:143], v[112:115], v[36:39]
ds_read_b64_tr_b16 v[188:189], v10 offset:62488
v_mfma_f32_16x16x32_bf16 v[56:59], v[140:143], v[116:119], v[56:59]
ds_read_b64_tr_b16 v[190:191], v10 offset:63768
v_mfma_f32_16x16x32_bf16 v[76:79], v[140:143], v[120:123], v[76:79]
ds_read_b64_tr_b16 v[192:193], v10 offset:62496
v_mfma_f32_16x16x32_bf16 v[96:99], v[140:143], v[124:127], v[96:99]
ds_read_b64_tr_b16 v[194:195], v10 offset:63776
v_mfma_f32_16x16x32_bf16 v[40:43], v[144:147], v[112:115], v[40:43]
s_waitcnt lgkmcnt(8)
v_mfma_f32_16x16x32_bf16 v[60:63], v[144:147], v[116:119], v[60:63]
ds_read_b128 v[196:199], v14 offset:40960
v_mfma_f32_16x16x32_bf16 v[80:83], v[144:147], v[120:123], v[80:83]
ds_read_b64_tr_b16 v[200:201], v16 offset:42240
v_mfma_f32_16x16x32_bf16 v[100:103], v[144:147], v[124:127], v[100:103]
ds_read_b64_tr_b16 v[202:203], v16 offset:42400
v_mfma_f32_16x16x32_bf16 v[104:107], v[152:155], v[148:151], v[104:107]
ds_read_b64_tr_b16 v[204:205], v16 offset:42248
v_mfma_f32_16x16x32_bf16 v[108:111], v[156:159], v[148:151], v[108:111]
ds_read_b64_tr_b16 v[206:207], v16 offset:42408
s_waitcnt lgkmcnt(13)
v_mfma_f32_16x16x32_bf16 v[24:27], v[176:179], v[160:163], v[24:27]
v_mfma_f32_16x16x32_bf16 v[44:47], v[176:179], v[164:167], v[44:47]
v_mfma_f32_16x16x32_bf16 v[64:67], v[176:179], v[168:171], v[64:67]
v_mfma_f32_16x16x32_bf16 v[84:87], v[176:179], v[172:175], v[84:87]
s_waitcnt lgkmcnt(0)
s_barrier
ds_read_b64_tr_b16 v[128:129], v9 offset:16384
ds_read_b64_tr_b16 v[130:131], v9 offset:17664
v_mfma_f32_16x16x32_bf16 v[28:31], v[180:183], v[160:163], v[28:31]
ds_read_b128 v[112:115], v5 offset:0
v_mfma_f32_16x16x32_bf16 v[48:51], v[180:183], v[164:167], v[48:51]
ds_read_b128 v[116:119], v5 offset:2048
v_mfma_f32_16x16x32_bf16 v[68:71], v[180:183], v[168:171], v[68:71]
ds_read_b128 v[120:123], v5 offset:4096
v_mfma_f32_16x16x32_bf16 v[88:91], v[180:183], v[172:175], v[88:91]
ds_read_b128 v[124:127], v5 offset:6144
v_mfma_f32_16x16x32_bf16 v[32:35], v[184:187], v[160:163], v[32:35]
ds_read_b64_tr_b16 v[132:133], v9 offset:16392
v_mfma_f32_16x16x32_bf16 v[52:55], v[184:187], v[164:167], v[52:55]
ds_read_b64_tr_b16 v[134:135], v9 offset:17672
v_mfma_f32_16x16x32_bf16 v[72:75], v[184:187], v[168:171], v[72:75]
ds_read_b64_tr_b16 v[136:137], v9 offset:16400
v_mfma_f32_16x16x32_bf16 v[92:95], v[184:187], v[172:175], v[92:95]
ds_read_b64_tr_b16 v[138:139], v9 offset:17680
v_mfma_f32_16x16x32_bf16 v[36:39], v[188:191], v[160:163], v[36:39]
ds_read_b64_tr_b16 v[140:141], v9 offset:16408
v_mfma_f32_16x16x32_bf16 v[56:59], v[188:191], v[164:167], v[56:59]
ds_read_b64_tr_b16 v[142:143], v9 offset:17688
v_mfma_f32_16x16x32_bf16 v[76:79], v[188:191], v[168:171], v[76:79]
ds_read_b64_tr_b16 v[144:145], v9 offset:16416
v_mfma_f32_16x16x32_bf16 v[96:99], v[188:191], v[172:175], v[96:99]
ds_read_b64_tr_b16 v[146:147], v9 offset:17696
v_mfma_f32_16x16x32_bf16 v[40:43], v[192:195], v[160:163], v[40:43]
s_waitcnt lgkmcnt(8)
v_mfma_f32_16x16x32_bf16 v[60:63], v[192:195], v[164:167], v[60:63]
ds_read_b128 v[148:151], v11 offset:0
v_mfma_f32_16x16x32_bf16 v[80:83], v[192:195], v[168:171], v[80:83]
ds_read_b64_tr_b16 v[152:153], v15 offset:0
v_mfma_f32_16x16x32_bf16 v[100:103], v[192:195], v[172:175], v[100:103]
ds_read_b64_tr_b16 v[154:155], v15 offset:160
v_mfma_f32_16x16x32_bf16 v[104:107], v[200:203], v[196:199], v[104:107]
ds_read_b64_tr_b16 v[156:157], v15 offset:8
v_mfma_f32_16x16x32_bf16 v[108:111], v[204:207], v[196:199], v[108:111]
ds_read_b64_tr_b16 v[158:159], v15 offset:168
s_waitcnt lgkmcnt(13)
v_mfma_f32_16x16x32_bf16 v[24:27], v[128:131], v[112:115], v[24:27]
v_mfma_f32_16x16x32_bf16 v[44:47], v[128:131], v[116:119], v[44:47]
v_mfma_f32_16x16x32_bf16 v[64:67], v[128:131], v[120:123], v[64:67]
v_mfma_f32_16x16x32_bf16 v[84:87], v[128:131], v[124:127], v[84:87]
s_waitcnt lgkmcnt(0)
ds_read_b64_tr_b16 v[176:177], v9 offset:21504
ds_read_b64_tr_b16 v[178:179], v9 offset:22784
v_mfma_f32_16x16x32_bf16 v[28:31], v[132:135], v[112:115], v[28:31]
ds_read_b128 v[160:163], v6 offset:0
v_mfma_f32_16x16x32_bf16 v[48:51], v[132:135], v[116:119], v[48:51]
ds_read_b128 v[164:167], v6 offset:2048
v_mfma_f32_16x16x32_bf16 v[68:71], v[132:135], v[120:123], v[68:71]
ds_read_b128 v[168:171], v6 offset:4096
v_mfma_f32_16x16x32_bf16 v[88:91], v[132:135], v[124:127], v[88:91]
ds_read_b128 v[172:175], v6 offset:6144
v_mfma_f32_16x16x32_bf16 v[32:35], v[136:139], v[112:115], v[32:35]
ds_read_b64_tr_b16 v[180:181], v9 offset:21512
v_mfma_f32_16x16x32_bf16 v[52:55], v[136:139], v[116:119], v[52:55]
ds_read_b64_tr_b16 v[182:183], v9 offset:22792
v_mfma_f32_16x16x32_bf16 v[72:75], v[136:139], v[120:123], v[72:75]
ds_read_b64_tr_b16 v[184:185], v9 offset:21520
v_mfma_f32_16x16x32_bf16 v[92:95], v[136:139], v[124:127], v[92:95]
ds_read_b64_tr_b16 v[186:187], v9 offset:22800
v_mfma_f32_16x16x32_bf16 v[36:39], v[140:143], v[112:115], v[36:39]
ds_read_b64_tr_b16 v[188:189], v9 offset:21528
v_mfma_f32_16x16x32_bf16 v[56:59], v[140:143], v[116:119], v[56:59]
ds_read_b64_tr_b16 v[190:191], v9 offset:22808
v_mfma_f32_16x16x32_bf16 v[76:79], v[140:143], v[120:123], v[76:79]
ds_read_b64_tr_b16 v[192:193], v9 offset:21536
v_mfma_f32_16x16x32_bf16 v[96:99], v[140:143], v[124:127], v[96:99]
ds_read_b64_tr_b16 v[194:195], v9 offset:22816
v_mfma_f32_16x16x32_bf16 v[40:43], v[144:147], v[112:115], v[40:43]
s_waitcnt lgkmcnt(8)
v_mfma_f32_16x16x32_bf16 v[60:63], v[144:147], v[116:119], v[60:63]
ds_read_b128 v[196:199], v12 offset:0
v_mfma_f32_16x16x32_bf16 v[80:83], v[144:147], v[120:123], v[80:83]
ds_read_b64_tr_b16 v[200:201], v15 offset:1280
v_mfma_f32_16x16x32_bf16 v[100:103], v[144:147], v[124:127], v[100:103]
ds_read_b64_tr_b16 v[202:203], v15 offset:1440
v_mfma_f32_16x16x32_bf16 v[104:107], v[152:155], v[148:151], v[104:107]
ds_read_b64_tr_b16 v[204:205], v15 offset:1288
v_mfma_f32_16x16x32_bf16 v[108:111], v[156:159], v[148:151], v[108:111]
ds_read_b64_tr_b16 v[206:207], v15 offset:1448
s_waitcnt lgkmcnt(13)
v_mfma_f32_16x16x32_bf16 v[24:27], v[176:179], v[160:163], v[24:27]
v_mfma_f32_16x16x32_bf16 v[44:47], v[176:179], v[164:167], v[44:47]
v_mfma_f32_16x16x32_bf16 v[64:67], v[176:179], v[168:171], v[64:67]
v_mfma_f32_16x16x32_bf16 v[84:87], v[176:179], v[172:175], v[84:87]
s_waitcnt lgkmcnt(0)
s_barrier
ds_read_b64_tr_b16 v[128:129], v9 offset:57344
ds_read_b64_tr_b16 v[130:131], v9 offset:58624
v_mfma_f32_16x16x32_bf16 v[28:31], v[180:183], v[160:163], v[28:31]
ds_read_b128 v[112:115], v5 offset:40960
v_mfma_f32_16x16x32_bf16 v[48:51], v[180:183], v[164:167], v[48:51]
ds_read_b128 v[116:119], v5 offset:43008
v_mfma_f32_16x16x32_bf16 v[68:71], v[180:183], v[168:171], v[68:71]
ds_read_b128 v[120:123], v5 offset:45056
v_mfma_f32_16x16x32_bf16 v[88:91], v[180:183], v[172:175], v[88:91]
ds_read_b128 v[124:127], v5 offset:47104
v_mfma_f32_16x16x32_bf16 v[32:35], v[184:187], v[160:163], v[32:35]
ds_read_b64_tr_b16 v[132:133], v9 offset:57352
v_mfma_f32_16x16x32_bf16 v[52:55], v[184:187], v[164:167], v[52:55]
ds_read_b64_tr_b16 v[134:135], v9 offset:58632
v_mfma_f32_16x16x32_bf16 v[72:75], v[184:187], v[168:171], v[72:75]
ds_read_b64_tr_b16 v[136:137], v9 offset:57360
v_mfma_f32_16x16x32_bf16 v[92:95], v[184:187], v[172:175], v[92:95]
ds_read_b64_tr_b16 v[138:139], v9 offset:58640
v_mfma_f32_16x16x32_bf16 v[36:39], v[188:191], v[160:163], v[36:39]
ds_read_b64_tr_b16 v[140:141], v9 offset:57368
v_mfma_f32_16x16x32_bf16 v[56:59], v[188:191], v[164:167], v[56:59]
ds_read_b64_tr_b16 v[142:143], v9 offset:58648
v_mfma_f32_16x16x32_bf16 v[76:79], v[188:191], v[168:171], v[76:79]
ds_read_b64_tr_b16 v[144:145], v9 offset:57376
v_mfma_f32_16x16x32_bf16 v[96:99], v[188:191], v[172:175], v[96:99]
ds_read_b64_tr_b16 v[146:147], v9 offset:58656
v_mfma_f32_16x16x32_bf16 v[40:43], v[192:195], v[160:163], v[40:43]
s_waitcnt lgkmcnt(8)
v_mfma_f32_16x16x32_bf16 v[60:63], v[192:195], v[164:167], v[60:63]
ds_read_b128 v[148:151], v11 offset:40960
v_mfma_f32_16x16x32_bf16 v[80:83], v[192:195], v[168:171], v[80:83]
ds_read_b64_tr_b16 v[152:153], v15 offset:40960
v_mfma_f32_16x16x32_bf16 v[100:103], v[192:195], v[172:175], v[100:103]
ds_read_b64_tr_b16 v[154:155], v15 offset:41120
v_mfma_f32_16x16x32_bf16 v[104:107], v[200:203], v[196:199], v[104:107]
ds_read_b64_tr_b16 v[156:157], v15 offset:40968
v_mfma_f32_16x16x32_bf16 v[108:111], v[204:207], v[196:199], v[108:111]
ds_read_b64_tr_b16 v[158:159], v15 offset:41128
s_waitcnt lgkmcnt(13)
v_mfma_f32_16x16x32_bf16 v[24:27], v[128:131], v[112:115], v[24:27]
v_mfma_f32_16x16x32_bf16 v[44:47], v[128:131], v[116:119], v[44:47]
v_mfma_f32_16x16x32_bf16 v[64:67], v[128:131], v[120:123], v[64:67]
v_mfma_f32_16x16x32_bf16 v[84:87], v[128:131], v[124:127], v[84:87]
s_waitcnt lgkmcnt(0)
ds_read_b64_tr_b16 v[176:177], v9 offset:62464
ds_read_b64_tr_b16 v[178:179], v9 offset:63744
v_mfma_f32_16x16x32_bf16 v[28:31], v[132:135], v[112:115], v[28:31]
ds_read_b128 v[160:163], v6 offset:40960
v_mfma_f32_16x16x32_bf16 v[48:51], v[132:135], v[116:119], v[48:51]
ds_read_b128 v[164:167], v6 offset:43008
v_mfma_f32_16x16x32_bf16 v[68:71], v[132:135], v[120:123], v[68:71]
ds_read_b128 v[168:171], v6 offset:45056
v_mfma_f32_16x16x32_bf16 v[88:91], v[132:135], v[124:127], v[88:91]
ds_read_b128 v[172:175], v6 offset:47104
v_mfma_f32_16x16x32_bf16 v[32:35], v[136:139], v[112:115], v[32:35]
ds_read_b64_tr_b16 v[180:181], v9 offset:62472
v_mfma_f32_16x16x32_bf16 v[52:55], v[136:139], v[116:119], v[52:55]
ds_read_b64_tr_b16 v[182:183], v9 offset:63752
v_mfma_f32_16x16x32_bf16 v[72:75], v[136:139], v[120:123], v[72:75]
ds_read_b64_tr_b16 v[184:185], v9 offset:62480
v_mfma_f32_16x16x32_bf16 v[92:95], v[136:139], v[124:127], v[92:95]
ds_read_b64_tr_b16 v[186:187], v9 offset:63760
v_mfma_f32_16x16x32_bf16 v[36:39], v[140:143], v[112:115], v[36:39]
ds_read_b64_tr_b16 v[188:189], v9 offset:62488
v_mfma_f32_16x16x32_bf16 v[56:59], v[140:143], v[116:119], v[56:59]
ds_read_b64_tr_b16 v[190:191], v9 offset:63768
v_mfma_f32_16x16x32_bf16 v[76:79], v[140:143], v[120:123], v[76:79]
ds_read_b64_tr_b16 v[192:193], v9 offset:62496
v_mfma_f32_16x16x32_bf16 v[96:99], v[140:143], v[124:127], v[96:99]
ds_read_b64_tr_b16 v[194:195], v9 offset:63776
v_mfma_f32_16x16x32_bf16 v[40:43], v[144:147], v[112:115], v[40:43]
s_waitcnt lgkmcnt(8)
v_mfma_f32_16x16x32_bf16 v[60:63], v[144:147], v[116:119], v[60:63]
ds_read_b128 v[196:199], v12 offset:40960
v_mfma_f32_16x16x32_bf16 v[80:83], v[144:147], v[120:123], v[80:83]
ds_read_b64_tr_b16 v[200:201], v15 offset:42240
v_mfma_f32_16x16x32_bf16 v[100:103], v[144:147], v[124:127], v[100:103]
ds_read_b64_tr_b16 v[202:203], v15 offset:42400
v_mfma_f32_16x16x32_bf16 v[104:107], v[152:155], v[148:151], v[104:107]
ds_read_b64_tr_b16 v[204:205], v15 offset:42248
v_mfma_f32_16x16x32_bf16 v[108:111], v[156:159], v[148:151], v[108:111]
ds_read_b64_tr_b16 v[206:207], v15 offset:42408
s_waitcnt lgkmcnt(13)
v_mfma_f32_16x16x32_bf16 v[24:27], v[176:179], v[160:163], v[24:27]
v_mfma_f32_16x16x32_bf16 v[44:47], v[176:179], v[164:167], v[44:47]
v_mfma_f32_16x16x32_bf16 v[64:67], v[176:179], v[168:171], v[64:67]
v_mfma_f32_16x16x32_bf16 v[84:87], v[176:179], v[172:175], v[84:87]
s_waitcnt lgkmcnt(0)
v_mfma_f32_16x16x32_bf16 v[28:31], v[180:183], v[160:163], v[28:31]
v_mfma_f32_16x16x32_bf16 v[48:51], v[180:183], v[164:167], v[48:51]
v_mfma_f32_16x16x32_bf16 v[68:71], v[180:183], v[168:171], v[68:71]
v_mfma_f32_16x16x32_bf16 v[88:91], v[180:183], v[172:175], v[88:91]
v_mfma_f32_16x16x32_bf16 v[32:35], v[184:187], v[160:163], v[32:35]
v_mfma_f32_16x16x32_bf16 v[52:55], v[184:187], v[164:167], v[52:55]
v_mfma_f32_16x16x32_bf16 v[72:75], v[184:187], v[168:171], v[72:75]
v_mfma_f32_16x16x32_bf16 v[92:95], v[184:187], v[172:175], v[92:95]
v_mfma_f32_16x16x32_bf16 v[36:39], v[188:191], v[160:163], v[36:39]
v_mfma_f32_16x16x32_bf16 v[56:59], v[188:191], v[164:167], v[56:59]
v_mfma_f32_16x16x32_bf16 v[76:79], v[188:191], v[168:171], v[76:79]
v_mfma_f32_16x16x32_bf16 v[96:99], v[188:191], v[172:175], v[96:99]
v_mfma_f32_16x16x32_bf16 v[40:43], v[192:195], v[160:163], v[40:43]
v_mfma_f32_16x16x32_bf16 v[60:63], v[192:195], v[164:167], v[60:63]
v_mfma_f32_16x16x32_bf16 v[80:83], v[192:195], v[168:171], v[80:83]
v_mfma_f32_16x16x32_bf16 v[100:103], v[192:195], v[172:175], v[100:103]
v_mfma_f32_16x16x32_bf16 v[104:107], v[200:203], v[196:199], v[104:107]
v_mfma_f32_16x16x32_bf16 v[108:111], v[204:207], v[196:199], v[108:111]
s_cmp_eq_u32 s8, 1
s_cselect_b32 s49, 2, 1
s_mul_i32 s49, s49, 1280
s_mul_i32 s48, s49, 64
s_cselect_b32 s50, 0, 6291456
s_cselect_b32 s52, 1.0, 1051011932
s_mov_b32 s53, s52
s_cmp_eq_u32 s8, 3
s_cselect_b32 s51, 32, 0
s_add_u32 s51, s51, s58
s_mul_i32 s51, s51, s48
s_add_u32 s50, s50, s51
s_mul_i32 s51, s56, s49
s_add_u32 s50, s50, s51
v_mul_lo_u32 v17, v3, s48
v_lshl_add_u32 v18, v2, 4, v17
v_lshl_add_u32 v19, v2, 3, v17
v_pk_mul_f32 v[24:25], v[24:25], s[52:53]
v_pk_mul_f32 v[26:27], v[26:27], s[52:53]
v_pk_mul_f32 v[28:29], v[28:29], s[52:53]
v_pk_mul_f32 v[30:31], v[30:31], s[52:53]
v_pk_mul_f32 v[32:33], v[32:33], s[52:53]
v_pk_mul_f32 v[34:35], v[34:35], s[52:53]
v_pk_mul_f32 v[36:37], v[36:37], s[52:53]
v_pk_mul_f32 v[38:39], v[38:39], s[52:53]
v_pk_mul_f32 v[40:41], v[40:41], s[52:53]
v_pk_mul_f32 v[42:43], v[42:43], s[52:53]
v_cvt_pk_bf16_f32 v24, v24, v25
v_cvt_pk_bf16_f32 v25, v26, v27
v_cvt_pk_bf16_f32 v26, v28, v29
v_cvt_pk_bf16_f32 v27, v30, v31
v_cvt_pk_bf16_f32 v28, v32, v33
v_cvt_pk_bf16_f32 v29, v34, v35
v_cvt_pk_bf16_f32 v30, v36, v37
v_cvt_pk_bf16_f32 v31, v38, v39
v_cvt_pk_bf16_f32 v32, v40, v41
v_cvt_pk_bf16_f32 v33, v42, v43
buffer_store_dwordx4 v[24:27], v18, s[44:47], s50 offen offset:0 sc1
buffer_store_dwordx4 v[28:31], v18, s[44:47], s50 offen offset:512 sc1
buffer_store_dwordx2 v[32:33], v19, s[44:47], s50 offen offset:1024 sc1
v_pk_mul_f32 v[44:45], v[44:45], s[52:53]
v_pk_mul_f32 v[46:47], v[46:47], s[52:53]
v_pk_mul_f32 v[48:49], v[48:49], s[52:53]
v_pk_mul_f32 v[50:51], v[50:51], s[52:53]
v_pk_mul_f32 v[52:53], v[52:53], s[52:53]
v_pk_mul_f32 v[54:55], v[54:55], s[52:53]
v_pk_mul_f32 v[56:57], v[56:57], s[52:53]
v_pk_mul_f32 v[58:59], v[58:59], s[52:53]
v_pk_mul_f32 v[60:61], v[60:61], s[52:53]
v_pk_mul_f32 v[62:63], v[62:63], s[52:53]
v_cvt_pk_bf16_f32 v44, v44, v45
v_cvt_pk_bf16_f32 v45, v46, v47
v_cvt_pk_bf16_f32 v46, v48, v49
v_cvt_pk_bf16_f32 v47, v50, v51
v_cvt_pk_bf16_f32 v48, v52, v53
v_cvt_pk_bf16_f32 v49, v54, v55
v_cvt_pk_bf16_f32 v50, v56, v57
v_cvt_pk_bf16_f32 v51, v58, v59
v_cvt_pk_bf16_f32 v52, v60, v61
v_cvt_pk_bf16_f32 v53, v62, v63
buffer_store_dwordx4 v[44:47], v18, s[44:47], s50 offen offset:256 sc1
buffer_store_dwordx4 v[48:51], v18, s[44:47], s50 offen offset:768 sc1
buffer_store_dwordx2 v[52:53], v19, s[44:47], s50 offen offset:1152 sc1
v_pk_mul_f32 v[64:65], v[64:65], s[52:53]
v_pk_mul_f32 v[66:67], v[66:67], s[52:53]
v_pk_mul_f32 v[68:69], v[68:69], s[52:53]
v_pk_mul_f32 v[70:71], v[70:71], s[52:53]
v_pk_mul_f32 v[72:73], v[72:73], s[52:53]
v_pk_mul_f32 v[74:75], v[74:75], s[52:53]
v_pk_mul_f32 v[76:77], v[76:77], s[52:53]
v_pk_mul_f32 v[78:79], v[78:79], s[52:53]
v_pk_mul_f32 v[80:81], v[80:81], s[52:53]
v_pk_mul_f32 v[82:83], v[82:83], s[52:53]
v_cvt_pk_bf16_f32 v64, v64, v65
v_cvt_pk_bf16_f32 v65, v66, v67
v_cvt_pk_bf16_f32 v66, v68, v69
v_cvt_pk_bf16_f32 v67, v70, v71
v_cvt_pk_bf16_f32 v68, v72, v73
v_cvt_pk_bf16_f32 v69, v74, v75
v_cvt_pk_bf16_f32 v70, v76, v77
v_cvt_pk_bf16_f32 v71, v78, v79
v_cvt_pk_bf16_f32 v72, v80, v81
v_cvt_pk_bf16_f32 v73, v82, v83
s_add_u32 s50, s50, s49
buffer_store_dwordx4 v[64:67], v18, s[44:47], s50 offen offset:0 sc1
buffer_store_dwordx4 v[68:71], v18, s[44:47], s50 offen offset:512 sc1
buffer_store_dwordx2 v[72:73], v19, s[44:47], s50 offen offset:1024 sc1
v_pk_mul_f32 v[84:85], v[84:85], s[52:53]
v_pk_mul_f32 v[86:87], v[86:87], s[52:53]
v_pk_mul_f32 v[88:89], v[88:89], s[52:53]
v_pk_mul_f32 v[90:91], v[90:91], s[52:53]
v_pk_mul_f32 v[92:93], v[92:93], s[52:53]
v_pk_mul_f32 v[94:95], v[94:95], s[52:53]
v_pk_mul_f32 v[96:97], v[96:97], s[52:53]
v_pk_mul_f32 v[98:99], v[98:99], s[52:53]
v_pk_mul_f32 v[100:101], v[100:101], s[52:53]
v_pk_mul_f32 v[102:103], v[102:103], s[52:53]
v_cvt_pk_bf16_f32 v84, v84, v85
v_cvt_pk_bf16_f32 v85, v86, v87
v_cvt_pk_bf16_f32 v86, v88, v89
v_cvt_pk_bf16_f32 v87, v90, v91
v_cvt_pk_bf16_f32 v88, v92, v93
v_cvt_pk_bf16_f32 v89, v94, v95
v_cvt_pk_bf16_f32 v90, v96, v97
v_cvt_pk_bf16_f32 v91, v98, v99
v_cvt_pk_bf16_f32 v92, v100, v101
v_cvt_pk_bf16_f32 v93, v102, v103
buffer_store_dwordx4 v[84:87], v18, s[44:47], s50 offen offset:256 sc1
buffer_store_dwordx4 v[88:91], v18, s[44:47], s50 offen offset:768 sc1
buffer_store_dwordx2 v[92:93], v19, s[44:47], s50 offen offset:1152 sc1
s_lshr_b32 s51, s15, 1
s_add_u32 s51, s51, s56
s_mul_i32 s50, s51, 2560
s_add_u32 s50, s50, 5242880
v_cvt_pk_bf16_f32 v104, v104, v105
v_cvt_pk_bf16_f32 v105, v106, v107
v_cvt_pk_bf16_f32 v106, v108, v109
v_cvt_pk_bf16_f32 v107, v110, v111
s_lshl_b32 s54, s13, 4
v_add_u32 v20, s54, v2
v_lshlrev_b32 v17, 9, v3
v_lshl_add_u32 v17, v20, 4, v17
v_lshlrev_b32 v18, 3, v20
s_mov_b32 s54, -1
s_mov_b32 s55, 0
s_mov_b64 exec, s[54:55]
buffer_store_dwordx4 v[104:107], v17, s[44:47], s50 offen sc1
s_mov_b32 s54, 0
s_mov_b32 s55, 0xffff
s_mov_b64 exec, s[54:55]
buffer_store_dwordx2 v[104:105], v18, s[44:47], s50 offen offset:1024 sc1
s_mov_b64 exec, -1
s_nop 1
s_branch attn
concat_heads__mha_block__grouped_kv_mqa__prompt_kernel_QK0:
s_barrier
ds_read_b64_tr_b16 v[128:129], v9 offset:16384
ds_read_b64_tr_b16 v[130:131], v9 offset:17664
ds_read_b128 v[112:115], v5 offset:0
ds_read_b128 v[116:119], v5 offset:2048
ds_read_b128 v[120:123], v5 offset:4096
ds_read_b128 v[124:127], v5 offset:6144
ds_read_b64_tr_b16 v[132:133], v9 offset:16392
ds_read_b64_tr_b16 v[134:135], v9 offset:17672
ds_read_b64_tr_b16 v[136:137], v9 offset:16400
ds_read_b64_tr_b16 v[138:139], v9 offset:17680
ds_read_b64_tr_b16 v[140:141], v9 offset:16408
ds_read_b64_tr_b16 v[142:143], v9 offset:17688
ds_read_b64_tr_b16 v[144:145], v9 offset:16416
ds_read_b64_tr_b16 v[146:147], v9 offset:17696
s_waitcnt lgkmcnt(0)
v_mfma_f32_16x16x32_bf16 v[24:27], v[128:131], v[112:115], 0
ds_read_b64_tr_b16 v[176:177], v9 offset:21504
v_mfma_f32_16x16x32_bf16 v[44:47], v[128:131], v[116:119], 0
ds_read_b64_tr_b16 v[178:179], v9 offset:22784
v_mfma_f32_16x16x32_bf16 v[64:67], v[128:131], v[120:123], 0
ds_read_b128 v[160:163], v6 offset:0
v_mfma_f32_16x16x32_bf16 v[84:87], v[128:131], v[124:127], 0
ds_read_b128 v[164:167], v6 offset:2048
v_mfma_f32_16x16x32_bf16 v[28:31], v[132:135], v[112:115], 0
ds_read_b128 v[168:171], v6 offset:4096
v_mfma_f32_16x16x32_bf16 v[48:51], v[132:135], v[116:119], 0
ds_read_b128 v[172:175], v6 offset:6144
v_mfma_f32_16x16x32_bf16 v[68:71], v[132:135], v[120:123], 0
ds_read_b64_tr_b16 v[180:181], v9 offset:21512
v_mfma_f32_16x16x32_bf16 v[88:91], v[132:135], v[124:127], 0
ds_read_b64_tr_b16 v[182:183], v9 offset:22792
v_mfma_f32_16x16x32_bf16 v[32:35], v[136:139], v[112:115], 0
ds_read_b64_tr_b16 v[184:185], v9 offset:21520
v_mfma_f32_16x16x32_bf16 v[52:55], v[136:139], v[116:119], 0
ds_read_b64_tr_b16 v[186:187], v9 offset:22800
v_mfma_f32_16x16x32_bf16 v[72:75], v[136:139], v[120:123], 0
ds_read_b64_tr_b16 v[188:189], v9 offset:21528
v_mfma_f32_16x16x32_bf16 v[92:95], v[136:139], v[124:127], 0
ds_read_b64_tr_b16 v[190:191], v9 offset:22808
v_mfma_f32_16x16x32_bf16 v[36:39], v[140:143], v[112:115], 0
ds_read_b64_tr_b16 v[192:193], v9 offset:21536
v_mfma_f32_16x16x32_bf16 v[56:59], v[140:143], v[116:119], 0
ds_read_b64_tr_b16 v[194:195], v9 offset:22816
v_mfma_f32_16x16x32_bf16 v[76:79], v[140:143], v[120:123], 0
v_mfma_f32_16x16x32_bf16 v[96:99], v[140:143], v[124:127], 0
v_mfma_f32_16x16x32_bf16 v[40:43], v[144:147], v[112:115], 0
v_mfma_f32_16x16x32_bf16 v[60:63], v[144:147], v[116:119], 0
v_mfma_f32_16x16x32_bf16 v[80:83], v[144:147], v[120:123], 0
v_mfma_f32_16x16x32_bf16 v[100:103], v[144:147], v[124:127], 0
s_waitcnt lgkmcnt(0)
s_barrier
v_mfma_f32_16x16x32_bf16 v[24:27], v[176:179], v[160:163], v[24:27]
ds_read_b64_tr_b16 v[128:129], v9 offset:57344
v_mfma_f32_16x16x32_bf16 v[44:47], v[176:179], v[164:167], v[44:47]
ds_read_b64_tr_b16 v[130:131], v9 offset:58624
v_mfma_f32_16x16x32_bf16 v[64:67], v[176:179], v[168:171], v[64:67]
ds_read_b128 v[112:115], v5 offset:40960
v_mfma_f32_16x16x32_bf16 v[84:87], v[176:179], v[172:175], v[84:87]
ds_read_b128 v[116:119], v5 offset:43008
v_mfma_f32_16x16x32_bf16 v[28:31], v[180:183], v[160:163], v[28:31]
ds_read_b128 v[120:123], v5 offset:45056
v_mfma_f32_16x16x32_bf16 v[48:51], v[180:183], v[164:167], v[48:51]
ds_read_b128 v[124:127], v5 offset:47104
v_mfma_f32_16x16x32_bf16 v[68:71], v[180:183], v[168:171], v[68:71]
ds_read_b64_tr_b16 v[132:133], v9 offset:57352
v_mfma_f32_16x16x32_bf16 v[88:91], v[180:183], v[172:175], v[88:91]
ds_read_b64_tr_b16 v[134:135], v9 offset:58632
v_mfma_f32_16x16x32_bf16 v[32:35], v[184:187], v[160:163], v[32:35]
ds_read_b64_tr_b16 v[136:137], v9 offset:57360
v_mfma_f32_16x16x32_bf16 v[52:55], v[184:187], v[164:167], v[52:55]
ds_read_b64_tr_b16 v[138:139], v9 offset:58640
v_mfma_f32_16x16x32_bf16 v[72:75], v[184:187], v[168:171], v[72:75]
ds_read_b64_tr_b16 v[140:141], v9 offset:57368
v_mfma_f32_16x16x32_bf16 v[92:95], v[184:187], v[172:175], v[92:95]
ds_read_b64_tr_b16 v[142:143], v9 offset:58648
v_mfma_f32_16x16x32_bf16 v[36:39], v[188:191], v[160:163], v[36:39]
ds_read_b64_tr_b16 v[144:145], v9 offset:57376
v_mfma_f32_16x16x32_bf16 v[56:59], v[188:191], v[164:167], v[56:59]
ds_read_b64_tr_b16 v[146:147], v9 offset:58656
v_mfma_f32_16x16x32_bf16 v[76:79], v[188:191], v[168:171], v[76:79]
v_mfma_f32_16x16x32_bf16 v[96:99], v[188:191], v[172:175], v[96:99]
v_mfma_f32_16x16x32_bf16 v[40:43], v[192:195], v[160:163], v[40:43]
v_mfma_f32_16x16x32_bf16 v[60:63], v[192:195], v[164:167], v[60:63]
v_mfma_f32_16x16x32_bf16 v[80:83], v[192:195], v[168:171], v[80:83]
v_mfma_f32_16x16x32_bf16 v[100:103], v[192:195], v[172:175], v[100:103]
s_waitcnt lgkmcnt(0)
v_mfma_f32_16x16x32_bf16 v[24:27], v[128:131], v[112:115], v[24:27]
ds_read_b64_tr_b16 v[176:177], v9 offset:62464
v_mfma_f32_16x16x32_bf16 v[44:47], v[128:131], v[116:119], v[44:47]
ds_read_b64_tr_b16 v[178:179], v9 offset:63744
v_mfma_f32_16x16x32_bf16 v[64:67], v[128:131], v[120:123], v[64:67]
ds_read_b128 v[160:163], v6 offset:40960
v_mfma_f32_16x16x32_bf16 v[84:87], v[128:131], v[124:127], v[84:87]
ds_read_b128 v[164:167], v6 offset:43008
v_mfma_f32_16x16x32_bf16 v[28:31], v[132:135], v[112:115], v[28:31]
ds_read_b128 v[168:171], v6 offset:45056
v_mfma_f32_16x16x32_bf16 v[48:51], v[132:135], v[116:119], v[48:51]
ds_read_b128 v[172:175], v6 offset:47104
v_mfma_f32_16x16x32_bf16 v[68:71], v[132:135], v[120:123], v[68:71]
ds_read_b64_tr_b16 v[180:181], v9 offset:62472
v_mfma_f32_16x16x32_bf16 v[88:91], v[132:135], v[124:127], v[88:91]
ds_read_b64_tr_b16 v[182:183], v9 offset:63752
v_mfma_f32_16x16x32_bf16 v[32:35], v[136:139], v[112:115], v[32:35]
ds_read_b64_tr_b16 v[184:185], v9 offset:62480
v_mfma_f32_16x16x32_bf16 v[52:55], v[136:139], v[116:119], v[52:55]
ds_read_b64_tr_b16 v[186:187], v9 offset:63760
v_mfma_f32_16x16x32_bf16 v[72:75], v[136:139], v[120:123], v[72:75]
ds_read_b64_tr_b16 v[188:189], v9 offset:62488
v_mfma_f32_16x16x32_bf16 v[92:95], v[136:139], v[124:127], v[92:95]
ds_read_b64_tr_b16 v[190:191], v9 offset:63768
v_mfma_f32_16x16x32_bf16 v[36:39], v[140:143], v[112:115], v[36:39]
ds_read_b64_tr_b16 v[192:193], v9 offset:62496
v_mfma_f32_16x16x32_bf16 v[56:59], v[140:143], v[116:119], v[56:59]
ds_read_b64_tr_b16 v[194:195], v9 offset:63776
v_mfma_f32_16x16x32_bf16 v[76:79], v[140:143], v[120:123], v[76:79]
v_mfma_f32_16x16x32_bf16 v[96:99], v[140:143], v[124:127], v[96:99]
v_mfma_f32_16x16x32_bf16 v[40:43], v[144:147], v[112:115], v[40:43]
v_mfma_f32_16x16x32_bf16 v[60:63], v[144:147], v[116:119], v[60:63]
v_mfma_f32_16x16x32_bf16 v[80:83], v[144:147], v[120:123], v[80:83]
v_mfma_f32_16x16x32_bf16 v[100:103], v[144:147], v[124:127], v[100:103]
s_waitcnt lgkmcnt(0)
s_barrier
v_mfma_f32_16x16x32_bf16 v[24:27], v[176:179], v[160:163], v[24:27]
ds_read_b64_tr_b16 v[128:129], v10 offset:16384
v_mfma_f32_16x16x32_bf16 v[44:47], v[176:179], v[164:167], v[44:47]
ds_read_b64_tr_b16 v[130:131], v10 offset:17664
v_mfma_f32_16x16x32_bf16 v[64:67], v[176:179], v[168:171], v[64:67]
ds_read_b128 v[112:115], v7 offset:0
v_mfma_f32_16x16x32_bf16 v[84:87], v[176:179], v[172:175], v[84:87]
ds_read_b128 v[116:119], v7 offset:2048
v_mfma_f32_16x16x32_bf16 v[28:31], v[180:183], v[160:163], v[28:31]
ds_read_b128 v[120:123], v7 offset:4096
v_mfma_f32_16x16x32_bf16 v[48:51], v[180:183], v[164:167], v[48:51]
ds_read_b128 v[124:127], v7 offset:6144
v_mfma_f32_16x16x32_bf16 v[68:71], v[180:183], v[168:171], v[68:71]
ds_read_b64_tr_b16 v[132:133], v10 offset:16392
v_mfma_f32_16x16x32_bf16 v[88:91], v[180:183], v[172:175], v[88:91]
ds_read_b64_tr_b16 v[134:135], v10 offset:17672
v_mfma_f32_16x16x32_bf16 v[32:35], v[184:187], v[160:163], v[32:35]
ds_read_b64_tr_b16 v[136:137], v10 offset:16400
v_mfma_f32_16x16x32_bf16 v[52:55], v[184:187], v[164:167], v[52:55]
ds_read_b64_tr_b16 v[138:139], v10 offset:17680
v_mfma_f32_16x16x32_bf16 v[72:75], v[184:187], v[168:171], v[72:75]
ds_read_b64_tr_b16 v[140:141], v10 offset:16408
v_mfma_f32_16x16x32_bf16 v[92:95], v[184:187], v[172:175], v[92:95]
ds_read_b64_tr_b16 v[142:143], v10 offset:17688
v_mfma_f32_16x16x32_bf16 v[36:39], v[188:191], v[160:163], v[36:39]
ds_read_b64_tr_b16 v[144:145], v10 offset:16416
v_mfma_f32_16x16x32_bf16 v[56:59], v[188:191], v[164:167], v[56:59]
ds_read_b64_tr_b16 v[146:147], v10 offset:17696
v_mfma_f32_16x16x32_bf16 v[76:79], v[188:191], v[168:171], v[76:79]
v_mfma_f32_16x16x32_bf16 v[96:99], v[188:191], v[172:175], v[96:99]
v_mfma_f32_16x16x32_bf16 v[40:43], v[192:195], v[160:163], v[40:43]
v_mfma_f32_16x16x32_bf16 v[60:63], v[192:195], v[164:167], v[60:63]
v_mfma_f32_16x16x32_bf16 v[80:83], v[192:195], v[168:171], v[80:83]
v_mfma_f32_16x16x32_bf16 v[100:103], v[192:195], v[172:175], v[100:103]
s_waitcnt lgkmcnt(0)
v_mfma_f32_16x16x32_bf16 v[24:27], v[128:131], v[112:115], v[24:27]
ds_read_b64_tr_b16 v[176:177], v10 offset:21504
v_mfma_f32_16x16x32_bf16 v[44:47], v[128:131], v[116:119], v[44:47]
ds_read_b64_tr_b16 v[178:179], v10 offset:22784
v_mfma_f32_16x16x32_bf16 v[64:67], v[128:131], v[120:123], v[64:67]
ds_read_b128 v[160:163], v8 offset:0
v_mfma_f32_16x16x32_bf16 v[84:87], v[128:131], v[124:127], v[84:87]
ds_read_b128 v[164:167], v8 offset:2048
v_mfma_f32_16x16x32_bf16 v[28:31], v[132:135], v[112:115], v[28:31]
ds_read_b128 v[168:171], v8 offset:4096
v_mfma_f32_16x16x32_bf16 v[48:51], v[132:135], v[116:119], v[48:51]
ds_read_b128 v[172:175], v8 offset:6144
v_mfma_f32_16x16x32_bf16 v[68:71], v[132:135], v[120:123], v[68:71]
ds_read_b64_tr_b16 v[180:181], v10 offset:21512
v_mfma_f32_16x16x32_bf16 v[88:91], v[132:135], v[124:127], v[88:91]
ds_read_b64_tr_b16 v[182:183], v10 offset:22792
v_mfma_f32_16x16x32_bf16 v[32:35], v[136:139], v[112:115], v[32:35]
ds_read_b64_tr_b16 v[184:185], v10 offset:21520
v_mfma_f32_16x16x32_bf16 v[52:55], v[136:139], v[116:119], v[52:55]
ds_read_b64_tr_b16 v[186:187], v10 offset:22800
v_mfma_f32_16x16x32_bf16 v[72:75], v[136:139], v[120:123], v[72:75]
ds_read_b64_tr_b16 v[188:189], v10 offset:21528
v_mfma_f32_16x16x32_bf16 v[92:95], v[136:139], v[124:127], v[92:95]
ds_read_b64_tr_b16 v[190:191], v10 offset:22808
v_mfma_f32_16x16x32_bf16 v[36:39], v[140:143], v[112:115], v[36:39]
ds_read_b64_tr_b16 v[192:193], v10 offset:21536
v_mfma_f32_16x16x32_bf16 v[56:59], v[140:143], v[116:119], v[56:59]
ds_read_b64_tr_b16 v[194:195], v10 offset:22816
v_mfma_f32_16x16x32_bf16 v[76:79], v[140:143], v[120:123], v[76:79]
v_mfma_f32_16x16x32_bf16 v[96:99], v[140:143], v[124:127], v[96:99]
v_mfma_f32_16x16x32_bf16 v[40:43], v[144:147], v[112:115], v[40:43]
v_mfma_f32_16x16x32_bf16 v[60:63], v[144:147], v[116:119], v[60:63]
v_mfma_f32_16x16x32_bf16 v[80:83], v[144:147], v[120:123], v[80:83]
v_mfma_f32_16x16x32_bf16 v[100:103], v[144:147], v[124:127], v[100:103]
s_waitcnt lgkmcnt(0)
s_barrier
v_mfma_f32_16x16x32_bf16 v[24:27], v[176:179], v[160:163], v[24:27]
ds_read_b64_tr_b16 v[128:129], v10 offset:57344
v_mfma_f32_16x16x32_bf16 v[44:47], v[176:179], v[164:167], v[44:47]
ds_read_b64_tr_b16 v[130:131], v10 offset:58624
v_mfma_f32_16x16x32_bf16 v[64:67], v[176:179], v[168:171], v[64:67]
ds_read_b128 v[112:115], v7 offset:40960
v_mfma_f32_16x16x32_bf16 v[84:87], v[176:179], v[172:175], v[84:87]
ds_read_b128 v[116:119], v7 offset:43008
v_mfma_f32_16x16x32_bf16 v[28:31], v[180:183], v[160:163], v[28:31]
ds_read_b128 v[120:123], v7 offset:45056
v_mfma_f32_16x16x32_bf16 v[48:51], v[180:183], v[164:167], v[48:51]
ds_read_b128 v[124:127], v7 offset:47104
v_mfma_f32_16x16x32_bf16 v[68:71], v[180:183], v[168:171], v[68:71]
ds_read_b64_tr_b16 v[132:133], v10 offset:57352
v_mfma_f32_16x16x32_bf16 v[88:91], v[180:183], v[172:175], v[88:91]
ds_read_b64_tr_b16 v[134:135], v10 offset:58632
v_mfma_f32_16x16x32_bf16 v[32:35], v[184:187], v[160:163], v[32:35]
ds_read_b64_tr_b16 v[136:137], v10 offset:57360
v_mfma_f32_16x16x32_bf16 v[52:55], v[184:187], v[164:167], v[52:55]
ds_read_b64_tr_b16 v[138:139], v10 offset:58640
v_mfma_f32_16x16x32_bf16 v[72:75], v[184:187], v[168:171], v[72:75]
ds_read_b64_tr_b16 v[140:141], v10 offset:57368
v_mfma_f32_16x16x32_bf16 v[92:95], v[184:187], v[172:175], v[92:95]
ds_read_b64_tr_b16 v[142:143], v10 offset:58648
v_mfma_f32_16x16x32_bf16 v[36:39], v[188:191], v[160:163], v[36:39]
ds_read_b64_tr_b16 v[144:145], v10 offset:57376
v_mfma_f32_16x16x32_bf16 v[56:59], v[188:191], v[164:167], v[56:59]
ds_read_b64_tr_b16 v[146:147], v10 offset:58656
v_mfma_f32_16x16x32_bf16 v[76:79], v[188:191], v[168:171], v[76:79]
v_mfma_f32_16x16x32_bf16 v[96:99], v[188:191], v[172:175], v[96:99]
v_mfma_f32_16x16x32_bf16 v[40:43], v[192:195], v[160:163], v[40:43]
v_mfma_f32_16x16x32_bf16 v[60:63], v[192:195], v[164:167], v[60:63]
v_mfma_f32_16x16x32_bf16 v[80:83], v[192:195], v[168:171], v[80:83]
v_mfma_f32_16x16x32_bf16 v[100:103], v[192:195], v[172:175], v[100:103]
s_waitcnt lgkmcnt(0)
v_mfma_f32_16x16x32_bf16 v[24:27], v[128:131], v[112:115], v[24:27]
ds_read_b64_tr_b16 v[176:177], v10 offset:62464
v_mfma_f32_16x16x32_bf16 v[44:47], v[128:131], v[116:119], v[44:47]
ds_read_b64_tr_b16 v[178:179], v10 offset:63744
v_mfma_f32_16x16x32_bf16 v[64:67], v[128:131], v[120:123], v[64:67]
ds_read_b128 v[160:163], v8 offset:40960
v_mfma_f32_16x16x32_bf16 v[84:87], v[128:131], v[124:127], v[84:87]
ds_read_b128 v[164:167], v8 offset:43008
v_mfma_f32_16x16x32_bf16 v[28:31], v[132:135], v[112:115], v[28:31]
ds_read_b128 v[168:171], v8 offset:45056
v_mfma_f32_16x16x32_bf16 v[48:51], v[132:135], v[116:119], v[48:51]
ds_read_b128 v[172:175], v8 offset:47104
v_mfma_f32_16x16x32_bf16 v[68:71], v[132:135], v[120:123], v[68:71]
ds_read_b64_tr_b16 v[180:181], v10 offset:62472
v_mfma_f32_16x16x32_bf16 v[88:91], v[132:135], v[124:127], v[88:91]
ds_read_b64_tr_b16 v[182:183], v10 offset:63752
v_mfma_f32_16x16x32_bf16 v[32:35], v[136:139], v[112:115], v[32:35]
ds_read_b64_tr_b16 v[184:185], v10 offset:62480
v_mfma_f32_16x16x32_bf16 v[52:55], v[136:139], v[116:119], v[52:55]
ds_read_b64_tr_b16 v[186:187], v10 offset:63760
v_mfma_f32_16x16x32_bf16 v[72:75], v[136:139], v[120:123], v[72:75]
ds_read_b64_tr_b16 v[188:189], v10 offset:62488
v_mfma_f32_16x16x32_bf16 v[92:95], v[136:139], v[124:127], v[92:95]
ds_read_b64_tr_b16 v[190:191], v10 offset:63768
v_mfma_f32_16x16x32_bf16 v[36:39], v[140:143], v[112:115], v[36:39]
ds_read_b64_tr_b16 v[192:193], v10 offset:62496
v_mfma_f32_16x16x32_bf16 v[56:59], v[140:143], v[116:119], v[56:59]
ds_read_b64_tr_b16 v[194:195], v10 offset:63776
v_mfma_f32_16x16x32_bf16 v[76:79], v[140:143], v[120:123], v[76:79]
v_mfma_f32_16x16x32_bf16 v[96:99], v[140:143], v[124:127], v[96:99]
v_mfma_f32_16x16x32_bf16 v[40:43], v[144:147], v[112:115], v[40:43]
v_mfma_f32_16x16x32_bf16 v[60:63], v[144:147], v[116:119], v[60:63]
v_mfma_f32_16x16x32_bf16 v[80:83], v[144:147], v[120:123], v[80:83]
v_mfma_f32_16x16x32_bf16 v[100:103], v[144:147], v[124:127], v[100:103]
s_waitcnt lgkmcnt(0)
s_barrier
v_mfma_f32_16x16x32_bf16 v[24:27], v[176:179], v[160:163], v[24:27]
ds_read_b64_tr_b16 v[128:129], v9 offset:16384
v_mfma_f32_16x16x32_bf16 v[44:47], v[176:179], v[164:167], v[44:47]
ds_read_b64_tr_b16 v[130:131], v9 offset:17664
v_mfma_f32_16x16x32_bf16 v[64:67], v[176:179], v[168:171], v[64:67]
ds_read_b128 v[112:115], v5 offset:0
v_mfma_f32_16x16x32_bf16 v[84:87], v[176:179], v[172:175], v[84:87]
ds_read_b128 v[116:119], v5 offset:2048
v_mfma_f32_16x16x32_bf16 v[28:31], v[180:183], v[160:163], v[28:31]
ds_read_b128 v[120:123], v5 offset:4096
v_mfma_f32_16x16x32_bf16 v[48:51], v[180:183], v[164:167], v[48:51]
ds_read_b128 v[124:127], v5 offset:6144
v_mfma_f32_16x16x32_bf16 v[68:71], v[180:183], v[168:171], v[68:71]
ds_read_b64_tr_b16 v[132:133], v9 offset:16392
v_mfma_f32_16x16x32_bf16 v[88:91], v[180:183], v[172:175], v[88:91]
ds_read_b64_tr_b16 v[134:135], v9 offset:17672
v_mfma_f32_16x16x32_bf16 v[32:35], v[184:187], v[160:163], v[32:35]
ds_read_b64_tr_b16 v[136:137], v9 offset:16400
v_mfma_f32_16x16x32_bf16 v[52:55], v[184:187], v[164:167], v[52:55]
ds_read_b64_tr_b16 v[138:139], v9 offset:17680
v_mfma_f32_16x16x32_bf16 v[72:75], v[184:187], v[168:171], v[72:75]
ds_read_b64_tr_b16 v[140:141], v9 offset:16408
v_mfma_f32_16x16x32_bf16 v[92:95], v[184:187], v[172:175], v[92:95]
ds_read_b64_tr_b16 v[142:143], v9 offset:17688
v_mfma_f32_16x16x32_bf16 v[36:39], v[188:191], v[160:163], v[36:39]
ds_read_b64_tr_b16 v[144:145], v9 offset:16416
v_mfma_f32_16x16x32_bf16 v[56:59], v[188:191], v[164:167], v[56:59]
ds_read_b64_tr_b16 v[146:147], v9 offset:17696
v_mfma_f32_16x16x32_bf16 v[76:79], v[188:191], v[168:171], v[76:79]
v_mfma_f32_16x16x32_bf16 v[96:99], v[188:191], v[172:175], v[96:99]
v_mfma_f32_16x16x32_bf16 v[40:43], v[192:195], v[160:163], v[40:43]
v_mfma_f32_16x16x32_bf16 v[60:63], v[192:195], v[164:167], v[60:63]
v_mfma_f32_16x16x32_bf16 v[80:83], v[192:195], v[168:171], v[80:83]
v_mfma_f32_16x16x32_bf16 v[100:103], v[192:195], v[172:175], v[100:103]
s_waitcnt lgkmcnt(0)
v_mfma_f32_16x16x32_bf16 v[24:27], v[128:131], v[112:115], v[24:27]
ds_read_b64_tr_b16 v[176:177], v9 offset:21504
v_mfma_f32_16x16x32_bf16 v[44:47], v[128:131], v[116:119], v[44:47]
ds_read_b64_tr_b16 v[178:179], v9 offset:22784
v_mfma_f32_16x16x32_bf16 v[64:67], v[128:131], v[120:123], v[64:67]
ds_read_b128 v[160:163], v6 offset:0
v_mfma_f32_16x16x32_bf16 v[84:87], v[128:131], v[124:127], v[84:87]
ds_read_b128 v[164:167], v6 offset:2048
v_mfma_f32_16x16x32_bf16 v[28:31], v[132:135], v[112:115], v[28:31]
ds_read_b128 v[168:171], v6 offset:4096
v_mfma_f32_16x16x32_bf16 v[48:51], v[132:135], v[116:119], v[48:51]
ds_read_b128 v[172:175], v6 offset:6144
v_mfma_f32_16x16x32_bf16 v[68:71], v[132:135], v[120:123], v[68:71]
ds_read_b64_tr_b16 v[180:181], v9 offset:21512
v_mfma_f32_16x16x32_bf16 v[88:91], v[132:135], v[124:127], v[88:91]
ds_read_b64_tr_b16 v[182:183], v9 offset:22792
v_mfma_f32_16x16x32_bf16 v[32:35], v[136:139], v[112:115], v[32:35]
ds_read_b64_tr_b16 v[184:185], v9 offset:21520
v_mfma_f32_16x16x32_bf16 v[52:55], v[136:139], v[116:119], v[52:55]
ds_read_b64_tr_b16 v[186:187], v9 offset:22800
v_mfma_f32_16x16x32_bf16 v[72:75], v[136:139], v[120:123], v[72:75]
ds_read_b64_tr_b16 v[188:189], v9 offset:21528
v_mfma_f32_16x16x32_bf16 v[92:95], v[136:139], v[124:127], v[92:95]
ds_read_b64_tr_b16 v[190:191], v9 offset:22808
v_mfma_f32_16x16x32_bf16 v[36:39], v[140:143], v[112:115], v[36:39]
ds_read_b64_tr_b16 v[192:193], v9 offset:21536
v_mfma_f32_16x16x32_bf16 v[56:59], v[140:143], v[116:119], v[56:59]
ds_read_b64_tr_b16 v[194:195], v9 offset:22816
v_mfma_f32_16x16x32_bf16 v[76:79], v[140:143], v[120:123], v[76:79]
v_mfma_f32_16x16x32_bf16 v[96:99], v[140:143], v[124:127], v[96:99]
v_mfma_f32_16x16x32_bf16 v[40:43], v[144:147], v[112:115], v[40:43]
v_mfma_f32_16x16x32_bf16 v[60:63], v[144:147], v[116:119], v[60:63]
v_mfma_f32_16x16x32_bf16 v[80:83], v[144:147], v[120:123], v[80:83]
v_mfma_f32_16x16x32_bf16 v[100:103], v[144:147], v[124:127], v[100:103]
s_waitcnt lgkmcnt(0)
s_barrier
v_mfma_f32_16x16x32_bf16 v[24:27], v[176:179], v[160:163], v[24:27]
ds_read_b64_tr_b16 v[128:129], v9 offset:57344
v_mfma_f32_16x16x32_bf16 v[44:47], v[176:179], v[164:167], v[44:47]
ds_read_b64_tr_b16 v[130:131], v9 offset:58624
v_mfma_f32_16x16x32_bf16 v[64:67], v[176:179], v[168:171], v[64:67]
ds_read_b128 v[112:115], v5 offset:40960
v_mfma_f32_16x16x32_bf16 v[84:87], v[176:179], v[172:175], v[84:87]
ds_read_b128 v[116:119], v5 offset:43008
v_mfma_f32_16x16x32_bf16 v[28:31], v[180:183], v[160:163], v[28:31]
ds_read_b128 v[120:123], v5 offset:45056
v_mfma_f32_16x16x32_bf16 v[48:51], v[180:183], v[164:167], v[48:51]
ds_read_b128 v[124:127], v5 offset:47104
v_mfma_f32_16x16x32_bf16 v[68:71], v[180:183], v[168:171], v[68:71]
ds_read_b64_tr_b16 v[132:133], v9 offset:57352
v_mfma_f32_16x16x32_bf16 v[88:91], v[180:183], v[172:175], v[88:91]
ds_read_b64_tr_b16 v[134:135], v9 offset:58632
v_mfma_f32_16x16x32_bf16 v[32:35], v[184:187], v[160:163], v[32:35]
ds_read_b64_tr_b16 v[136:137], v9 offset:57360
v_mfma_f32_16x16x32_bf16 v[52:55], v[184:187], v[164:167], v[52:55]
ds_read_b64_tr_b16 v[138:139], v9 offset:58640
v_mfma_f32_16x16x32_bf16 v[72:75], v[184:187], v[168:171], v[72:75]
ds_read_b64_tr_b16 v[140:141], v9 offset:57368
v_mfma_f32_16x16x32_bf16 v[92:95], v[184:187], v[172:175], v[92:95]
ds_read_b64_tr_b16 v[142:143], v9 offset:58648
v_mfma_f32_16x16x32_bf16 v[36:39], v[188:191], v[160:163], v[36:39]
ds_read_b64_tr_b16 v[144:145], v9 offset:57376
v_mfma_f32_16x16x32_bf16 v[56:59], v[188:191], v[164:167], v[56:59]
ds_read_b64_tr_b16 v[146:147], v9 offset:58656
v_mfma_f32_16x16x32_bf16 v[76:79], v[188:191], v[168:171], v[76:79]
v_mfma_f32_16x16x32_bf16 v[96:99], v[188:191], v[172:175], v[96:99]
v_mfma_f32_16x16x32_bf16 v[40:43], v[192:195], v[160:163], v[40:43]
v_mfma_f32_16x16x32_bf16 v[60:63], v[192:195], v[164:167], v[60:63]
v_mfma_f32_16x16x32_bf16 v[80:83], v[192:195], v[168:171], v[80:83]
v_mfma_f32_16x16x32_bf16 v[100:103], v[192:195], v[172:175], v[100:103]
s_waitcnt lgkmcnt(0)
v_mfma_f32_16x16x32_bf16 v[24:27], v[128:131], v[112:115], v[24:27]
ds_read_b64_tr_b16 v[176:177], v9 offset:62464
v_mfma_f32_16x16x32_bf16 v[44:47], v[128:131], v[116:119], v[44:47]
ds_read_b64_tr_b16 v[178:179], v9 offset:63744
v_mfma_f32_16x16x32_bf16 v[64:67], v[128:131], v[120:123], v[64:67]
ds_read_b128 v[160:163], v6 offset:40960
v_mfma_f32_16x16x32_bf16 v[84:87], v[128:131], v[124:127], v[84:87]
ds_read_b128 v[164:167], v6 offset:43008
v_mfma_f32_16x16x32_bf16 v[28:31], v[132:135], v[112:115], v[28:31]
ds_read_b128 v[168:171], v6 offset:45056
v_mfma_f32_16x16x32_bf16 v[48:51], v[132:135], v[116:119], v[48:51]
ds_read_b128 v[172:175], v6 offset:47104
v_mfma_f32_16x16x32_bf16 v[68:71], v[132:135], v[120:123], v[68:71]
ds_read_b64_tr_b16 v[180:181], v9 offset:62472
v_mfma_f32_16x16x32_bf16 v[88:91], v[132:135], v[124:127], v[88:91]
ds_read_b64_tr_b16 v[182:183], v9 offset:63752
v_mfma_f32_16x16x32_bf16 v[32:35], v[136:139], v[112:115], v[32:35]
ds_read_b64_tr_b16 v[184:185], v9 offset:62480
v_mfma_f32_16x16x32_bf16 v[52:55], v[136:139], v[116:119], v[52:55]
ds_read_b64_tr_b16 v[186:187], v9 offset:63760
v_mfma_f32_16x16x32_bf16 v[72:75], v[136:139], v[120:123], v[72:75]
ds_read_b64_tr_b16 v[188:189], v9 offset:62488
v_mfma_f32_16x16x32_bf16 v[92:95], v[136:139], v[124:127], v[92:95]
ds_read_b64_tr_b16 v[190:191], v9 offset:63768
v_mfma_f32_16x16x32_bf16 v[36:39], v[140:143], v[112:115], v[36:39]
ds_read_b64_tr_b16 v[192:193], v9 offset:62496
v_mfma_f32_16x16x32_bf16 v[56:59], v[140:143], v[116:119], v[56:59]
ds_read_b64_tr_b16 v[194:195], v9 offset:63776
v_mfma_f32_16x16x32_bf16 v[76:79], v[140:143], v[120:123], v[76:79]
v_mfma_f32_16x16x32_bf16 v[96:99], v[140:143], v[124:127], v[96:99]
v_mfma_f32_16x16x32_bf16 v[40:43], v[144:147], v[112:115], v[40:43]
v_mfma_f32_16x16x32_bf16 v[60:63], v[144:147], v[116:119], v[60:63]
v_mfma_f32_16x16x32_bf16 v[80:83], v[144:147], v[120:123], v[80:83]
v_mfma_f32_16x16x32_bf16 v[100:103], v[144:147], v[124:127], v[100:103]
s_waitcnt lgkmcnt(0)
s_barrier
v_mfma_f32_16x16x32_bf16 v[24:27], v[176:179], v[160:163], v[24:27]
ds_read_b64_tr_b16 v[128:129], v10 offset:16384
v_mfma_f32_16x16x32_bf16 v[44:47], v[176:179], v[164:167], v[44:47]
ds_read_b64_tr_b16 v[130:131], v10 offset:17664
v_mfma_f32_16x16x32_bf16 v[64:67], v[176:179], v[168:171], v[64:67]
ds_read_b128 v[112:115], v7 offset:0
v_mfma_f32_16x16x32_bf16 v[84:87], v[176:179], v[172:175], v[84:87]
ds_read_b128 v[116:119], v7 offset:2048
v_mfma_f32_16x16x32_bf16 v[28:31], v[180:183], v[160:163], v[28:31]
ds_read_b128 v[120:123], v7 offset:4096
v_mfma_f32_16x16x32_bf16 v[48:51], v[180:183], v[164:167], v[48:51]
ds_read_b128 v[124:127], v7 offset:6144
v_mfma_f32_16x16x32_bf16 v[68:71], v[180:183], v[168:171], v[68:71]
ds_read_b64_tr_b16 v[132:133], v10 offset:16392
v_mfma_f32_16x16x32_bf16 v[88:91], v[180:183], v[172:175], v[88:91]
ds_read_b64_tr_b16 v[134:135], v10 offset:17672
v_mfma_f32_16x16x32_bf16 v[32:35], v[184:187], v[160:163], v[32:35]
ds_read_b64_tr_b16 v[136:137], v10 offset:16400
v_mfma_f32_16x16x32_bf16 v[52:55], v[184:187], v[164:167], v[52:55]
ds_read_b64_tr_b16 v[138:139], v10 offset:17680
v_mfma_f32_16x16x32_bf16 v[72:75], v[184:187], v[168:171], v[72:75]
ds_read_b64_tr_b16 v[140:141], v10 offset:16408
v_mfma_f32_16x16x32_bf16 v[92:95], v[184:187], v[172:175], v[92:95]
ds_read_b64_tr_b16 v[142:143], v10 offset:17688
v_mfma_f32_16x16x32_bf16 v[36:39], v[188:191], v[160:163], v[36:39]
ds_read_b64_tr_b16 v[144:145], v10 offset:16416
v_mfma_f32_16x16x32_bf16 v[56:59], v[188:191], v[164:167], v[56:59]
ds_read_b64_tr_b16 v[146:147], v10 offset:17696
v_mfma_f32_16x16x32_bf16 v[76:79], v[188:191], v[168:171], v[76:79]
v_mfma_f32_16x16x32_bf16 v[96:99], v[188:191], v[172:175], v[96:99]
v_mfma_f32_16x16x32_bf16 v[40:43], v[192:195], v[160:163], v[40:43]
v_mfma_f32_16x16x32_bf16 v[60:63], v[192:195], v[164:167], v[60:63]
v_mfma_f32_16x16x32_bf16 v[80:83], v[192:195], v[168:171], v[80:83]
v_mfma_f32_16x16x32_bf16 v[100:103], v[192:195], v[172:175], v[100:103]
s_waitcnt lgkmcnt(0)
v_mfma_f32_16x16x32_bf16 v[24:27], v[128:131], v[112:115], v[24:27]
ds_read_b64_tr_b16 v[176:177], v10 offset:21504
v_mfma_f32_16x16x32_bf16 v[44:47], v[128:131], v[116:119], v[44:47]
ds_read_b64_tr_b16 v[178:179], v10 offset:22784
v_mfma_f32_16x16x32_bf16 v[64:67], v[128:131], v[120:123], v[64:67]
ds_read_b128 v[160:163], v8 offset:0
v_mfma_f32_16x16x32_bf16 v[84:87], v[128:131], v[124:127], v[84:87]
ds_read_b128 v[164:167], v8 offset:2048
v_mfma_f32_16x16x32_bf16 v[28:31], v[132:135], v[112:115], v[28:31]
ds_read_b128 v[168:171], v8 offset:4096
v_mfma_f32_16x16x32_bf16 v[48:51], v[132:135], v[116:119], v[48:51]
ds_read_b128 v[172:175], v8 offset:6144
v_mfma_f32_16x16x32_bf16 v[68:71], v[132:135], v[120:123], v[68:71]
ds_read_b64_tr_b16 v[180:181], v10 offset:21512
v_mfma_f32_16x16x32_bf16 v[88:91], v[132:135], v[124:127], v[88:91]
ds_read_b64_tr_b16 v[182:183], v10 offset:22792
v_mfma_f32_16x16x32_bf16 v[32:35], v[136:139], v[112:115], v[32:35]
ds_read_b64_tr_b16 v[184:185], v10 offset:21520
v_mfma_f32_16x16x32_bf16 v[52:55], v[136:139], v[116:119], v[52:55]
ds_read_b64_tr_b16 v[186:187], v10 offset:22800
v_mfma_f32_16x16x32_bf16 v[72:75], v[136:139], v[120:123], v[72:75]
ds_read_b64_tr_b16 v[188:189], v10 offset:21528
v_mfma_f32_16x16x32_bf16 v[92:95], v[136:139], v[124:127], v[92:95]
ds_read_b64_tr_b16 v[190:191], v10 offset:22808
v_mfma_f32_16x16x32_bf16 v[36:39], v[140:143], v[112:115], v[36:39]
ds_read_b64_tr_b16 v[192:193], v10 offset:21536
v_mfma_f32_16x16x32_bf16 v[56:59], v[140:143], v[116:119], v[56:59]
ds_read_b64_tr_b16 v[194:195], v10 offset:22816
v_mfma_f32_16x16x32_bf16 v[76:79], v[140:143], v[120:123], v[76:79]
v_mfma_f32_16x16x32_bf16 v[96:99], v[140:143], v[124:127], v[96:99]
v_mfma_f32_16x16x32_bf16 v[40:43], v[144:147], v[112:115], v[40:43]
v_mfma_f32_16x16x32_bf16 v[60:63], v[144:147], v[116:119], v[60:63]
v_mfma_f32_16x16x32_bf16 v[80:83], v[144:147], v[120:123], v[80:83]
v_mfma_f32_16x16x32_bf16 v[100:103], v[144:147], v[124:127], v[100:103]
s_waitcnt lgkmcnt(0)
s_barrier
v_mfma_f32_16x16x32_bf16 v[24:27], v[176:179], v[160:163], v[24:27]
ds_read_b64_tr_b16 v[128:129], v10 offset:57344
v_mfma_f32_16x16x32_bf16 v[44:47], v[176:179], v[164:167], v[44:47]
ds_read_b64_tr_b16 v[130:131], v10 offset:58624
v_mfma_f32_16x16x32_bf16 v[64:67], v[176:179], v[168:171], v[64:67]
ds_read_b128 v[112:115], v7 offset:40960
v_mfma_f32_16x16x32_bf16 v[84:87], v[176:179], v[172:175], v[84:87]
ds_read_b128 v[116:119], v7 offset:43008
v_mfma_f32_16x16x32_bf16 v[28:31], v[180:183], v[160:163], v[28:31]
ds_read_b128 v[120:123], v7 offset:45056
v_mfma_f32_16x16x32_bf16 v[48:51], v[180:183], v[164:167], v[48:51]
ds_read_b128 v[124:127], v7 offset:47104
v_mfma_f32_16x16x32_bf16 v[68:71], v[180:183], v[168:171], v[68:71]
ds_read_b64_tr_b16 v[132:133], v10 offset:57352
v_mfma_f32_16x16x32_bf16 v[88:91], v[180:183], v[172:175], v[88:91]
ds_read_b64_tr_b16 v[134:135], v10 offset:58632
v_mfma_f32_16x16x32_bf16 v[32:35], v[184:187], v[160:163], v[32:35]
ds_read_b64_tr_b16 v[136:137], v10 offset:57360
v_mfma_f32_16x16x32_bf16 v[52:55], v[184:187], v[164:167], v[52:55]
ds_read_b64_tr_b16 v[138:139], v10 offset:58640
v_mfma_f32_16x16x32_bf16 v[72:75], v[184:187], v[168:171], v[72:75]
ds_read_b64_tr_b16 v[140:141], v10 offset:57368
v_mfma_f32_16x16x32_bf16 v[92:95], v[184:187], v[172:175], v[92:95]
ds_read_b64_tr_b16 v[142:143], v10 offset:58648
v_mfma_f32_16x16x32_bf16 v[36:39], v[188:191], v[160:163], v[36:39]
ds_read_b64_tr_b16 v[144:145], v10 offset:57376
v_mfma_f32_16x16x32_bf16 v[56:59], v[188:191], v[164:167], v[56:59]
ds_read_b64_tr_b16 v[146:147], v10 offset:58656
v_mfma_f32_16x16x32_bf16 v[76:79], v[188:191], v[168:171], v[76:79]
v_mfma_f32_16x16x32_bf16 v[96:99], v[188:191], v[172:175], v[96:99]
v_mfma_f32_16x16x32_bf16 v[40:43], v[192:195], v[160:163], v[40:43]
v_mfma_f32_16x16x32_bf16 v[60:63], v[192:195], v[164:167], v[60:63]
v_mfma_f32_16x16x32_bf16 v[80:83], v[192:195], v[168:171], v[80:83]
v_mfma_f32_16x16x32_bf16 v[100:103], v[192:195], v[172:175], v[100:103]
s_waitcnt lgkmcnt(0)
v_mfma_f32_16x16x32_bf16 v[24:27], v[128:131], v[112:115], v[24:27]
ds_read_b64_tr_b16 v[176:177], v10 offset:62464
v_mfma_f32_16x16x32_bf16 v[44:47], v[128:131], v[116:119], v[44:47]
ds_read_b64_tr_b16 v[178:179], v10 offset:63744
v_mfma_f32_16x16x32_bf16 v[64:67], v[128:131], v[120:123], v[64:67]
ds_read_b128 v[160:163], v8 offset:40960
v_mfma_f32_16x16x32_bf16 v[84:87], v[128:131], v[124:127], v[84:87]
ds_read_b128 v[164:167], v8 offset:43008
v_mfma_f32_16x16x32_bf16 v[28:31], v[132:135], v[112:115], v[28:31]
ds_read_b128 v[168:171], v8 offset:45056
v_mfma_f32_16x16x32_bf16 v[48:51], v[132:135], v[116:119], v[48:51]
ds_read_b128 v[172:175], v8 offset:47104
v_mfma_f32_16x16x32_bf16 v[68:71], v[132:135], v[120:123], v[68:71]
ds_read_b64_tr_b16 v[180:181], v10 offset:62472
v_mfma_f32_16x16x32_bf16 v[88:91], v[132:135], v[124:127], v[88:91]
ds_read_b64_tr_b16 v[182:183], v10 offset:63752
v_mfma_f32_16x16x32_bf16 v[32:35], v[136:139], v[112:115], v[32:35]
ds_read_b64_tr_b16 v[184:185], v10 offset:62480
v_mfma_f32_16x16x32_bf16 v[52:55], v[136:139], v[116:119], v[52:55]
ds_read_b64_tr_b16 v[186:187], v10 offset:63760
v_mfma_f32_16x16x32_bf16 v[72:75], v[136:139], v[120:123], v[72:75]
ds_read_b64_tr_b16 v[188:189], v10 offset:62488
v_mfma_f32_16x16x32_bf16 v[92:95], v[136:139], v[124:127], v[92:95]
ds_read_b64_tr_b16 v[190:191], v10 offset:63768
v_mfma_f32_16x16x32_bf16 v[36:39], v[140:143], v[112:115], v[36:39]
ds_read_b64_tr_b16 v[192:193], v10 offset:62496
v_mfma_f32_16x16x32_bf16 v[56:59], v[140:143], v[116:119], v[56:59]
ds_read_b64_tr_b16 v[194:195], v10 offset:63776
v_mfma_f32_16x16x32_bf16 v[76:79], v[140:143], v[120:123], v[76:79]
v_mfma_f32_16x16x32_bf16 v[96:99], v[140:143], v[124:127], v[96:99]
v_mfma_f32_16x16x32_bf16 v[40:43], v[144:147], v[112:115], v[40:43]
v_mfma_f32_16x16x32_bf16 v[60:63], v[144:147], v[116:119], v[60:63]
v_mfma_f32_16x16x32_bf16 v[80:83], v[144:147], v[120:123], v[80:83]
v_mfma_f32_16x16x32_bf16 v[100:103], v[144:147], v[124:127], v[100:103]
s_waitcnt lgkmcnt(0)
s_barrier
v_mfma_f32_16x16x32_bf16 v[24:27], v[176:179], v[160:163], v[24:27]
ds_read_b64_tr_b16 v[128:129], v9 offset:16384
v_mfma_f32_16x16x32_bf16 v[44:47], v[176:179], v[164:167], v[44:47]
ds_read_b64_tr_b16 v[130:131], v9 offset:17664
v_mfma_f32_16x16x32_bf16 v[64:67], v[176:179], v[168:171], v[64:67]
ds_read_b128 v[112:115], v5 offset:0
v_mfma_f32_16x16x32_bf16 v[84:87], v[176:179], v[172:175], v[84:87]
ds_read_b128 v[116:119], v5 offset:2048
v_mfma_f32_16x16x32_bf16 v[28:31], v[180:183], v[160:163], v[28:31]
ds_read_b128 v[120:123], v5 offset:4096
v_mfma_f32_16x16x32_bf16 v[48:51], v[180:183], v[164:167], v[48:51]
ds_read_b128 v[124:127], v5 offset:6144
v_mfma_f32_16x16x32_bf16 v[68:71], v[180:183], v[168:171], v[68:71]
ds_read_b64_tr_b16 v[132:133], v9 offset:16392
v_mfma_f32_16x16x32_bf16 v[88:91], v[180:183], v[172:175], v[88:91]
ds_read_b64_tr_b16 v[134:135], v9 offset:17672
v_mfma_f32_16x16x32_bf16 v[32:35], v[184:187], v[160:163], v[32:35]
ds_read_b64_tr_b16 v[136:137], v9 offset:16400
v_mfma_f32_16x16x32_bf16 v[52:55], v[184:187], v[164:167], v[52:55]
ds_read_b64_tr_b16 v[138:139], v9 offset:17680
v_mfma_f32_16x16x32_bf16 v[72:75], v[184:187], v[168:171], v[72:75]
ds_read_b64_tr_b16 v[140:141], v9 offset:16408
v_mfma_f32_16x16x32_bf16 v[92:95], v[184:187], v[172:175], v[92:95]
ds_read_b64_tr_b16 v[142:143], v9 offset:17688
v_mfma_f32_16x16x32_bf16 v[36:39], v[188:191], v[160:163], v[36:39]
ds_read_b64_tr_b16 v[144:145], v9 offset:16416
v_mfma_f32_16x16x32_bf16 v[56:59], v[188:191], v[164:167], v[56:59]
ds_read_b64_tr_b16 v[146:147], v9 offset:17696
v_mfma_f32_16x16x32_bf16 v[76:79], v[188:191], v[168:171], v[76:79]
v_mfma_f32_16x16x32_bf16 v[96:99], v[188:191], v[172:175], v[96:99]
v_mfma_f32_16x16x32_bf16 v[40:43], v[192:195], v[160:163], v[40:43]
v_mfma_f32_16x16x32_bf16 v[60:63], v[192:195], v[164:167], v[60:63]
v_mfma_f32_16x16x32_bf16 v[80:83], v[192:195], v[168:171], v[80:83]
v_mfma_f32_16x16x32_bf16 v[100:103], v[192:195], v[172:175], v[100:103]
s_waitcnt lgkmcnt(0)
v_mfma_f32_16x16x32_bf16 v[24:27], v[128:131], v[112:115], v[24:27]
ds_read_b64_tr_b16 v[176:177], v9 offset:21504
v_mfma_f32_16x16x32_bf16 v[44:47], v[128:131], v[116:119], v[44:47]
ds_read_b64_tr_b16 v[178:179], v9 offset:22784
v_mfma_f32_16x16x32_bf16 v[64:67], v[128:131], v[120:123], v[64:67]
ds_read_b128 v[160:163], v6 offset:0
v_mfma_f32_16x16x32_bf16 v[84:87], v[128:131], v[124:127], v[84:87]
ds_read_b128 v[164:167], v6 offset:2048
v_mfma_f32_16x16x32_bf16 v[28:31], v[132:135], v[112:115], v[28:31]
ds_read_b128 v[168:171], v6 offset:4096
v_mfma_f32_16x16x32_bf16 v[48:51], v[132:135], v[116:119], v[48:51]
ds_read_b128 v[172:175], v6 offset:6144
v_mfma_f32_16x16x32_bf16 v[68:71], v[132:135], v[120:123], v[68:71]
ds_read_b64_tr_b16 v[180:181], v9 offset:21512
v_mfma_f32_16x16x32_bf16 v[88:91], v[132:135], v[124:127], v[88:91]
ds_read_b64_tr_b16 v[182:183], v9 offset:22792
v_mfma_f32_16x16x32_bf16 v[32:35], v[136:139], v[112:115], v[32:35]
ds_read_b64_tr_b16 v[184:185], v9 offset:21520
v_mfma_f32_16x16x32_bf16 v[52:55], v[136:139], v[116:119], v[52:55]
ds_read_b64_tr_b16 v[186:187], v9 offset:22800
v_mfma_f32_16x16x32_bf16 v[72:75], v[136:139], v[120:123], v[72:75]
ds_read_b64_tr_b16 v[188:189], v9 offset:21528
v_mfma_f32_16x16x32_bf16 v[92:95], v[136:139], v[124:127], v[92:95]
ds_read_b64_tr_b16 v[190:191], v9 offset:22808
v_mfma_f32_16x16x32_bf16 v[36:39], v[140:143], v[112:115], v[36:39]
ds_read_b64_tr_b16 v[192:193], v9 offset:21536
v_mfma_f32_16x16x32_bf16 v[56:59], v[140:143], v[116:119], v[56:59]
ds_read_b64_tr_b16 v[194:195], v9 offset:22816
v_mfma_f32_16x16x32_bf16 v[76:79], v[140:143], v[120:123], v[76:79]
v_mfma_f32_16x16x32_bf16 v[96:99], v[140:143], v[124:127], v[96:99]
v_mfma_f32_16x16x32_bf16 v[40:43], v[144:147], v[112:115], v[40:43]
v_mfma_f32_16x16x32_bf16 v[60:63], v[144:147], v[116:119], v[60:63]
v_mfma_f32_16x16x32_bf16 v[80:83], v[144:147], v[120:123], v[80:83]
v_mfma_f32_16x16x32_bf16 v[100:103], v[144:147], v[124:127], v[100:103]
s_waitcnt lgkmcnt(0)
s_barrier
v_mfma_f32_16x16x32_bf16 v[24:27], v[176:179], v[160:163], v[24:27]
ds_read_b64_tr_b16 v[128:129], v9 offset:57344
v_mfma_f32_16x16x32_bf16 v[44:47], v[176:179], v[164:167], v[44:47]
ds_read_b64_tr_b16 v[130:131], v9 offset:58624
v_mfma_f32_16x16x32_bf16 v[64:67], v[176:179], v[168:171], v[64:67]
ds_read_b128 v[112:115], v5 offset:40960
v_mfma_f32_16x16x32_bf16 v[84:87], v[176:179], v[172:175], v[84:87]
ds_read_b128 v[116:119], v5 offset:43008
v_mfma_f32_16x16x32_bf16 v[28:31], v[180:183], v[160:163], v[28:31]
ds_read_b128 v[120:123], v5 offset:45056
v_mfma_f32_16x16x32_bf16 v[48:51], v[180:183], v[164:167], v[48:51]
ds_read_b128 v[124:127], v5 offset:47104
v_mfma_f32_16x16x32_bf16 v[68:71], v[180:183], v[168:171], v[68:71]
ds_read_b64_tr_b16 v[132:133], v9 offset:57352
v_mfma_f32_16x16x32_bf16 v[88:91], v[180:183], v[172:175], v[88:91]
ds_read_b64_tr_b16 v[134:135], v9 offset:58632
v_mfma_f32_16x16x32_bf16 v[32:35], v[184:187], v[160:163], v[32:35]
ds_read_b64_tr_b16 v[136:137], v9 offset:57360
v_mfma_f32_16x16x32_bf16 v[52:55], v[184:187], v[164:167], v[52:55]
ds_read_b64_tr_b16 v[138:139], v9 offset:58640
v_mfma_f32_16x16x32_bf16 v[72:75], v[184:187], v[168:171], v[72:75]
ds_read_b64_tr_b16 v[140:141], v9 offset:57368
v_mfma_f32_16x16x32_bf16 v[92:95], v[184:187], v[172:175], v[92:95]
ds_read_b64_tr_b16 v[142:143], v9 offset:58648
v_mfma_f32_16x16x32_bf16 v[36:39], v[188:191], v[160:163], v[36:39]
ds_read_b64_tr_b16 v[144:145], v9 offset:57376
v_mfma_f32_16x16x32_bf16 v[56:59], v[188:191], v[164:167], v[56:59]
ds_read_b64_tr_b16 v[146:147], v9 offset:58656
v_mfma_f32_16x16x32_bf16 v[76:79], v[188:191], v[168:171], v[76:79]
v_mfma_f32_16x16x32_bf16 v[96:99], v[188:191], v[172:175], v[96:99]
v_mfma_f32_16x16x32_bf16 v[40:43], v[192:195], v[160:163], v[40:43]
v_mfma_f32_16x16x32_bf16 v[60:63], v[192:195], v[164:167], v[60:63]
v_mfma_f32_16x16x32_bf16 v[80:83], v[192:195], v[168:171], v[80:83]
v_mfma_f32_16x16x32_bf16 v[100:103], v[192:195], v[172:175], v[100:103]
s_waitcnt lgkmcnt(0)
v_mfma_f32_16x16x32_bf16 v[24:27], v[128:131], v[112:115], v[24:27]
ds_read_b64_tr_b16 v[176:177], v9 offset:62464
v_mfma_f32_16x16x32_bf16 v[44:47], v[128:131], v[116:119], v[44:47]
ds_read_b64_tr_b16 v[178:179], v9 offset:63744
v_mfma_f32_16x16x32_bf16 v[64:67], v[128:131], v[120:123], v[64:67]
ds_read_b128 v[160:163], v6 offset:40960
v_mfma_f32_16x16x32_bf16 v[84:87], v[128:131], v[124:127], v[84:87]
ds_read_b128 v[164:167], v6 offset:43008
v_mfma_f32_16x16x32_bf16 v[28:31], v[132:135], v[112:115], v[28:31]
ds_read_b128 v[168:171], v6 offset:45056
v_mfma_f32_16x16x32_bf16 v[48:51], v[132:135], v[116:119], v[48:51]
ds_read_b128 v[172:175], v6 offset:47104
v_mfma_f32_16x16x32_bf16 v[68:71], v[132:135], v[120:123], v[68:71]
ds_read_b64_tr_b16 v[180:181], v9 offset:62472
v_mfma_f32_16x16x32_bf16 v[88:91], v[132:135], v[124:127], v[88:91]
ds_read_b64_tr_b16 v[182:183], v9 offset:63752
v_mfma_f32_16x16x32_bf16 v[32:35], v[136:139], v[112:115], v[32:35]
ds_read_b64_tr_b16 v[184:185], v9 offset:62480
v_mfma_f32_16x16x32_bf16 v[52:55], v[136:139], v[116:119], v[52:55]
ds_read_b64_tr_b16 v[186:187], v9 offset:63760
v_mfma_f32_16x16x32_bf16 v[72:75], v[136:139], v[120:123], v[72:75]
ds_read_b64_tr_b16 v[188:189], v9 offset:62488
v_mfma_f32_16x16x32_bf16 v[92:95], v[136:139], v[124:127], v[92:95]
ds_read_b64_tr_b16 v[190:191], v9 offset:63768
v_mfma_f32_16x16x32_bf16 v[36:39], v[140:143], v[112:115], v[36:39]
ds_read_b64_tr_b16 v[192:193], v9 offset:62496
v_mfma_f32_16x16x32_bf16 v[56:59], v[140:143], v[116:119], v[56:59]
ds_read_b64_tr_b16 v[194:195], v9 offset:63776
v_mfma_f32_16x16x32_bf16 v[76:79], v[140:143], v[120:123], v[76:79]
v_mfma_f32_16x16x32_bf16 v[96:99], v[140:143], v[124:127], v[96:99]
v_mfma_f32_16x16x32_bf16 v[40:43], v[144:147], v[112:115], v[40:43]
v_mfma_f32_16x16x32_bf16 v[60:63], v[144:147], v[116:119], v[60:63]
v_mfma_f32_16x16x32_bf16 v[80:83], v[144:147], v[120:123], v[80:83]
v_mfma_f32_16x16x32_bf16 v[100:103], v[144:147], v[124:127], v[100:103]
s_waitcnt lgkmcnt(0)
v_mfma_f32_16x16x32_bf16 v[24:27], v[176:179], v[160:163], v[24:27]
v_mfma_f32_16x16x32_bf16 v[44:47], v[176:179], v[164:167], v[44:47]
v_mfma_f32_16x16x32_bf16 v[64:67], v[176:179], v[168:171], v[64:67]
v_mfma_f32_16x16x32_bf16 v[84:87], v[176:179], v[172:175], v[84:87]
v_mfma_f32_16x16x32_bf16 v[28:31], v[180:183], v[160:163], v[28:31]
v_mfma_f32_16x16x32_bf16 v[48:51], v[180:183], v[164:167], v[48:51]
v_mfma_f32_16x16x32_bf16 v[68:71], v[180:183], v[168:171], v[68:71]
v_mfma_f32_16x16x32_bf16 v[88:91], v[180:183], v[172:175], v[88:91]
v_mfma_f32_16x16x32_bf16 v[32:35], v[184:187], v[160:163], v[32:35]
v_mfma_f32_16x16x32_bf16 v[52:55], v[184:187], v[164:167], v[52:55]
v_mfma_f32_16x16x32_bf16 v[72:75], v[184:187], v[168:171], v[72:75]
v_mfma_f32_16x16x32_bf16 v[92:95], v[184:187], v[172:175], v[92:95]
v_mfma_f32_16x16x32_bf16 v[36:39], v[188:191], v[160:163], v[36:39]
v_mfma_f32_16x16x32_bf16 v[56:59], v[188:191], v[164:167], v[56:59]
v_mfma_f32_16x16x32_bf16 v[76:79], v[188:191], v[168:171], v[76:79]
v_mfma_f32_16x16x32_bf16 v[96:99], v[188:191], v[172:175], v[96:99]
v_mfma_f32_16x16x32_bf16 v[40:43], v[192:195], v[160:163], v[40:43]
v_mfma_f32_16x16x32_bf16 v[60:63], v[192:195], v[164:167], v[60:63]
v_mfma_f32_16x16x32_bf16 v[80:83], v[192:195], v[168:171], v[80:83]
v_mfma_f32_16x16x32_bf16 v[100:103], v[192:195], v[172:175], v[100:103]
s_cmp_eq_u32 s8, 1
s_cselect_b32 s49, 2, 1
s_mul_i32 s49, s49, 1280
s_mul_i32 s48, s49, 64
s_cselect_b32 s50, 0, 6291456
s_cselect_b32 s52, 1.0, 1051011932
s_mov_b32 s53, s52
s_cmp_eq_u32 s8, 3
s_cselect_b32 s51, 32, 0
s_add_u32 s51, s51, s58
s_mul_i32 s51, s51, s48
s_add_u32 s50, s50, s51
s_mul_i32 s51, s56, s49
s_add_u32 s50, s50, s51
v_mul_lo_u32 v17, v3, s48
v_lshl_add_u32 v18, v2, 4, v17
v_lshl_add_u32 v19, v2, 3, v17
v_pk_mul_f32 v[24:25], v[24:25], s[52:53]
v_pk_mul_f32 v[26:27], v[26:27], s[52:53]
v_pk_mul_f32 v[28:29], v[28:29], s[52:53]
v_pk_mul_f32 v[30:31], v[30:31], s[52:53]
v_pk_mul_f32 v[32:33], v[32:33], s[52:53]
v_pk_mul_f32 v[34:35], v[34:35], s[52:53]
v_pk_mul_f32 v[36:37], v[36:37], s[52:53]
v_pk_mul_f32 v[38:39], v[38:39], s[52:53]
v_pk_mul_f32 v[40:41], v[40:41], s[52:53]
v_pk_mul_f32 v[42:43], v[42:43], s[52:53]
v_cvt_pk_bf16_f32 v24, v24, v25
v_cvt_pk_bf16_f32 v25, v26, v27
v_cvt_pk_bf16_f32 v26, v28, v29
v_cvt_pk_bf16_f32 v27, v30, v31
v_cvt_pk_bf16_f32 v28, v32, v33
v_cvt_pk_bf16_f32 v29, v34, v35
v_cvt_pk_bf16_f32 v30, v36, v37
v_cvt_pk_bf16_f32 v31, v38, v39
v_cvt_pk_bf16_f32 v32, v40, v41
v_cvt_pk_bf16_f32 v33, v42, v43
buffer_store_dwordx4 v[24:27], v18, s[44:47], s50 offen offset:0 sc1
buffer_store_dwordx4 v[28:31], v18, s[44:47], s50 offen offset:512 sc1
buffer_store_dwordx2 v[32:33], v19, s[44:47], s50 offen offset:1024 sc1
v_pk_mul_f32 v[44:45], v[44:45], s[52:53]
v_pk_mul_f32 v[46:47], v[46:47], s[52:53]
v_pk_mul_f32 v[48:49], v[48:49], s[52:53]
v_pk_mul_f32 v[50:51], v[50:51], s[52:53]
v_pk_mul_f32 v[52:53], v[52:53], s[52:53]
v_pk_mul_f32 v[54:55], v[54:55], s[52:53]
v_pk_mul_f32 v[56:57], v[56:57], s[52:53]
v_pk_mul_f32 v[58:59], v[58:59], s[52:53]
v_pk_mul_f32 v[60:61], v[60:61], s[52:53]
v_pk_mul_f32 v[62:63], v[62:63], s[52:53]
v_cvt_pk_bf16_f32 v44, v44, v45
v_cvt_pk_bf16_f32 v45, v46, v47
v_cvt_pk_bf16_f32 v46, v48, v49
v_cvt_pk_bf16_f32 v47, v50, v51
v_cvt_pk_bf16_f32 v48, v52, v53
v_cvt_pk_bf16_f32 v49, v54, v55
v_cvt_pk_bf16_f32 v50, v56, v57
v_cvt_pk_bf16_f32 v51, v58, v59
v_cvt_pk_bf16_f32 v52, v60, v61
v_cvt_pk_bf16_f32 v53, v62, v63
buffer_store_dwordx4 v[44:47], v18, s[44:47], s50 offen offset:256 sc1
buffer_store_dwordx4 v[48:51], v18, s[44:47], s50 offen offset:768 sc1
buffer_store_dwordx2 v[52:53], v19, s[44:47], s50 offen offset:1152 sc1
v_pk_mul_f32 v[64:65], v[64:65], s[52:53]
v_pk_mul_f32 v[66:67], v[66:67], s[52:53]
v_pk_mul_f32 v[68:69], v[68:69], s[52:53]
v_pk_mul_f32 v[70:71], v[70:71], s[52:53]
v_pk_mul_f32 v[72:73], v[72:73], s[52:53]
v_pk_mul_f32 v[74:75], v[74:75], s[52:53]
v_pk_mul_f32 v[76:77], v[76:77], s[52:53]
v_pk_mul_f32 v[78:79], v[78:79], s[52:53]
v_pk_mul_f32 v[80:81], v[80:81], s[52:53]
v_pk_mul_f32 v[82:83], v[82:83], s[52:53]
v_cvt_pk_bf16_f32 v64, v64, v65
v_cvt_pk_bf16_f32 v65, v66, v67
v_cvt_pk_bf16_f32 v66, v68, v69
v_cvt_pk_bf16_f32 v67, v70, v71
v_cvt_pk_bf16_f32 v68, v72, v73
v_cvt_pk_bf16_f32 v69, v74, v75
v_cvt_pk_bf16_f32 v70, v76, v77
v_cvt_pk_bf16_f32 v71, v78, v79
v_cvt_pk_bf16_f32 v72, v80, v81
v_cvt_pk_bf16_f32 v73, v82, v83
s_add_u32 s50, s50, s49
buffer_store_dwordx4 v[64:67], v18, s[44:47], s50 offen offset:0 sc1
buffer_store_dwordx4 v[68:71], v18, s[44:47], s50 offen offset:512 sc1
buffer_store_dwordx2 v[72:73], v19, s[44:47], s50 offen offset:1024 sc1
v_pk_mul_f32 v[84:85], v[84:85], s[52:53]
v_pk_mul_f32 v[86:87], v[86:87], s[52:53]
v_pk_mul_f32 v[88:89], v[88:89], s[52:53]
v_pk_mul_f32 v[90:91], v[90:91], s[52:53]
v_pk_mul_f32 v[92:93], v[92:93], s[52:53]
v_pk_mul_f32 v[94:95], v[94:95], s[52:53]
v_pk_mul_f32 v[96:97], v[96:97], s[52:53]
v_pk_mul_f32 v[98:99], v[98:99], s[52:53]
v_pk_mul_f32 v[100:101], v[100:101], s[52:53]
v_pk_mul_f32 v[102:103], v[102:103], s[52:53]
v_cvt_pk_bf16_f32 v84, v84, v85
v_cvt_pk_bf16_f32 v85, v86, v87
v_cvt_pk_bf16_f32 v86, v88, v89
v_cvt_pk_bf16_f32 v87, v90, v91
v_cvt_pk_bf16_f32 v88, v92, v93
v_cvt_pk_bf16_f32 v89, v94, v95
v_cvt_pk_bf16_f32 v90, v96, v97
v_cvt_pk_bf16_f32 v91, v98, v99
v_cvt_pk_bf16_f32 v92, v100, v101
v_cvt_pk_bf16_f32 v93, v102, v103
buffer_store_dwordx4 v[84:87], v18, s[44:47], s50 offen offset:256 sc1
buffer_store_dwordx4 v[88:91], v18, s[44:47], s50 offen offset:768 sc1
buffer_store_dwordx2 v[92:93], v19, s[44:47], s50 offen offset:1152 sc1
s_nop 1
s_branch attn
concat_heads__mha_block__grouped_kv_mqa__prompt_kernel_QK2:
v_add_u32 v15, 36864, v15
v_add_u32 v16, 36864, v16
s_barrier
ds_read_b64_tr_b16 v[128:129], v9 offset:16384
ds_read_b64_tr_b16 v[130:131], v9 offset:17664
ds_read_b128 v[112:115], v5 offset:0
ds_read_b128 v[116:119], v5 offset:2048
ds_read_b128 v[120:123], v5 offset:4096
ds_read_b128 v[124:127], v5 offset:6144
ds_read_b64_tr_b16 v[132:133], v9 offset:16392
ds_read_b64_tr_b16 v[134:135], v9 offset:17672
ds_read_b64_tr_b16 v[136:137], v9 offset:16400
ds_read_b64_tr_b16 v[138:139], v9 offset:17680
ds_read_b64_tr_b16 v[140:141], v9 offset:16408
ds_read_b64_tr_b16 v[142:143], v9 offset:17688
ds_read_b64_tr_b16 v[144:145], v9 offset:16416
ds_read_b64_tr_b16 v[146:147], v9 offset:17696
s_waitcnt lgkmcnt(8)
ds_read_b128 v[148:151], v11 offset:0
ds_read_b64_tr_b16 v[152:153], v15 offset:0
ds_read_b64_tr_b16 v[154:155], v15 offset:160
ds_read_b64_tr_b16 v[156:157], v15 offset:32
ds_read_b64_tr_b16 v[158:159], v15 offset:192
s_waitcnt lgkmcnt(13)
v_mfma_f32_16x16x32_bf16 v[24:27], v[128:131], v[112:115], 0
v_mfma_f32_16x16x32_bf16 v[44:47], v[128:131], v[116:119], 0
v_mfma_f32_16x16x32_bf16 v[64:67], v[128:131], v[120:123], 0
v_mfma_f32_16x16x32_bf16 v[84:87], v[128:131], v[124:127], 0
s_waitcnt lgkmcnt(0)
ds_read_b64_tr_b16 v[176:177], v9 offset:21504
ds_read_b64_tr_b16 v[178:179], v9 offset:22784
v_mfma_f32_16x16x32_bf16 v[28:31], v[132:135], v[112:115], 0
ds_read_b128 v[160:163], v6 offset:0
v_mfma_f32_16x16x32_bf16 v[48:51], v[132:135], v[116:119], 0
ds_read_b128 v[164:167], v6 offset:2048
v_mfma_f32_16x16x32_bf16 v[68:71], v[132:135], v[120:123], 0
ds_read_b128 v[168:171], v6 offset:4096
v_mfma_f32_16x16x32_bf16 v[88:91], v[132:135], v[124:127], 0
ds_read_b128 v[172:175], v6 offset:6144
v_mfma_f32_16x16x32_bf16 v[32:35], v[136:139], v[112:115], 0
ds_read_b64_tr_b16 v[180:181], v9 offset:21512
v_mfma_f32_16x16x32_bf16 v[52:55], v[136:139], v[116:119], 0
ds_read_b64_tr_b16 v[182:183], v9 offset:22792
v_mfma_f32_16x16x32_bf16 v[72:75], v[136:139], v[120:123], 0
ds_read_b64_tr_b16 v[184:185], v9 offset:21520
v_mfma_f32_16x16x32_bf16 v[92:95], v[136:139], v[124:127], 0
ds_read_b64_tr_b16 v[186:187], v9 offset:22800
v_mfma_f32_16x16x32_bf16 v[36:39], v[140:143], v[112:115], 0
ds_read_b64_tr_b16 v[188:189], v9 offset:21528
v_mfma_f32_16x16x32_bf16 v[56:59], v[140:143], v[116:119], 0
ds_read_b64_tr_b16 v[190:191], v9 offset:22808
v_mfma_f32_16x16x32_bf16 v[76:79], v[140:143], v[120:123], 0
ds_read_b64_tr_b16 v[192:193], v9 offset:21536
v_mfma_f32_16x16x32_bf16 v[96:99], v[140:143], v[124:127], 0
ds_read_b64_tr_b16 v[194:195], v9 offset:22816
v_mfma_f32_16x16x32_bf16 v[40:43], v[144:147], v[112:115], 0
s_waitcnt lgkmcnt(8)
v_mfma_f32_16x16x32_bf16 v[60:63], v[144:147], v[116:119], 0
ds_read_b128 v[196:199], v12 offset:0
v_mfma_f32_16x16x32_bf16 v[80:83], v[144:147], v[120:123], 0
ds_read_b64_tr_b16 v[200:201], v15 offset:1280
v_mfma_f32_16x16x32_bf16 v[100:103], v[144:147], v[124:127], 0
ds_read_b64_tr_b16 v[202:203], v15 offset:1440
v_mfma_f32_16x16x32_bf16 v[104:107], v[148:151], v[152:155], 0
ds_read_b64_tr_b16 v[204:205], v15 offset:1312
v_mfma_f32_16x16x32_bf16 v[108:111], v[148:151], v[156:159], 0
ds_read_b64_tr_b16 v[206:207], v15 offset:1472
s_waitcnt lgkmcnt(13)
v_mfma_f32_16x16x32_bf16 v[24:27], v[176:179], v[160:163], v[24:27]
v_mfma_f32_16x16x32_bf16 v[44:47], v[176:179], v[164:167], v[44:47]
v_mfma_f32_16x16x32_bf16 v[64:67], v[176:179], v[168:171], v[64:67]
v_mfma_f32_16x16x32_bf16 v[84:87], v[176:179], v[172:175], v[84:87]
s_waitcnt lgkmcnt(0)
s_barrier
ds_read_b64_tr_b16 v[128:129], v9 offset:57344
ds_read_b64_tr_b16 v[130:131], v9 offset:58624
v_mfma_f32_16x16x32_bf16 v[28:31], v[180:183], v[160:163], v[28:31]
ds_read_b128 v[112:115], v5 offset:40960
v_mfma_f32_16x16x32_bf16 v[48:51], v[180:183], v[164:167], v[48:51]
ds_read_b128 v[116:119], v5 offset:43008
v_mfma_f32_16x16x32_bf16 v[68:71], v[180:183], v[168:171], v[68:71]
ds_read_b128 v[120:123], v5 offset:45056
v_mfma_f32_16x16x32_bf16 v[88:91], v[180:183], v[172:175], v[88:91]
ds_read_b128 v[124:127], v5 offset:47104
v_mfma_f32_16x16x32_bf16 v[32:35], v[184:187], v[160:163], v[32:35]
ds_read_b64_tr_b16 v[132:133], v9 offset:57352
v_mfma_f32_16x16x32_bf16 v[52:55], v[184:187], v[164:167], v[52:55]
ds_read_b64_tr_b16 v[134:135], v9 offset:58632
v_mfma_f32_16x16x32_bf16 v[72:75], v[184:187], v[168:171], v[72:75]
ds_read_b64_tr_b16 v[136:137], v9 offset:57360
v_mfma_f32_16x16x32_bf16 v[92:95], v[184:187], v[172:175], v[92:95]
ds_read_b64_tr_b16 v[138:139], v9 offset:58640
v_mfma_f32_16x16x32_bf16 v[36:39], v[188:191], v[160:163], v[36:39]
ds_read_b64_tr_b16 v[140:141], v9 offset:57368
v_mfma_f32_16x16x32_bf16 v[56:59], v[188:191], v[164:167], v[56:59]
ds_read_b64_tr_b16 v[142:143], v9 offset:58648
v_mfma_f32_16x16x32_bf16 v[76:79], v[188:191], v[168:171], v[76:79]
ds_read_b64_tr_b16 v[144:145], v9 offset:57376
v_mfma_f32_16x16x32_bf16 v[96:99], v[188:191], v[172:175], v[96:99]
ds_read_b64_tr_b16 v[146:147], v9 offset:58656
v_mfma_f32_16x16x32_bf16 v[40:43], v[192:195], v[160:163], v[40:43]
s_waitcnt lgkmcnt(8)
v_mfma_f32_16x16x32_bf16 v[60:63], v[192:195], v[164:167], v[60:63]
ds_read_b128 v[148:151], v11 offset:40960
v_mfma_f32_16x16x32_bf16 v[80:83], v[192:195], v[168:171], v[80:83]
ds_read_b64_tr_b16 v[152:153], v15 offset:40960
v_mfma_f32_16x16x32_bf16 v[100:103], v[192:195], v[172:175], v[100:103]
ds_read_b64_tr_b16 v[154:155], v15 offset:41120
v_mfma_f32_16x16x32_bf16 v[104:107], v[196:199], v[200:203], v[104:107]
ds_read_b64_tr_b16 v[156:157], v15 offset:40992
v_mfma_f32_16x16x32_bf16 v[108:111], v[196:199], v[204:207], v[108:111]
ds_read_b64_tr_b16 v[158:159], v15 offset:41152
s_waitcnt lgkmcnt(13)
v_mfma_f32_16x16x32_bf16 v[24:27], v[128:131], v[112:115], v[24:27]
v_mfma_f32_16x16x32_bf16 v[44:47], v[128:131], v[116:119], v[44:47]
v_mfma_f32_16x16x32_bf16 v[64:67], v[128:131], v[120:123], v[64:67]
v_mfma_f32_16x16x32_bf16 v[84:87], v[128:131], v[124:127], v[84:87]
s_waitcnt lgkmcnt(0)
ds_read_b64_tr_b16 v[176:177], v9 offset:62464
ds_read_b64_tr_b16 v[178:179], v9 offset:63744
v_mfma_f32_16x16x32_bf16 v[28:31], v[132:135], v[112:115], v[28:31]
ds_read_b128 v[160:163], v6 offset:40960
v_mfma_f32_16x16x32_bf16 v[48:51], v[132:135], v[116:119], v[48:51]
ds_read_b128 v[164:167], v6 offset:43008
v_mfma_f32_16x16x32_bf16 v[68:71], v[132:135], v[120:123], v[68:71]
ds_read_b128 v[168:171], v6 offset:45056
v_mfma_f32_16x16x32_bf16 v[88:91], v[132:135], v[124:127], v[88:91]
ds_read_b128 v[172:175], v6 offset:47104
v_mfma_f32_16x16x32_bf16 v[32:35], v[136:139], v[112:115], v[32:35]
ds_read_b64_tr_b16 v[180:181], v9 offset:62472
v_mfma_f32_16x16x32_bf16 v[52:55], v[136:139], v[116:119], v[52:55]
ds_read_b64_tr_b16 v[182:183], v9 offset:63752
v_mfma_f32_16x16x32_bf16 v[72:75], v[136:139], v[120:123], v[72:75]
ds_read_b64_tr_b16 v[184:185], v9 offset:62480
v_mfma_f32_16x16x32_bf16 v[92:95], v[136:139], v[124:127], v[92:95]
ds_read_b64_tr_b16 v[186:187], v9 offset:63760
v_mfma_f32_16x16x32_bf16 v[36:39], v[140:143], v[112:115], v[36:39]
ds_read_b64_tr_b16 v[188:189], v9 offset:62488
v_mfma_f32_16x16x32_bf16 v[56:59], v[140:143], v[116:119], v[56:59]
ds_read_b64_tr_b16 v[190:191], v9 offset:63768
v_mfma_f32_16x16x32_bf16 v[76:79], v[140:143], v[120:123], v[76:79]
ds_read_b64_tr_b16 v[192:193], v9 offset:62496
v_mfma_f32_16x16x32_bf16 v[96:99], v[140:143], v[124:127], v[96:99]
ds_read_b64_tr_b16 v[194:195], v9 offset:63776
v_mfma_f32_16x16x32_bf16 v[40:43], v[144:147], v[112:115], v[40:43]
s_waitcnt lgkmcnt(8)
v_mfma_f32_16x16x32_bf16 v[60:63], v[144:147], v[116:119], v[60:63]
ds_read_b128 v[196:199], v12 offset:40960
v_mfma_f32_16x16x32_bf16 v[80:83], v[144:147], v[120:123], v[80:83]
ds_read_b64_tr_b16 v[200:201], v15 offset:42240
v_mfma_f32_16x16x32_bf16 v[100:103], v[144:147], v[124:127], v[100:103]
ds_read_b64_tr_b16 v[202:203], v15 offset:42400
v_mfma_f32_16x16x32_bf16 v[104:107], v[148:151], v[152:155], v[104:107]
ds_read_b64_tr_b16 v[204:205], v15 offset:42272
v_mfma_f32_16x16x32_bf16 v[108:111], v[148:151], v[156:159], v[108:111]
ds_read_b64_tr_b16 v[206:207], v15 offset:42432
s_waitcnt lgkmcnt(13)
v_mfma_f32_16x16x32_bf16 v[24:27], v[176:179], v[160:163], v[24:27]
v_mfma_f32_16x16x32_bf16 v[44:47], v[176:179], v[164:167], v[44:47]
v_mfma_f32_16x16x32_bf16 v[64:67], v[176:179], v[168:171], v[64:67]
v_mfma_f32_16x16x32_bf16 v[84:87], v[176:179], v[172:175], v[84:87]
s_waitcnt lgkmcnt(0)
s_barrier
ds_read_b64_tr_b16 v[128:129], v10 offset:16384
ds_read_b64_tr_b16 v[130:131], v10 offset:17664
v_mfma_f32_16x16x32_bf16 v[28:31], v[180:183], v[160:163], v[28:31]
ds_read_b128 v[112:115], v7 offset:0
v_mfma_f32_16x16x32_bf16 v[48:51], v[180:183], v[164:167], v[48:51]
ds_read_b128 v[116:119], v7 offset:2048
v_mfma_f32_16x16x32_bf16 v[68:71], v[180:183], v[168:171], v[68:71]
ds_read_b128 v[120:123], v7 offset:4096
v_mfma_f32_16x16x32_bf16 v[88:91], v[180:183], v[172:175], v[88:91]
ds_read_b128 v[124:127], v7 offset:6144
v_mfma_f32_16x16x32_bf16 v[32:35], v[184:187], v[160:163], v[32:35]
ds_read_b64_tr_b16 v[132:133], v10 offset:16392
v_mfma_f32_16x16x32_bf16 v[52:55], v[184:187], v[164:167], v[52:55]
ds_read_b64_tr_b16 v[134:135], v10 offset:17672
v_mfma_f32_16x16x32_bf16 v[72:75], v[184:187], v[168:171], v[72:75]
ds_read_b64_tr_b16 v[136:137], v10 offset:16400
v_mfma_f32_16x16x32_bf16 v[92:95], v[184:187], v[172:175], v[92:95]
ds_read_b64_tr_b16 v[138:139], v10 offset:17680
v_mfma_f32_16x16x32_bf16 v[36:39], v[188:191], v[160:163], v[36:39]
ds_read_b64_tr_b16 v[140:141], v10 offset:16408
v_mfma_f32_16x16x32_bf16 v[56:59], v[188:191], v[164:167], v[56:59]
ds_read_b64_tr_b16 v[142:143], v10 offset:17688
v_mfma_f32_16x16x32_bf16 v[76:79], v[188:191], v[168:171], v[76:79]
ds_read_b64_tr_b16 v[144:145], v10 offset:16416
v_mfma_f32_16x16x32_bf16 v[96:99], v[188:191], v[172:175], v[96:99]
ds_read_b64_tr_b16 v[146:147], v10 offset:17696
v_mfma_f32_16x16x32_bf16 v[40:43], v[192:195], v[160:163], v[40:43]
s_waitcnt lgkmcnt(8)
v_mfma_f32_16x16x32_bf16 v[60:63], v[192:195], v[164:167], v[60:63]
ds_read_b128 v[148:151], v13 offset:0
v_mfma_f32_16x16x32_bf16 v[80:83], v[192:195], v[168:171], v[80:83]
ds_read_b64_tr_b16 v[152:153], v16 offset:0
v_mfma_f32_16x16x32_bf16 v[100:103], v[192:195], v[172:175], v[100:103]
ds_read_b64_tr_b16 v[154:155], v16 offset:160
v_mfma_f32_16x16x32_bf16 v[104:107], v[196:199], v[200:203], v[104:107]
ds_read_b64_tr_b16 v[156:157], v16 offset:32
v_mfma_f32_16x16x32_bf16 v[108:111], v[196:199], v[204:207], v[108:111]
ds_read_b64_tr_b16 v[158:159], v16 offset:192
s_waitcnt lgkmcnt(13)
v_mfma_f32_16x16x32_bf16 v[24:27], v[128:131], v[112:115], v[24:27]
v_mfma_f32_16x16x32_bf16 v[44:47], v[128:131], v[116:119], v[44:47]
v_mfma_f32_16x16x32_bf16 v[64:67], v[128:131], v[120:123], v[64:67]
v_mfma_f32_16x16x32_bf16 v[84:87], v[128:131], v[124:127], v[84:87]
s_waitcnt lgkmcnt(0)
ds_read_b64_tr_b16 v[176:177], v10 offset:21504
ds_read_b64_tr_b16 v[178:179], v10 offset:22784
v_mfma_f32_16x16x32_bf16 v[28:31], v[132:135], v[112:115], v[28:31]
ds_read_b128 v[160:163], v8 offset:0
v_mfma_f32_16x16x32_bf16 v[48:51], v[132:135], v[116:119], v[48:51]
ds_read_b128 v[164:167], v8 offset:2048
v_mfma_f32_16x16x32_bf16 v[68:71], v[132:135], v[120:123], v[68:71]
ds_read_b128 v[168:171], v8 offset:4096
v_mfma_f32_16x16x32_bf16 v[88:91], v[132:135], v[124:127], v[88:91]
ds_read_b128 v[172:175], v8 offset:6144
v_mfma_f32_16x16x32_bf16 v[32:35], v[136:139], v[112:115], v[32:35]
ds_read_b64_tr_b16 v[180:181], v10 offset:21512
v_mfma_f32_16x16x32_bf16 v[52:55], v[136:139], v[116:119], v[52:55]
ds_read_b64_tr_b16 v[182:183], v10 offset:22792
v_mfma_f32_16x16x32_bf16 v[72:75], v[136:139], v[120:123], v[72:75]
ds_read_b64_tr_b16 v[184:185], v10 offset:21520
v_mfma_f32_16x16x32_bf16 v[92:95], v[136:139], v[124:127], v[92:95]
ds_read_b64_tr_b16 v[186:187], v10 offset:22800
v_mfma_f32_16x16x32_bf16 v[36:39], v[140:143], v[112:115], v[36:39]
ds_read_b64_tr_b16 v[188:189], v10 offset:21528
v_mfma_f32_16x16x32_bf16 v[56:59], v[140:143], v[116:119], v[56:59]
ds_read_b64_tr_b16 v[190:191], v10 offset:22808
v_mfma_f32_16x16x32_bf16 v[76:79], v[140:143], v[120:123], v[76:79]
ds_read_b64_tr_b16 v[192:193], v10 offset:21536
v_mfma_f32_16x16x32_bf16 v[96:99], v[140:143], v[124:127], v[96:99]
ds_read_b64_tr_b16 v[194:195], v10 offset:22816
v_mfma_f32_16x16x32_bf16 v[40:43], v[144:147], v[112:115], v[40:43]
s_waitcnt lgkmcnt(8)
v_mfma_f32_16x16x32_bf16 v[60:63], v[144:147], v[116:119], v[60:63]
ds_read_b128 v[196:199], v14 offset:0
v_mfma_f32_16x16x32_bf16 v[80:83], v[144:147], v[120:123], v[80:83]
ds_read_b64_tr_b16 v[200:201], v16 offset:1280
v_mfma_f32_16x16x32_bf16 v[100:103], v[144:147], v[124:127], v[100:103]
ds_read_b64_tr_b16 v[202:203], v16 offset:1440
v_mfma_f32_16x16x32_bf16 v[104:107], v[148:151], v[152:155], v[104:107]
ds_read_b64_tr_b16 v[204:205], v16 offset:1312
v_mfma_f32_16x16x32_bf16 v[108:111], v[148:151], v[156:159], v[108:111]
ds_read_b64_tr_b16 v[206:207], v16 offset:1472
s_waitcnt lgkmcnt(13)
v_mfma_f32_16x16x32_bf16 v[24:27], v[176:179], v[160:163], v[24:27]
v_mfma_f32_16x16x32_bf16 v[44:47], v[176:179], v[164:167], v[44:47]
v_mfma_f32_16x16x32_bf16 v[64:67], v[176:179], v[168:171], v[64:67]
v_mfma_f32_16x16x32_bf16 v[84:87], v[176:179], v[172:175], v[84:87]
s_waitcnt lgkmcnt(0)
s_barrier
ds_read_b64_tr_b16 v[128:129], v10 offset:57344
ds_read_b64_tr_b16 v[130:131], v10 offset:58624
v_mfma_f32_16x16x32_bf16 v[28:31], v[180:183], v[160:163], v[28:31]
ds_read_b128 v[112:115], v7 offset:40960
v_mfma_f32_16x16x32_bf16 v[48:51], v[180:183], v[164:167], v[48:51]
ds_read_b128 v[116:119], v7 offset:43008
v_mfma_f32_16x16x32_bf16 v[68:71], v[180:183], v[168:171], v[68:71]
ds_read_b128 v[120:123], v7 offset:45056
v_mfma_f32_16x16x32_bf16 v[88:91], v[180:183], v[172:175], v[88:91]
ds_read_b128 v[124:127], v7 offset:47104
v_mfma_f32_16x16x32_bf16 v[32:35], v[184:187], v[160:163], v[32:35]
ds_read_b64_tr_b16 v[132:133], v10 offset:57352
v_mfma_f32_16x16x32_bf16 v[52:55], v[184:187], v[164:167], v[52:55]
ds_read_b64_tr_b16 v[134:135], v10 offset:58632
v_mfma_f32_16x16x32_bf16 v[72:75], v[184:187], v[168:171], v[72:75]
ds_read_b64_tr_b16 v[136:137], v10 offset:57360
v_mfma_f32_16x16x32_bf16 v[92:95], v[184:187], v[172:175], v[92:95]
ds_read_b64_tr_b16 v[138:139], v10 offset:58640
v_mfma_f32_16x16x32_bf16 v[36:39], v[188:191], v[160:163], v[36:39]
ds_read_b64_tr_b16 v[140:141], v10 offset:57368
v_mfma_f32_16x16x32_bf16 v[56:59], v[188:191], v[164:167], v[56:59]
ds_read_b64_tr_b16 v[142:143], v10 offset:58648
v_mfma_f32_16x16x32_bf16 v[76:79], v[188:191], v[168:171], v[76:79]
ds_read_b64_tr_b16 v[144:145], v10 offset:57376
v_mfma_f32_16x16x32_bf16 v[96:99], v[188:191], v[172:175], v[96:99]
ds_read_b64_tr_b16 v[146:147], v10 offset:58656
v_mfma_f32_16x16x32_bf16 v[40:43], v[192:195], v[160:163], v[40:43]
s_waitcnt lgkmcnt(8)
v_mfma_f32_16x16x32_bf16 v[60:63], v[192:195], v[164:167], v[60:63]
ds_read_b128 v[148:151], v13 offset:40960
v_mfma_f32_16x16x32_bf16 v[80:83], v[192:195], v[168:171], v[80:83]
ds_read_b64_tr_b16 v[152:153], v16 offset:40960
v_mfma_f32_16x16x32_bf16 v[100:103], v[192:195], v[172:175], v[100:103]
ds_read_b64_tr_b16 v[154:155], v16 offset:41120
v_mfma_f32_16x16x32_bf16 v[104:107], v[196:199], v[200:203], v[104:107]
ds_read_b64_tr_b16 v[156:157], v16 offset:40992
v_mfma_f32_16x16x32_bf16 v[108:111], v[196:199], v[204:207], v[108:111]
ds_read_b64_tr_b16 v[158:159], v16 offset:41152
s_waitcnt lgkmcnt(13)
v_mfma_f32_16x16x32_bf16 v[24:27], v[128:131], v[112:115], v[24:27]
v_mfma_f32_16x16x32_bf16 v[44:47], v[128:131], v[116:119], v[44:47]
v_mfma_f32_16x16x32_bf16 v[64:67], v[128:131], v[120:123], v[64:67]
v_mfma_f32_16x16x32_bf16 v[84:87], v[128:131], v[124:127], v[84:87]
s_waitcnt lgkmcnt(0)
ds_read_b64_tr_b16 v[176:177], v10 offset:62464
ds_read_b64_tr_b16 v[178:179], v10 offset:63744
v_mfma_f32_16x16x32_bf16 v[28:31], v[132:135], v[112:115], v[28:31]
ds_read_b128 v[160:163], v8 offset:40960
v_mfma_f32_16x16x32_bf16 v[48:51], v[132:135], v[116:119], v[48:51]
ds_read_b128 v[164:167], v8 offset:43008
v_mfma_f32_16x16x32_bf16 v[68:71], v[132:135], v[120:123], v[68:71]
ds_read_b128 v[168:171], v8 offset:45056
v_mfma_f32_16x16x32_bf16 v[88:91], v[132:135], v[124:127], v[88:91]
ds_read_b128 v[172:175], v8 offset:47104
v_mfma_f32_16x16x32_bf16 v[32:35], v[136:139], v[112:115], v[32:35]
ds_read_b64_tr_b16 v[180:181], v10 offset:62472
v_mfma_f32_16x16x32_bf16 v[52:55], v[136:139], v[116:119], v[52:55]
ds_read_b64_tr_b16 v[182:183], v10 offset:63752
v_mfma_f32_16x16x32_bf16 v[72:75], v[136:139], v[120:123], v[72:75]
ds_read_b64_tr_b16 v[184:185], v10 offset:62480
v_mfma_f32_16x16x32_bf16 v[92:95], v[136:139], v[124:127], v[92:95]
ds_read_b64_tr_b16 v[186:187], v10 offset:63760
v_mfma_f32_16x16x32_bf16 v[36:39], v[140:143], v[112:115], v[36:39]
ds_read_b64_tr_b16 v[188:189], v10 offset:62488
v_mfma_f32_16x16x32_bf16 v[56:59], v[140:143], v[116:119], v[56:59]
ds_read_b64_tr_b16 v[190:191], v10 offset:63768
v_mfma_f32_16x16x32_bf16 v[76:79], v[140:143], v[120:123], v[76:79]
ds_read_b64_tr_b16 v[192:193], v10 offset:62496
v_mfma_f32_16x16x32_bf16 v[96:99], v[140:143], v[124:127], v[96:99]
ds_read_b64_tr_b16 v[194:195], v10 offset:63776
v_mfma_f32_16x16x32_bf16 v[40:43], v[144:147], v[112:115], v[40:43]
s_waitcnt lgkmcnt(8)
v_mfma_f32_16x16x32_bf16 v[60:63], v[144:147], v[116:119], v[60:63]
ds_read_b128 v[196:199], v14 offset:40960
v_mfma_f32_16x16x32_bf16 v[80:83], v[144:147], v[120:123], v[80:83]
ds_read_b64_tr_b16 v[200:201], v16 offset:42240
v_mfma_f32_16x16x32_bf16 v[100:103], v[144:147], v[124:127], v[100:103]
ds_read_b64_tr_b16 v[202:203], v16 offset:42400
v_mfma_f32_16x16x32_bf16 v[104:107], v[148:151], v[152:155], v[104:107]
ds_read_b64_tr_b16 v[204:205], v16 offset:42272
v_mfma_f32_16x16x32_bf16 v[108:111], v[148:151], v[156:159], v[108:111]
ds_read_b64_tr_b16 v[206:207], v16 offset:42432
s_waitcnt lgkmcnt(13)
v_mfma_f32_16x16x32_bf16 v[24:27], v[176:179], v[160:163], v[24:27]
v_mfma_f32_16x16x32_bf16 v[44:47], v[176:179], v[164:167], v[44:47]
v_mfma_f32_16x16x32_bf16 v[64:67], v[176:179], v[168:171], v[64:67]
v_mfma_f32_16x16x32_bf16 v[84:87], v[176:179], v[172:175], v[84:87]
s_waitcnt lgkmcnt(0)
s_barrier
ds_read_b64_tr_b16 v[128:129], v9 offset:16384
ds_read_b64_tr_b16 v[130:131], v9 offset:17664
v_mfma_f32_16x16x32_bf16 v[28:31], v[180:183], v[160:163], v[28:31]
ds_read_b128 v[112:115], v5 offset:0
v_mfma_f32_16x16x32_bf16 v[48:51], v[180:183], v[164:167], v[48:51]
ds_read_b128 v[116:119], v5 offset:2048
v_mfma_f32_16x16x32_bf16 v[68:71], v[180:183], v[168:171], v[68:71]
ds_read_b128 v[120:123], v5 offset:4096
v_mfma_f32_16x16x32_bf16 v[88:91], v[180:183], v[172:175], v[88:91]
ds_read_b128 v[124:127], v5 offset:6144
v_mfma_f32_16x16x32_bf16 v[32:35], v[184:187], v[160:163], v[32:35]
ds_read_b64_tr_b16 v[132:133], v9 offset:16392
v_mfma_f32_16x16x32_bf16 v[52:55], v[184:187], v[164:167], v[52:55]
ds_read_b64_tr_b16 v[134:135], v9 offset:17672
v_mfma_f32_16x16x32_bf16 v[72:75], v[184:187], v[168:171], v[72:75]
ds_read_b64_tr_b16 v[136:137], v9 offset:16400
v_mfma_f32_16x16x32_bf16 v[92:95], v[184:187], v[172:175], v[92:95]
ds_read_b64_tr_b16 v[138:139], v9 offset:17680
v_mfma_f32_16x16x32_bf16 v[36:39], v[188:191], v[160:163], v[36:39]
ds_read_b64_tr_b16 v[140:141], v9 offset:16408
v_mfma_f32_16x16x32_bf16 v[56:59], v[188:191], v[164:167], v[56:59]
ds_read_b64_tr_b16 v[142:143], v9 offset:17688
v_mfma_f32_16x16x32_bf16 v[76:79], v[188:191], v[168:171], v[76:79]
ds_read_b64_tr_b16 v[144:145], v9 offset:16416
v_mfma_f32_16x16x32_bf16 v[96:99], v[188:191], v[172:175], v[96:99]
ds_read_b64_tr_b16 v[146:147], v9 offset:17696
v_mfma_f32_16x16x32_bf16 v[40:43], v[192:195], v[160:163], v[40:43]
s_waitcnt lgkmcnt(8)
v_mfma_f32_16x16x32_bf16 v[60:63], v[192:195], v[164:167], v[60:63]
ds_read_b128 v[148:151], v11 offset:0
v_mfma_f32_16x16x32_bf16 v[80:83], v[192:195], v[168:171], v[80:83]
ds_read_b64_tr_b16 v[152:153], v15 offset:0
v_mfma_f32_16x16x32_bf16 v[100:103], v[192:195], v[172:175], v[100:103]
ds_read_b64_tr_b16 v[154:155], v15 offset:160
v_mfma_f32_16x16x32_bf16 v[104:107], v[196:199], v[200:203], v[104:107]
ds_read_b64_tr_b16 v[156:157], v15 offset:32
v_mfma_f32_16x16x32_bf16 v[108:111], v[196:199], v[204:207], v[108:111]
ds_read_b64_tr_b16 v[158:159], v15 offset:192
s_waitcnt lgkmcnt(13)
v_mfma_f32_16x16x32_bf16 v[24:27], v[128:131], v[112:115], v[24:27]
v_mfma_f32_16x16x32_bf16 v[44:47], v[128:131], v[116:119], v[44:47]
v_mfma_f32_16x16x32_bf16 v[64:67], v[128:131], v[120:123], v[64:67]
v_mfma_f32_16x16x32_bf16 v[84:87], v[128:131], v[124:127], v[84:87]
s_waitcnt lgkmcnt(0)
ds_read_b64_tr_b16 v[176:177], v9 offset:21504
ds_read_b64_tr_b16 v[178:179], v9 offset:22784
v_mfma_f32_16x16x32_bf16 v[28:31], v[132:135], v[112:115], v[28:31]
ds_read_b128 v[160:163], v6 offset:0
v_mfma_f32_16x16x32_bf16 v[48:51], v[132:135], v[116:119], v[48:51]
ds_read_b128 v[164:167], v6 offset:2048
v_mfma_f32_16x16x32_bf16 v[68:71], v[132:135], v[120:123], v[68:71]
ds_read_b128 v[168:171], v6 offset:4096
v_mfma_f32_16x16x32_bf16 v[88:91], v[132:135], v[124:127], v[88:91]
ds_read_b128 v[172:175], v6 offset:6144
v_mfma_f32_16x16x32_bf16 v[32:35], v[136:139], v[112:115], v[32:35]
ds_read_b64_tr_b16 v[180:181], v9 offset:21512
v_mfma_f32_16x16x32_bf16 v[52:55], v[136:139], v[116:119], v[52:55]
ds_read_b64_tr_b16 v[182:183], v9 offset:22792
v_mfma_f32_16x16x32_bf16 v[72:75], v[136:139], v[120:123], v[72:75]
ds_read_b64_tr_b16 v[184:185], v9 offset:21520
v_mfma_f32_16x16x32_bf16 v[92:95], v[136:139], v[124:127], v[92:95]
ds_read_b64_tr_b16 v[186:187], v9 offset:22800
v_mfma_f32_16x16x32_bf16 v[36:39], v[140:143], v[112:115], v[36:39]
ds_read_b64_tr_b16 v[188:189], v9 offset:21528
v_mfma_f32_16x16x32_bf16 v[56:59], v[140:143], v[116:119], v[56:59]
ds_read_b64_tr_b16 v[190:191], v9 offset:22808
v_mfma_f32_16x16x32_bf16 v[76:79], v[140:143], v[120:123], v[76:79]
ds_read_b64_tr_b16 v[192:193], v9 offset:21536
v_mfma_f32_16x16x32_bf16 v[96:99], v[140:143], v[124:127], v[96:99]
ds_read_b64_tr_b16 v[194:195], v9 offset:22816
v_mfma_f32_16x16x32_bf16 v[40:43], v[144:147], v[112:115], v[40:43]
s_waitcnt lgkmcnt(8)
v_mfma_f32_16x16x32_bf16 v[60:63], v[144:147], v[116:119], v[60:63]
ds_read_b128 v[196:199], v12 offset:0
v_mfma_f32_16x16x32_bf16 v[80:83], v[144:147], v[120:123], v[80:83]
ds_read_b64_tr_b16 v[200:201], v15 offset:1280
v_mfma_f32_16x16x32_bf16 v[100:103], v[144:147], v[124:127], v[100:103]
ds_read_b64_tr_b16 v[202:203], v15 offset:1440
v_mfma_f32_16x16x32_bf16 v[104:107], v[148:151], v[152:155], v[104:107]
ds_read_b64_tr_b16 v[204:205], v15 offset:1312
v_mfma_f32_16x16x32_bf16 v[108:111], v[148:151], v[156:159], v[108:111]
ds_read_b64_tr_b16 v[206:207], v15 offset:1472
s_waitcnt lgkmcnt(13)
v_mfma_f32_16x16x32_bf16 v[24:27], v[176:179], v[160:163], v[24:27]
v_mfma_f32_16x16x32_bf16 v[44:47], v[176:179], v[164:167], v[44:47]
v_mfma_f32_16x16x32_bf16 v[64:67], v[176:179], v[168:171], v[64:67]
v_mfma_f32_16x16x32_bf16 v[84:87], v[176:179], v[172:175], v[84:87]
s_waitcnt lgkmcnt(0)
s_barrier
ds_read_b64_tr_b16 v[128:129], v9 offset:57344
ds_read_b64_tr_b16 v[130:131], v9 offset:58624
v_mfma_f32_16x16x32_bf16 v[28:31], v[180:183], v[160:163], v[28:31]
ds_read_b128 v[112:115], v5 offset:40960
v_mfma_f32_16x16x32_bf16 v[48:51], v[180:183], v[164:167], v[48:51]
ds_read_b128 v[116:119], v5 offset:43008
v_mfma_f32_16x16x32_bf16 v[68:71], v[180:183], v[168:171], v[68:71]
ds_read_b128 v[120:123], v5 offset:45056
v_mfma_f32_16x16x32_bf16 v[88:91], v[180:183], v[172:175], v[88:91]
ds_read_b128 v[124:127], v5 offset:47104
v_mfma_f32_16x16x32_bf16 v[32:35], v[184:187], v[160:163], v[32:35]
ds_read_b64_tr_b16 v[132:133], v9 offset:57352
v_mfma_f32_16x16x32_bf16 v[52:55], v[184:187], v[164:167], v[52:55]
ds_read_b64_tr_b16 v[134:135], v9 offset:58632
v_mfma_f32_16x16x32_bf16 v[72:75], v[184:187], v[168:171], v[72:75]
ds_read_b64_tr_b16 v[136:137], v9 offset:57360
v_mfma_f32_16x16x32_bf16 v[92:95], v[184:187], v[172:175], v[92:95]
ds_read_b64_tr_b16 v[138:139], v9 offset:58640
v_mfma_f32_16x16x32_bf16 v[36:39], v[188:191], v[160:163], v[36:39]
ds_read_b64_tr_b16 v[140:141], v9 offset:57368
v_mfma_f32_16x16x32_bf16 v[56:59], v[188:191], v[164:167], v[56:59]
ds_read_b64_tr_b16 v[142:143], v9 offset:58648
v_mfma_f32_16x16x32_bf16 v[76:79], v[188:191], v[168:171], v[76:79]
ds_read_b64_tr_b16 v[144:145], v9 offset:57376
v_mfma_f32_16x16x32_bf16 v[96:99], v[188:191], v[172:175], v[96:99]
ds_read_b64_tr_b16 v[146:147], v9 offset:58656
v_mfma_f32_16x16x32_bf16 v[40:43], v[192:195], v[160:163], v[40:43]
s_waitcnt lgkmcnt(8)
v_mfma_f32_16x16x32_bf16 v[60:63], v[192:195], v[164:167], v[60:63]
ds_read_b128 v[148:151], v11 offset:40960
v_mfma_f32_16x16x32_bf16 v[80:83], v[192:195], v[168:171], v[80:83]
ds_read_b64_tr_b16 v[152:153], v15 offset:40960
v_mfma_f32_16x16x32_bf16 v[100:103], v[192:195], v[172:175], v[100:103]
ds_read_b64_tr_b16 v[154:155], v15 offset:41120
v_mfma_f32_16x16x32_bf16 v[104:107], v[196:199], v[200:203], v[104:107]
ds_read_b64_tr_b16 v[156:157], v15 offset:40992
v_mfma_f32_16x16x32_bf16 v[108:111], v[196:199], v[204:207], v[108:111]
ds_read_b64_tr_b16 v[158:159], v15 offset:41152
s_waitcnt lgkmcnt(13)
v_mfma_f32_16x16x32_bf16 v[24:27], v[128:131], v[112:115], v[24:27]
v_mfma_f32_16x16x32_bf16 v[44:47], v[128:131], v[116:119], v[44:47]
v_mfma_f32_16x16x32_bf16 v[64:67], v[128:131], v[120:123], v[64:67]
v_mfma_f32_16x16x32_bf16 v[84:87], v[128:131], v[124:127], v[84:87]
s_waitcnt lgkmcnt(0)
ds_read_b64_tr_b16 v[176:177], v9 offset:62464
ds_read_b64_tr_b16 v[178:179], v9 offset:63744
v_mfma_f32_16x16x32_bf16 v[28:31], v[132:135], v[112:115], v[28:31]
ds_read_b128 v[160:163], v6 offset:40960
v_mfma_f32_16x16x32_bf16 v[48:51], v[132:135], v[116:119], v[48:51]
ds_read_b128 v[164:167], v6 offset:43008
v_mfma_f32_16x16x32_bf16 v[68:71], v[132:135], v[120:123], v[68:71]
ds_read_b128 v[168:171], v6 offset:45056
v_mfma_f32_16x16x32_bf16 v[88:91], v[132:135], v[124:127], v[88:91]
ds_read_b128 v[172:175], v6 offset:47104
v_mfma_f32_16x16x32_bf16 v[32:35], v[136:139], v[112:115], v[32:35]
ds_read_b64_tr_b16 v[180:181], v9 offset:62472
v_mfma_f32_16x16x32_bf16 v[52:55], v[136:139], v[116:119], v[52:55]
ds_read_b64_tr_b16 v[182:183], v9 offset:63752
v_mfma_f32_16x16x32_bf16 v[72:75], v[136:139], v[120:123], v[72:75]
ds_read_b64_tr_b16 v[184:185], v9 offset:62480
v_mfma_f32_16x16x32_bf16 v[92:95], v[136:139], v[124:127], v[92:95]
ds_read_b64_tr_b16 v[186:187], v9 offset:63760
v_mfma_f32_16x16x32_bf16 v[36:39], v[140:143], v[112:115], v[36:39]
ds_read_b64_tr_b16 v[188:189], v9 offset:62488
v_mfma_f32_16x16x32_bf16 v[56:59], v[140:143], v[116:119], v[56:59]
ds_read_b64_tr_b16 v[190:191], v9 offset:63768
v_mfma_f32_16x16x32_bf16 v[76:79], v[140:143], v[120:123], v[76:79]
ds_read_b64_tr_b16 v[192:193], v9 offset:62496
v_mfma_f32_16x16x32_bf16 v[96:99], v[140:143], v[124:127], v[96:99]
ds_read_b64_tr_b16 v[194:195], v9 offset:63776
v_mfma_f32_16x16x32_bf16 v[40:43], v[144:147], v[112:115], v[40:43]
s_waitcnt lgkmcnt(8)
v_mfma_f32_16x16x32_bf16 v[60:63], v[144:147], v[116:119], v[60:63]
ds_read_b128 v[196:199], v12 offset:40960
v_mfma_f32_16x16x32_bf16 v[80:83], v[144:147], v[120:123], v[80:83]
ds_read_b64_tr_b16 v[200:201], v15 offset:42240
v_mfma_f32_16x16x32_bf16 v[100:103], v[144:147], v[124:127], v[100:103]
ds_read_b64_tr_b16 v[202:203], v15 offset:42400
v_mfma_f32_16x16x32_bf16 v[104:107], v[148:151], v[152:155], v[104:107]
ds_read_b64_tr_b16 v[204:205], v15 offset:42272
v_mfma_f32_16x16x32_bf16 v[108:111], v[148:151], v[156:159], v[108:111]
ds_read_b64_tr_b16 v[206:207], v15 offset:42432
s_waitcnt lgkmcnt(13)
v_mfma_f32_16x16x32_bf16 v[24:27], v[176:179], v[160:163], v[24:27]
v_mfma_f32_16x16x32_bf16 v[44:47], v[176:179], v[164:167], v[44:47]
v_mfma_f32_16x16x32_bf16 v[64:67], v[176:179], v[168:171], v[64:67]
v_mfma_f32_16x16x32_bf16 v[84:87], v[176:179], v[172:175], v[84:87]
s_waitcnt lgkmcnt(0)
s_barrier
ds_read_b64_tr_b16 v[128:129], v10 offset:16384
ds_read_b64_tr_b16 v[130:131], v10 offset:17664
v_mfma_f32_16x16x32_bf16 v[28:31], v[180:183], v[160:163], v[28:31]
ds_read_b128 v[112:115], v7 offset:0
v_mfma_f32_16x16x32_bf16 v[48:51], v[180:183], v[164:167], v[48:51]
ds_read_b128 v[116:119], v7 offset:2048
v_mfma_f32_16x16x32_bf16 v[68:71], v[180:183], v[168:171], v[68:71]
ds_read_b128 v[120:123], v7 offset:4096
v_mfma_f32_16x16x32_bf16 v[88:91], v[180:183], v[172:175], v[88:91]
ds_read_b128 v[124:127], v7 offset:6144
v_mfma_f32_16x16x32_bf16 v[32:35], v[184:187], v[160:163], v[32:35]
ds_read_b64_tr_b16 v[132:133], v10 offset:16392
v_mfma_f32_16x16x32_bf16 v[52:55], v[184:187], v[164:167], v[52:55]
ds_read_b64_tr_b16 v[134:135], v10 offset:17672
v_mfma_f32_16x16x32_bf16 v[72:75], v[184:187], v[168:171], v[72:75]
ds_read_b64_tr_b16 v[136:137], v10 offset:16400
v_mfma_f32_16x16x32_bf16 v[92:95], v[184:187], v[172:175], v[92:95]
ds_read_b64_tr_b16 v[138:139], v10 offset:17680
v_mfma_f32_16x16x32_bf16 v[36:39], v[188:191], v[160:163], v[36:39]
ds_read_b64_tr_b16 v[140:141], v10 offset:16408
v_mfma_f32_16x16x32_bf16 v[56:59], v[188:191], v[164:167], v[56:59]
ds_read_b64_tr_b16 v[142:143], v10 offset:17688
v_mfma_f32_16x16x32_bf16 v[76:79], v[188:191], v[168:171], v[76:79]
ds_read_b64_tr_b16 v[144:145], v10 offset:16416
v_mfma_f32_16x16x32_bf16 v[96:99], v[188:191], v[172:175], v[96:99]
ds_read_b64_tr_b16 v[146:147], v10 offset:17696
v_mfma_f32_16x16x32_bf16 v[40:43], v[192:195], v[160:163], v[40:43]
s_waitcnt lgkmcnt(8)
v_mfma_f32_16x16x32_bf16 v[60:63], v[192:195], v[164:167], v[60:63]
ds_read_b128 v[148:151], v13 offset:0
v_mfma_f32_16x16x32_bf16 v[80:83], v[192:195], v[168:171], v[80:83]
ds_read_b64_tr_b16 v[152:153], v16 offset:0
v_mfma_f32_16x16x32_bf16 v[100:103], v[192:195], v[172:175], v[100:103]
ds_read_b64_tr_b16 v[154:155], v16 offset:160
v_mfma_f32_16x16x32_bf16 v[104:107], v[196:199], v[200:203], v[104:107]
ds_read_b64_tr_b16 v[156:157], v16 offset:32
v_mfma_f32_16x16x32_bf16 v[108:111], v[196:199], v[204:207], v[108:111]
ds_read_b64_tr_b16 v[158:159], v16 offset:192
s_waitcnt lgkmcnt(13)
v_mfma_f32_16x16x32_bf16 v[24:27], v[128:131], v[112:115], v[24:27]
v_mfma_f32_16x16x32_bf16 v[44:47], v[128:131], v[116:119], v[44:47]
v_mfma_f32_16x16x32_bf16 v[64:67], v[128:131], v[120:123], v[64:67]
v_mfma_f32_16x16x32_bf16 v[84:87], v[128:131], v[124:127], v[84:87]
s_waitcnt lgkmcnt(0)
ds_read_b64_tr_b16 v[176:177], v10 offset:21504
ds_read_b64_tr_b16 v[178:179], v10 offset:22784
v_mfma_f32_16x16x32_bf16 v[28:31], v[132:135], v[112:115], v[28:31]
ds_read_b128 v[160:163], v8 offset:0
v_mfma_f32_16x16x32_bf16 v[48:51], v[132:135], v[116:119], v[48:51]
ds_read_b128 v[164:167], v8 offset:2048
v_mfma_f32_16x16x32_bf16 v[68:71], v[132:135], v[120:123], v[68:71]
ds_read_b128 v[168:171], v8 offset:4096
v_mfma_f32_16x16x32_bf16 v[88:91], v[132:135], v[124:127], v[88:91]
ds_read_b128 v[172:175], v8 offset:6144
v_mfma_f32_16x16x32_bf16 v[32:35], v[136:139], v[112:115], v[32:35]
ds_read_b64_tr_b16 v[180:181], v10 offset:21512
v_mfma_f32_16x16x32_bf16 v[52:55], v[136:139], v[116:119], v[52:55]
ds_read_b64_tr_b16 v[182:183], v10 offset:22792
v_mfma_f32_16x16x32_bf16 v[72:75], v[136:139], v[120:123], v[72:75]
ds_read_b64_tr_b16 v[184:185], v10 offset:21520
v_mfma_f32_16x16x32_bf16 v[92:95], v[136:139], v[124:127], v[92:95]
ds_read_b64_tr_b16 v[186:187], v10 offset:22800
v_mfma_f32_16x16x32_bf16 v[36:39], v[140:143], v[112:115], v[36:39]
ds_read_b64_tr_b16 v[188:189], v10 offset:21528
v_mfma_f32_16x16x32_bf16 v[56:59], v[140:143], v[116:119], v[56:59]
ds_read_b64_tr_b16 v[190:191], v10 offset:22808
v_mfma_f32_16x16x32_bf16 v[76:79], v[140:143], v[120:123], v[76:79]
ds_read_b64_tr_b16 v[192:193], v10 offset:21536
v_mfma_f32_16x16x32_bf16 v[96:99], v[140:143], v[124:127], v[96:99]
ds_read_b64_tr_b16 v[194:195], v10 offset:22816
v_mfma_f32_16x16x32_bf16 v[40:43], v[144:147], v[112:115], v[40:43]
s_waitcnt lgkmcnt(8)
v_mfma_f32_16x16x32_bf16 v[60:63], v[144:147], v[116:119], v[60:63]
ds_read_b128 v[196:199], v14 offset:0
v_mfma_f32_16x16x32_bf16 v[80:83], v[144:147], v[120:123], v[80:83]
ds_read_b64_tr_b16 v[200:201], v16 offset:1280
v_mfma_f32_16x16x32_bf16 v[100:103], v[144:147], v[124:127], v[100:103]
ds_read_b64_tr_b16 v[202:203], v16 offset:1440
v_mfma_f32_16x16x32_bf16 v[104:107], v[148:151], v[152:155], v[104:107]
ds_read_b64_tr_b16 v[204:205], v16 offset:1312
v_mfma_f32_16x16x32_bf16 v[108:111], v[148:151], v[156:159], v[108:111]
ds_read_b64_tr_b16 v[206:207], v16 offset:1472
s_waitcnt lgkmcnt(13)
v_mfma_f32_16x16x32_bf16 v[24:27], v[176:179], v[160:163], v[24:27]
v_mfma_f32_16x16x32_bf16 v[44:47], v[176:179], v[164:167], v[44:47]
v_mfma_f32_16x16x32_bf16 v[64:67], v[176:179], v[168:171], v[64:67]
v_mfma_f32_16x16x32_bf16 v[84:87], v[176:179], v[172:175], v[84:87]
s_waitcnt lgkmcnt(0)
s_barrier
ds_read_b64_tr_b16 v[128:129], v10 offset:57344
ds_read_b64_tr_b16 v[130:131], v10 offset:58624
v_mfma_f32_16x16x32_bf16 v[28:31], v[180:183], v[160:163], v[28:31]
ds_read_b128 v[112:115], v7 offset:40960
v_mfma_f32_16x16x32_bf16 v[48:51], v[180:183], v[164:167], v[48:51]
ds_read_b128 v[116:119], v7 offset:43008
v_mfma_f32_16x16x32_bf16 v[68:71], v[180:183], v[168:171], v[68:71]
ds_read_b128 v[120:123], v7 offset:45056
v_mfma_f32_16x16x32_bf16 v[88:91], v[180:183], v[172:175], v[88:91]
ds_read_b128 v[124:127], v7 offset:47104
v_mfma_f32_16x16x32_bf16 v[32:35], v[184:187], v[160:163], v[32:35]
ds_read_b64_tr_b16 v[132:133], v10 offset:57352
v_mfma_f32_16x16x32_bf16 v[52:55], v[184:187], v[164:167], v[52:55]
ds_read_b64_tr_b16 v[134:135], v10 offset:58632
v_mfma_f32_16x16x32_bf16 v[72:75], v[184:187], v[168:171], v[72:75]
ds_read_b64_tr_b16 v[136:137], v10 offset:57360
v_mfma_f32_16x16x32_bf16 v[92:95], v[184:187], v[172:175], v[92:95]
ds_read_b64_tr_b16 v[138:139], v10 offset:58640
v_mfma_f32_16x16x32_bf16 v[36:39], v[188:191], v[160:163], v[36:39]
ds_read_b64_tr_b16 v[140:141], v10 offset:57368
v_mfma_f32_16x16x32_bf16 v[56:59], v[188:191], v[164:167], v[56:59]
ds_read_b64_tr_b16 v[142:143], v10 offset:58648
v_mfma_f32_16x16x32_bf16 v[76:79], v[188:191], v[168:171], v[76:79]
ds_read_b64_tr_b16 v[144:145], v10 offset:57376
v_mfma_f32_16x16x32_bf16 v[96:99], v[188:191], v[172:175], v[96:99]
ds_read_b64_tr_b16 v[146:147], v10 offset:58656
v_mfma_f32_16x16x32_bf16 v[40:43], v[192:195], v[160:163], v[40:43]
s_waitcnt lgkmcnt(8)
v_mfma_f32_16x16x32_bf16 v[60:63], v[192:195], v[164:167], v[60:63]
ds_read_b128 v[148:151], v13 offset:40960
v_mfma_f32_16x16x32_bf16 v[80:83], v[192:195], v[168:171], v[80:83]
ds_read_b64_tr_b16 v[152:153], v16 offset:40960
v_mfma_f32_16x16x32_bf16 v[100:103], v[192:195], v[172:175], v[100:103]
ds_read_b64_tr_b16 v[154:155], v16 offset:41120
v_mfma_f32_16x16x32_bf16 v[104:107], v[196:199], v[200:203], v[104:107]
ds_read_b64_tr_b16 v[156:157], v16 offset:40992
v_mfma_f32_16x16x32_bf16 v[108:111], v[196:199], v[204:207], v[108:111]
ds_read_b64_tr_b16 v[158:159], v16 offset:41152
s_waitcnt lgkmcnt(13)
v_mfma_f32_16x16x32_bf16 v[24:27], v[128:131], v[112:115], v[24:27]
v_mfma_f32_16x16x32_bf16 v[44:47], v[128:131], v[116:119], v[44:47]
v_mfma_f32_16x16x32_bf16 v[64:67], v[128:131], v[120:123], v[64:67]
v_mfma_f32_16x16x32_bf16 v[84:87], v[128:131], v[124:127], v[84:87]
s_waitcnt lgkmcnt(0)
ds_read_b64_tr_b16 v[176:177], v10 offset:62464
ds_read_b64_tr_b16 v[178:179], v10 offset:63744
v_mfma_f32_16x16x32_bf16 v[28:31], v[132:135], v[112:115], v[28:31]
ds_read_b128 v[160:163], v8 offset:40960
v_mfma_f32_16x16x32_bf16 v[48:51], v[132:135], v[116:119], v[48:51]
ds_read_b128 v[164:167], v8 offset:43008
v_mfma_f32_16x16x32_bf16 v[68:71], v[132:135], v[120:123], v[68:71]
ds_read_b128 v[168:171], v8 offset:45056
v_mfma_f32_16x16x32_bf16 v[88:91], v[132:135], v[124:127], v[88:91]
ds_read_b128 v[172:175], v8 offset:47104
v_mfma_f32_16x16x32_bf16 v[32:35], v[136:139], v[112:115], v[32:35]
ds_read_b64_tr_b16 v[180:181], v10 offset:62472
v_mfma_f32_16x16x32_bf16 v[52:55], v[136:139], v[116:119], v[52:55]
ds_read_b64_tr_b16 v[182:183], v10 offset:63752
v_mfma_f32_16x16x32_bf16 v[72:75], v[136:139], v[120:123], v[72:75]
ds_read_b64_tr_b16 v[184:185], v10 offset:62480
v_mfma_f32_16x16x32_bf16 v[92:95], v[136:139], v[124:127], v[92:95]
ds_read_b64_tr_b16 v[186:187], v10 offset:63760
v_mfma_f32_16x16x32_bf16 v[36:39], v[140:143], v[112:115], v[36:39]
ds_read_b64_tr_b16 v[188:189], v10 offset:62488
v_mfma_f32_16x16x32_bf16 v[56:59], v[140:143], v[116:119], v[56:59]
ds_read_b64_tr_b16 v[190:191], v10 offset:63768
v_mfma_f32_16x16x32_bf16 v[76:79], v[140:143], v[120:123], v[76:79]
ds_read_b64_tr_b16 v[192:193], v10 offset:62496
v_mfma_f32_16x16x32_bf16 v[96:99], v[140:143], v[124:127], v[96:99]
ds_read_b64_tr_b16 v[194:195], v10 offset:63776
v_mfma_f32_16x16x32_bf16 v[40:43], v[144:147], v[112:115], v[40:43]
s_waitcnt lgkmcnt(8)
v_mfma_f32_16x16x32_bf16 v[60:63], v[144:147], v[116:119], v[60:63]
ds_read_b128 v[196:199], v14 offset:40960
v_mfma_f32_16x16x32_bf16 v[80:83], v[144:147], v[120:123], v[80:83]
ds_read_b64_tr_b16 v[200:201], v16 offset:42240
v_mfma_f32_16x16x32_bf16 v[100:103], v[144:147], v[124:127], v[100:103]
ds_read_b64_tr_b16 v[202:203], v16 offset:42400
v_mfma_f32_16x16x32_bf16 v[104:107], v[148:151], v[152:155], v[104:107]
ds_read_b64_tr_b16 v[204:205], v16 offset:42272
v_mfma_f32_16x16x32_bf16 v[108:111], v[148:151], v[156:159], v[108:111]
ds_read_b64_tr_b16 v[206:207], v16 offset:42432
s_waitcnt lgkmcnt(13)
v_mfma_f32_16x16x32_bf16 v[24:27], v[176:179], v[160:163], v[24:27]
v_mfma_f32_16x16x32_bf16 v[44:47], v[176:179], v[164:167], v[44:47]
v_mfma_f32_16x16x32_bf16 v[64:67], v[176:179], v[168:171], v[64:67]
v_mfma_f32_16x16x32_bf16 v[84:87], v[176:179], v[172:175], v[84:87]
s_waitcnt lgkmcnt(0)
s_barrier
ds_read_b64_tr_b16 v[128:129], v9 offset:16384
ds_read_b64_tr_b16 v[130:131], v9 offset:17664
v_mfma_f32_16x16x32_bf16 v[28:31], v[180:183], v[160:163], v[28:31]
ds_read_b128 v[112:115], v5 offset:0
v_mfma_f32_16x16x32_bf16 v[48:51], v[180:183], v[164:167], v[48:51]
ds_read_b128 v[116:119], v5 offset:2048
v_mfma_f32_16x16x32_bf16 v[68:71], v[180:183], v[168:171], v[68:71]
ds_read_b128 v[120:123], v5 offset:4096
v_mfma_f32_16x16x32_bf16 v[88:91], v[180:183], v[172:175], v[88:91]
ds_read_b128 v[124:127], v5 offset:6144
v_mfma_f32_16x16x32_bf16 v[32:35], v[184:187], v[160:163], v[32:35]
ds_read_b64_tr_b16 v[132:133], v9 offset:16392
v_mfma_f32_16x16x32_bf16 v[52:55], v[184:187], v[164:167], v[52:55]
ds_read_b64_tr_b16 v[134:135], v9 offset:17672
v_mfma_f32_16x16x32_bf16 v[72:75], v[184:187], v[168:171], v[72:75]
ds_read_b64_tr_b16 v[136:137], v9 offset:16400
v_mfma_f32_16x16x32_bf16 v[92:95], v[184:187], v[172:175], v[92:95]
ds_read_b64_tr_b16 v[138:139], v9 offset:17680
v_mfma_f32_16x16x32_bf16 v[36:39], v[188:191], v[160:163], v[36:39]
ds_read_b64_tr_b16 v[140:141], v9 offset:16408
v_mfma_f32_16x16x32_bf16 v[56:59], v[188:191], v[164:167], v[56:59]
ds_read_b64_tr_b16 v[142:143], v9 offset:17688
v_mfma_f32_16x16x32_bf16 v[76:79], v[188:191], v[168:171], v[76:79]
ds_read_b64_tr_b16 v[144:145], v9 offset:16416
v_mfma_f32_16x16x32_bf16 v[96:99], v[188:191], v[172:175], v[96:99]
ds_read_b64_tr_b16 v[146:147], v9 offset:17696
v_mfma_f32_16x16x32_bf16 v[40:43], v[192:195], v[160:163], v[40:43]
s_waitcnt lgkmcnt(8)
v_mfma_f32_16x16x32_bf16 v[60:63], v[192:195], v[164:167], v[60:63]
ds_read_b128 v[148:151], v11 offset:0
v_mfma_f32_16x16x32_bf16 v[80:83], v[192:195], v[168:171], v[80:83]
ds_read_b64_tr_b16 v[152:153], v15 offset:0
v_mfma_f32_16x16x32_bf16 v[100:103], v[192:195], v[172:175], v[100:103]
ds_read_b64_tr_b16 v[154:155], v15 offset:160
v_mfma_f32_16x16x32_bf16 v[104:107], v[196:199], v[200:203], v[104:107]
ds_read_b64_tr_b16 v[156:157], v15 offset:32
v_mfma_f32_16x16x32_bf16 v[108:111], v[196:199], v[204:207], v[108:111]
ds_read_b64_tr_b16 v[158:159], v15 offset:192
s_waitcnt lgkmcnt(13)
v_mfma_f32_16x16x32_bf16 v[24:27], v[128:131], v[112:115], v[24:27]
v_mfma_f32_16x16x32_bf16 v[44:47], v[128:131], v[116:119], v[44:47]
v_mfma_f32_16x16x32_bf16 v[64:67], v[128:131], v[120:123], v[64:67]
v_mfma_f32_16x16x32_bf16 v[84:87], v[128:131], v[124:127], v[84:87]
s_waitcnt lgkmcnt(0)
ds_read_b64_tr_b16 v[176:177], v9 offset:21504
ds_read_b64_tr_b16 v[178:179], v9 offset:22784
v_mfma_f32_16x16x32_bf16 v[28:31], v[132:135], v[112:115], v[28:31]
ds_read_b128 v[160:163], v6 offset:0
v_mfma_f32_16x16x32_bf16 v[48:51], v[132:135], v[116:119], v[48:51]
ds_read_b128 v[164:167], v6 offset:2048
v_mfma_f32_16x16x32_bf16 v[68:71], v[132:135], v[120:123], v[68:71]
ds_read_b128 v[168:171], v6 offset:4096
v_mfma_f32_16x16x32_bf16 v[88:91], v[132:135], v[124:127], v[88:91]
ds_read_b128 v[172:175], v6 offset:6144
v_mfma_f32_16x16x32_bf16 v[32:35], v[136:139], v[112:115], v[32:35]
ds_read_b64_tr_b16 v[180:181], v9 offset:21512
v_mfma_f32_16x16x32_bf16 v[52:55], v[136:139], v[116:119], v[52:55]
ds_read_b64_tr_b16 v[182:183], v9 offset:22792
v_mfma_f32_16x16x32_bf16 v[72:75], v[136:139], v[120:123], v[72:75]
ds_read_b64_tr_b16 v[184:185], v9 offset:21520
v_mfma_f32_16x16x32_bf16 v[92:95], v[136:139], v[124:127], v[92:95]
ds_read_b64_tr_b16 v[186:187], v9 offset:22800
v_mfma_f32_16x16x32_bf16 v[36:39], v[140:143], v[112:115], v[36:39]
ds_read_b64_tr_b16 v[188:189], v9 offset:21528
v_mfma_f32_16x16x32_bf16 v[56:59], v[140:143], v[116:119], v[56:59]
ds_read_b64_tr_b16 v[190:191], v9 offset:22808
v_mfma_f32_16x16x32_bf16 v[76:79], v[140:143], v[120:123], v[76:79]
ds_read_b64_tr_b16 v[192:193], v9 offset:21536
v_mfma_f32_16x16x32_bf16 v[96:99], v[140:143], v[124:127], v[96:99]
ds_read_b64_tr_b16 v[194:195], v9 offset:22816
v_mfma_f32_16x16x32_bf16 v[40:43], v[144:147], v[112:115], v[40:43]
s_waitcnt lgkmcnt(8)
v_mfma_f32_16x16x32_bf16 v[60:63], v[144:147], v[116:119], v[60:63]
ds_read_b128 v[196:199], v12 offset:0
v_mfma_f32_16x16x32_bf16 v[80:83], v[144:147], v[120:123], v[80:83]
ds_read_b64_tr_b16 v[200:201], v15 offset:1280
v_mfma_f32_16x16x32_bf16 v[100:103], v[144:147], v[124:127], v[100:103]
ds_read_b64_tr_b16 v[202:203], v15 offset:1440
v_mfma_f32_16x16x32_bf16 v[104:107], v[148:151], v[152:155], v[104:107]
ds_read_b64_tr_b16 v[204:205], v15 offset:1312
v_mfma_f32_16x16x32_bf16 v[108:111], v[148:151], v[156:159], v[108:111]
ds_read_b64_tr_b16 v[206:207], v15 offset:1472
s_waitcnt lgkmcnt(13)
v_mfma_f32_16x16x32_bf16 v[24:27], v[176:179], v[160:163], v[24:27]
v_mfma_f32_16x16x32_bf16 v[44:47], v[176:179], v[164:167], v[44:47]
v_mfma_f32_16x16x32_bf16 v[64:67], v[176:179], v[168:171], v[64:67]
v_mfma_f32_16x16x32_bf16 v[84:87], v[176:179], v[172:175], v[84:87]
s_waitcnt lgkmcnt(0)
s_barrier
ds_read_b64_tr_b16 v[128:129], v9 offset:57344
ds_read_b64_tr_b16 v[130:131], v9 offset:58624
v_mfma_f32_16x16x32_bf16 v[28:31], v[180:183], v[160:163], v[28:31]
ds_read_b128 v[112:115], v5 offset:40960
v_mfma_f32_16x16x32_bf16 v[48:51], v[180:183], v[164:167], v[48:51]
ds_read_b128 v[116:119], v5 offset:43008
v_mfma_f32_16x16x32_bf16 v[68:71], v[180:183], v[168:171], v[68:71]
ds_read_b128 v[120:123], v5 offset:45056
v_mfma_f32_16x16x32_bf16 v[88:91], v[180:183], v[172:175], v[88:91]
ds_read_b128 v[124:127], v5 offset:47104
v_mfma_f32_16x16x32_bf16 v[32:35], v[184:187], v[160:163], v[32:35]
ds_read_b64_tr_b16 v[132:133], v9 offset:57352
v_mfma_f32_16x16x32_bf16 v[52:55], v[184:187], v[164:167], v[52:55]
ds_read_b64_tr_b16 v[134:135], v9 offset:58632
v_mfma_f32_16x16x32_bf16 v[72:75], v[184:187], v[168:171], v[72:75]
ds_read_b64_tr_b16 v[136:137], v9 offset:57360
v_mfma_f32_16x16x32_bf16 v[92:95], v[184:187], v[172:175], v[92:95]
ds_read_b64_tr_b16 v[138:139], v9 offset:58640
v_mfma_f32_16x16x32_bf16 v[36:39], v[188:191], v[160:163], v[36:39]
ds_read_b64_tr_b16 v[140:141], v9 offset:57368
v_mfma_f32_16x16x32_bf16 v[56:59], v[188:191], v[164:167], v[56:59]
ds_read_b64_tr_b16 v[142:143], v9 offset:58648
v_mfma_f32_16x16x32_bf16 v[76:79], v[188:191], v[168:171], v[76:79]
ds_read_b64_tr_b16 v[144:145], v9 offset:57376
v_mfma_f32_16x16x32_bf16 v[96:99], v[188:191], v[172:175], v[96:99]
ds_read_b64_tr_b16 v[146:147], v9 offset:58656
v_mfma_f32_16x16x32_bf16 v[40:43], v[192:195], v[160:163], v[40:43]
s_waitcnt lgkmcnt(8)
v_mfma_f32_16x16x32_bf16 v[60:63], v[192:195], v[164:167], v[60:63]
ds_read_b128 v[148:151], v11 offset:40960
v_mfma_f32_16x16x32_bf16 v[80:83], v[192:195], v[168:171], v[80:83]
ds_read_b64_tr_b16 v[152:153], v15 offset:40960
v_mfma_f32_16x16x32_bf16 v[100:103], v[192:195], v[172:175], v[100:103]
ds_read_b64_tr_b16 v[154:155], v15 offset:41120
v_mfma_f32_16x16x32_bf16 v[104:107], v[196:199], v[200:203], v[104:107]
ds_read_b64_tr_b16 v[156:157], v15 offset:40992
v_mfma_f32_16x16x32_bf16 v[108:111], v[196:199], v[204:207], v[108:111]
ds_read_b64_tr_b16 v[158:159], v15 offset:41152
s_waitcnt lgkmcnt(13)
v_mfma_f32_16x16x32_bf16 v[24:27], v[128:131], v[112:115], v[24:27]
v_mfma_f32_16x16x32_bf16 v[44:47], v[128:131], v[116:119], v[44:47]
v_mfma_f32_16x16x32_bf16 v[64:67], v[128:131], v[120:123], v[64:67]
v_mfma_f32_16x16x32_bf16 v[84:87], v[128:131], v[124:127], v[84:87]
s_waitcnt lgkmcnt(0)
ds_read_b64_tr_b16 v[176:177], v9 offset:62464
ds_read_b64_tr_b16 v[178:179], v9 offset:63744
v_mfma_f32_16x16x32_bf16 v[28:31], v[132:135], v[112:115], v[28:31]
ds_read_b128 v[160:163], v6 offset:40960
v_mfma_f32_16x16x32_bf16 v[48:51], v[132:135], v[116:119], v[48:51]
ds_read_b128 v[164:167], v6 offset:43008
v_mfma_f32_16x16x32_bf16 v[68:71], v[132:135], v[120:123], v[68:71]
ds_read_b128 v[168:171], v6 offset:45056
v_mfma_f32_16x16x32_bf16 v[88:91], v[132:135], v[124:127], v[88:91]
ds_read_b128 v[172:175], v6 offset:47104
v_mfma_f32_16x16x32_bf16 v[32:35], v[136:139], v[112:115], v[32:35]
ds_read_b64_tr_b16 v[180:181], v9 offset:62472
v_mfma_f32_16x16x32_bf16 v[52:55], v[136:139], v[116:119], v[52:55]
ds_read_b64_tr_b16 v[182:183], v9 offset:63752
v_mfma_f32_16x16x32_bf16 v[72:75], v[136:139], v[120:123], v[72:75]
ds_read_b64_tr_b16 v[184:185], v9 offset:62480
v_mfma_f32_16x16x32_bf16 v[92:95], v[136:139], v[124:127], v[92:95]
ds_read_b64_tr_b16 v[186:187], v9 offset:63760
v_mfma_f32_16x16x32_bf16 v[36:39], v[140:143], v[112:115], v[36:39]
ds_read_b64_tr_b16 v[188:189], v9 offset:62488
v_mfma_f32_16x16x32_bf16 v[56:59], v[140:143], v[116:119], v[56:59]
ds_read_b64_tr_b16 v[190:191], v9 offset:63768
v_mfma_f32_16x16x32_bf16 v[76:79], v[140:143], v[120:123], v[76:79]
ds_read_b64_tr_b16 v[192:193], v9 offset:62496
v_mfma_f32_16x16x32_bf16 v[96:99], v[140:143], v[124:127], v[96:99]
ds_read_b64_tr_b16 v[194:195], v9 offset:63776
v_mfma_f32_16x16x32_bf16 v[40:43], v[144:147], v[112:115], v[40:43]
s_waitcnt lgkmcnt(8)
v_mfma_f32_16x16x32_bf16 v[60:63], v[144:147], v[116:119], v[60:63]
ds_read_b128 v[196:199], v12 offset:40960
v_mfma_f32_16x16x32_bf16 v[80:83], v[144:147], v[120:123], v[80:83]
ds_read_b64_tr_b16 v[200:201], v15 offset:42240
v_mfma_f32_16x16x32_bf16 v[100:103], v[144:147], v[124:127], v[100:103]
ds_read_b64_tr_b16 v[202:203], v15 offset:42400
v_mfma_f32_16x16x32_bf16 v[104:107], v[148:151], v[152:155], v[104:107]
ds_read_b64_tr_b16 v[204:205], v15 offset:42272
v_mfma_f32_16x16x32_bf16 v[108:111], v[148:151], v[156:159], v[108:111]
ds_read_b64_tr_b16 v[206:207], v15 offset:42432
s_waitcnt lgkmcnt(13)
v_mfma_f32_16x16x32_bf16 v[24:27], v[176:179], v[160:163], v[24:27]
v_mfma_f32_16x16x32_bf16 v[44:47], v[176:179], v[164:167], v[44:47]
v_mfma_f32_16x16x32_bf16 v[64:67], v[176:179], v[168:171], v[64:67]
v_mfma_f32_16x16x32_bf16 v[84:87], v[176:179], v[172:175], v[84:87]
s_waitcnt lgkmcnt(0)
v_mfma_f32_16x16x32_bf16 v[28:31], v[180:183], v[160:163], v[28:31]
v_mfma_f32_16x16x32_bf16 v[48:51], v[180:183], v[164:167], v[48:51]
v_mfma_f32_16x16x32_bf16 v[68:71], v[180:183], v[168:171], v[68:71]
v_mfma_f32_16x16x32_bf16 v[88:91], v[180:183], v[172:175], v[88:91]
v_mfma_f32_16x16x32_bf16 v[32:35], v[184:187], v[160:163], v[32:35]
v_mfma_f32_16x16x32_bf16 v[52:55], v[184:187], v[164:167], v[52:55]
v_mfma_f32_16x16x32_bf16 v[72:75], v[184:187], v[168:171], v[72:75]
v_mfma_f32_16x16x32_bf16 v[92:95], v[184:187], v[172:175], v[92:95]
v_mfma_f32_16x16x32_bf16 v[36:39], v[188:191], v[160:163], v[36:39]
v_mfma_f32_16x16x32_bf16 v[56:59], v[188:191], v[164:167], v[56:59]
v_mfma_f32_16x16x32_bf16 v[76:79], v[188:191], v[168:171], v[76:79]
v_mfma_f32_16x16x32_bf16 v[96:99], v[188:191], v[172:175], v[96:99]
v_mfma_f32_16x16x32_bf16 v[40:43], v[192:195], v[160:163], v[40:43]
v_mfma_f32_16x16x32_bf16 v[60:63], v[192:195], v[164:167], v[60:63]
v_mfma_f32_16x16x32_bf16 v[80:83], v[192:195], v[168:171], v[80:83]
v_mfma_f32_16x16x32_bf16 v[100:103], v[192:195], v[172:175], v[100:103]
v_mfma_f32_16x16x32_bf16 v[104:107], v[196:199], v[200:203], v[104:107]
v_mfma_f32_16x16x32_bf16 v[108:111], v[196:199], v[204:207], v[108:111]
s_cmp_eq_u32 s8, 1
s_cselect_b32 s49, 2, 1
s_mul_i32 s49, s49, 1280
s_mul_i32 s48, s49, 64
s_cselect_b32 s50, 0, 6291456
s_cselect_b32 s52, 1.0, 1051011932
s_mov_b32 s53, s52
s_cmp_eq_u32 s8, 3
s_cselect_b32 s51, 32, 0
s_add_u32 s51, s51, s58
s_mul_i32 s51, s51, s48
s_add_u32 s50, s50, s51
s_mul_i32 s51, s56, s49
s_add_u32 s50, s50, s51
v_mul_lo_u32 v17, v3, s48
v_lshl_add_u32 v18, v2, 4, v17
v_lshl_add_u32 v19, v2, 3, v17
v_pk_mul_f32 v[24:25], v[24:25], s[52:53]
v_pk_mul_f32 v[26:27], v[26:27], s[52:53]
v_pk_mul_f32 v[28:29], v[28:29], s[52:53]
v_pk_mul_f32 v[30:31], v[30:31], s[52:53]
v_pk_mul_f32 v[32:33], v[32:33], s[52:53]
v_pk_mul_f32 v[34:35], v[34:35], s[52:53]
v_pk_mul_f32 v[36:37], v[36:37], s[52:53]
v_pk_mul_f32 v[38:39], v[38:39], s[52:53]
v_pk_mul_f32 v[40:41], v[40:41], s[52:53]
v_pk_mul_f32 v[42:43], v[42:43], s[52:53]
v_cvt_pk_bf16_f32 v24, v24, v25
v_cvt_pk_bf16_f32 v25, v26, v27
v_cvt_pk_bf16_f32 v26, v28, v29
v_cvt_pk_bf16_f32 v27, v30, v31
v_cvt_pk_bf16_f32 v28, v32, v33
v_cvt_pk_bf16_f32 v29, v34, v35
v_cvt_pk_bf16_f32 v30, v36, v37
v_cvt_pk_bf16_f32 v31, v38, v39
v_cvt_pk_bf16_f32 v32, v40, v41
v_cvt_pk_bf16_f32 v33, v42, v43
buffer_store_dwordx4 v[24:27], v18, s[44:47], s50 offen offset:0 sc1
buffer_store_dwordx4 v[28:31], v18, s[44:47], s50 offen offset:512 sc1
buffer_store_dwordx2 v[32:33], v19, s[44:47], s50 offen offset:1024 sc1
v_pk_mul_f32 v[44:45], v[44:45], s[52:53]
v_pk_mul_f32 v[46:47], v[46:47], s[52:53]
v_pk_mul_f32 v[48:49], v[48:49], s[52:53]
v_pk_mul_f32 v[50:51], v[50:51], s[52:53]
v_pk_mul_f32 v[52:53], v[52:53], s[52:53]
v_pk_mul_f32 v[54:55], v[54:55], s[52:53]
v_pk_mul_f32 v[56:57], v[56:57], s[52:53]
v_pk_mul_f32 v[58:59], v[58:59], s[52:53]
v_pk_mul_f32 v[60:61], v[60:61], s[52:53]
v_pk_mul_f32 v[62:63], v[62:63], s[52:53]
v_cvt_pk_bf16_f32 v44, v44, v45
v_cvt_pk_bf16_f32 v45, v46, v47
v_cvt_pk_bf16_f32 v46, v48, v49
v_cvt_pk_bf16_f32 v47, v50, v51
v_cvt_pk_bf16_f32 v48, v52, v53
v_cvt_pk_bf16_f32 v49, v54, v55
v_cvt_pk_bf16_f32 v50, v56, v57
v_cvt_pk_bf16_f32 v51, v58, v59
v_cvt_pk_bf16_f32 v52, v60, v61
v_cvt_pk_bf16_f32 v53, v62, v63
buffer_store_dwordx4 v[44:47], v18, s[44:47], s50 offen offset:256 sc1
buffer_store_dwordx4 v[48:51], v18, s[44:47], s50 offen offset:768 sc1
buffer_store_dwordx2 v[52:53], v19, s[44:47], s50 offen offset:1152 sc1
v_pk_mul_f32 v[64:65], v[64:65], s[52:53]
v_pk_mul_f32 v[66:67], v[66:67], s[52:53]
v_pk_mul_f32 v[68:69], v[68:69], s[52:53]
v_pk_mul_f32 v[70:71], v[70:71], s[52:53]
v_pk_mul_f32 v[72:73], v[72:73], s[52:53]
v_pk_mul_f32 v[74:75], v[74:75], s[52:53]
v_pk_mul_f32 v[76:77], v[76:77], s[52:53]
v_pk_mul_f32 v[78:79], v[78:79], s[52:53]
v_pk_mul_f32 v[80:81], v[80:81], s[52:53]
v_pk_mul_f32 v[82:83], v[82:83], s[52:53]
v_cvt_pk_bf16_f32 v64, v64, v65
v_cvt_pk_bf16_f32 v65, v66, v67
v_cvt_pk_bf16_f32 v66, v68, v69
v_cvt_pk_bf16_f32 v67, v70, v71
v_cvt_pk_bf16_f32 v68, v72, v73
v_cvt_pk_bf16_f32 v69, v74, v75
v_cvt_pk_bf16_f32 v70, v76, v77
v_cvt_pk_bf16_f32 v71, v78, v79
v_cvt_pk_bf16_f32 v72, v80, v81
v_cvt_pk_bf16_f32 v73, v82, v83
s_add_u32 s50, s50, s49
buffer_store_dwordx4 v[64:67], v18, s[44:47], s50 offen offset:0 sc1
buffer_store_dwordx4 v[68:71], v18, s[44:47], s50 offen offset:512 sc1
buffer_store_dwordx2 v[72:73], v19, s[44:47], s50 offen offset:1024 sc1
v_pk_mul_f32 v[84:85], v[84:85], s[52:53]
v_pk_mul_f32 v[86:87], v[86:87], s[52:53]
v_pk_mul_f32 v[88:89], v[88:89], s[52:53]
v_pk_mul_f32 v[90:91], v[90:91], s[52:53]
v_pk_mul_f32 v[92:93], v[92:93], s[52:53]
v_pk_mul_f32 v[94:95], v[94:95], s[52:53]
v_pk_mul_f32 v[96:97], v[96:97], s[52:53]
v_pk_mul_f32 v[98:99], v[98:99], s[52:53]
v_pk_mul_f32 v[100:101], v[100:101], s[52:53]
v_pk_mul_f32 v[102:103], v[102:103], s[52:53]
v_cvt_pk_bf16_f32 v84, v84, v85
v_cvt_pk_bf16_f32 v85, v86, v87
v_cvt_pk_bf16_f32 v86, v88, v89
v_cvt_pk_bf16_f32 v87, v90, v91
v_cvt_pk_bf16_f32 v88, v92, v93
v_cvt_pk_bf16_f32 v89, v94, v95
v_cvt_pk_bf16_f32 v90, v96, v97
v_cvt_pk_bf16_f32 v91, v98, v99
v_cvt_pk_bf16_f32 v92, v100, v101
v_cvt_pk_bf16_f32 v93, v102, v103
buffer_store_dwordx4 v[84:87], v18, s[44:47], s50 offen offset:256 sc1
buffer_store_dwordx4 v[88:91], v18, s[44:47], s50 offen offset:768 sc1
buffer_store_dwordx2 v[92:93], v19, s[44:47], s50 offen offset:1152 sc1
s_lshr_b32 s51, s15, 1
s_add_u32 s51, s51, s56
s_mul_i32 s50, s51, 2560
s_add_u32 s50, s50, 5242880
v_cvt_pk_bf16_f32 v104, v104, v105
v_cvt_pk_bf16_f32 v105, v106, v107
v_cvt_pk_bf16_f32 v106, v108, v109
v_cvt_pk_bf16_f32 v107, v110, v111
s_mul_i32 s54, s13, 640
s_add_u32 s50, s50, s54
v_permlane16_swap_b32 v104, v106
v_permlane16_swap_b32 v105, v107
v_lshrrev_b32 v17, 1, v3
v_mul_u32_u24 v17, 320, v17
v_and_b32 v18, 31, v1
v_lshl_add_u32 v17, v18, 4, v17
s_mov_b32 s54, 0x000fffff
s_mov_b32 s55, 0x000fffff
s_mov_b64 exec, s[54:55]
buffer_store_dwordx4 v[104:107], v17, s[44:47], s50 offen offset:1280 sc1
s_mov_b64 exec, -1
s_nop 1
s_branch attn
concat_heads__mha_block__grouped_kv_mqa__prompt_kernel_V:
s_barrier
ds_read_b64_tr_b16 v[128:129], v9 offset:16384
ds_read_b64_tr_b16 v[130:131], v9 offset:17664
ds_read_b128 v[112:115], v5 offset:0
ds_read_b128 v[116:119], v5 offset:2048
ds_read_b128 v[120:123], v5 offset:4096
ds_read_b128 v[124:127], v5 offset:6144
ds_read_b64_tr_b16 v[132:133], v9 offset:16392
ds_read_b64_tr_b16 v[134:135], v9 offset:17672
ds_read_b64_tr_b16 v[136:137], v9 offset:16400
ds_read_b64_tr_b16 v[138:139], v9 offset:17680
ds_read_b64_tr_b16 v[140:141], v9 offset:16408
ds_read_b64_tr_b16 v[142:143], v9 offset:17688
ds_read_b64_tr_b16 v[144:145], v9 offset:16416
ds_read_b64_tr_b16 v[146:147], v9 offset:17696
s_waitcnt lgkmcnt(0)
v_mfma_f32_16x16x32_bf16 v[24:27], v[112:115], v[128:131], 0
ds_read_b64_tr_b16 v[176:177], v9 offset:21504
v_mfma_f32_16x16x32_bf16 v[44:47], v[116:119], v[128:131], 0
ds_read_b64_tr_b16 v[178:179], v9 offset:22784
v_mfma_f32_16x16x32_bf16 v[64:67], v[120:123], v[128:131], 0
ds_read_b128 v[160:163], v6 offset:0
v_mfma_f32_16x16x32_bf16 v[84:87], v[124:127], v[128:131], 0
ds_read_b128 v[164:167], v6 offset:2048
v_mfma_f32_16x16x32_bf16 v[28:31], v[112:115], v[132:135], 0
ds_read_b128 v[168:171], v6 offset:4096
v_mfma_f32_16x16x32_bf16 v[48:51], v[116:119], v[132:135], 0
ds_read_b128 v[172:175], v6 offset:6144
v_mfma_f32_16x16x32_bf16 v[68:71], v[120:123], v[132:135], 0
ds_read_b64_tr_b16 v[180:181], v9 offset:21512
v_mfma_f32_16x16x32_bf16 v[88:91], v[124:127], v[132:135], 0
ds_read_b64_tr_b16 v[182:183], v9 offset:22792
v_mfma_f32_16x16x32_bf16 v[32:35], v[112:115], v[136:139], 0
ds_read_b64_tr_b16 v[184:185], v9 offset:21520
v_mfma_f32_16x16x32_bf16 v[52:55], v[116:119], v[136:139], 0
ds_read_b64_tr_b16 v[186:187], v9 offset:22800
v_mfma_f32_16x16x32_bf16 v[72:75], v[120:123], v[136:139], 0
ds_read_b64_tr_b16 v[188:189], v9 offset:21528
v_mfma_f32_16x16x32_bf16 v[92:95], v[124:127], v[136:139], 0
ds_read_b64_tr_b16 v[190:191], v9 offset:22808
v_mfma_f32_16x16x32_bf16 v[36:39], v[112:115], v[140:143], 0
ds_read_b64_tr_b16 v[192:193], v9 offset:21536
v_mfma_f32_16x16x32_bf16 v[56:59], v[116:119], v[140:143], 0
ds_read_b64_tr_b16 v[194:195], v9 offset:22816
v_mfma_f32_16x16x32_bf16 v[76:79], v[120:123], v[140:143], 0
v_mfma_f32_16x16x32_bf16 v[96:99], v[124:127], v[140:143], 0
v_mfma_f32_16x16x32_bf16 v[40:43], v[112:115], v[144:147], 0
v_mfma_f32_16x16x32_bf16 v[60:63], v[116:119], v[144:147], 0
v_mfma_f32_16x16x32_bf16 v[80:83], v[120:123], v[144:147], 0
v_mfma_f32_16x16x32_bf16 v[100:103], v[124:127], v[144:147], 0
s_waitcnt lgkmcnt(0)
s_barrier
v_mfma_f32_16x16x32_bf16 v[24:27], v[160:163], v[176:179], v[24:27]
ds_read_b64_tr_b16 v[128:129], v9 offset:57344
v_mfma_f32_16x16x32_bf16 v[44:47], v[164:167], v[176:179], v[44:47]
ds_read_b64_tr_b16 v[130:131], v9 offset:58624
v_mfma_f32_16x16x32_bf16 v[64:67], v[168:171], v[176:179], v[64:67]
ds_read_b128 v[112:115], v5 offset:40960
v_mfma_f32_16x16x32_bf16 v[84:87], v[172:175], v[176:179], v[84:87]
ds_read_b128 v[116:119], v5 offset:43008
v_mfma_f32_16x16x32_bf16 v[28:31], v[160:163], v[180:183], v[28:31]
ds_read_b128 v[120:123], v5 offset:45056
v_mfma_f32_16x16x32_bf16 v[48:51], v[164:167], v[180:183], v[48:51]
ds_read_b128 v[124:127], v5 offset:47104
v_mfma_f32_16x16x32_bf16 v[68:71], v[168:171], v[180:183], v[68:71]
ds_read_b64_tr_b16 v[132:133], v9 offset:57352
v_mfma_f32_16x16x32_bf16 v[88:91], v[172:175], v[180:183], v[88:91]
ds_read_b64_tr_b16 v[134:135], v9 offset:58632
v_mfma_f32_16x16x32_bf16 v[32:35], v[160:163], v[184:187], v[32:35]
ds_read_b64_tr_b16 v[136:137], v9 offset:57360
v_mfma_f32_16x16x32_bf16 v[52:55], v[164:167], v[184:187], v[52:55]
ds_read_b64_tr_b16 v[138:139], v9 offset:58640
v_mfma_f32_16x16x32_bf16 v[72:75], v[168:171], v[184:187], v[72:75]
ds_read_b64_tr_b16 v[140:141], v9 offset:57368
v_mfma_f32_16x16x32_bf16 v[92:95], v[172:175], v[184:187], v[92:95]
ds_read_b64_tr_b16 v[142:143], v9 offset:58648
v_mfma_f32_16x16x32_bf16 v[36:39], v[160:163], v[188:191], v[36:39]
ds_read_b64_tr_b16 v[144:145], v9 offset:57376
v_mfma_f32_16x16x32_bf16 v[56:59], v[164:167], v[188:191], v[56:59]
ds_read_b64_tr_b16 v[146:147], v9 offset:58656
v_mfma_f32_16x16x32_bf16 v[76:79], v[168:171], v[188:191], v[76:79]
v_mfma_f32_16x16x32_bf16 v[96:99], v[172:175], v[188:191], v[96:99]
v_mfma_f32_16x16x32_bf16 v[40:43], v[160:163], v[192:195], v[40:43]
v_mfma_f32_16x16x32_bf16 v[60:63], v[164:167], v[192:195], v[60:63]
v_mfma_f32_16x16x32_bf16 v[80:83], v[168:171], v[192:195], v[80:83]
v_mfma_f32_16x16x32_bf16 v[100:103], v[172:175], v[192:195], v[100:103]
s_waitcnt lgkmcnt(0)
v_mfma_f32_16x16x32_bf16 v[24:27], v[112:115], v[128:131], v[24:27]
ds_read_b64_tr_b16 v[176:177], v9 offset:62464
v_mfma_f32_16x16x32_bf16 v[44:47], v[116:119], v[128:131], v[44:47]
ds_read_b64_tr_b16 v[178:179], v9 offset:63744
v_mfma_f32_16x16x32_bf16 v[64:67], v[120:123], v[128:131], v[64:67]
ds_read_b128 v[160:163], v6 offset:40960
v_mfma_f32_16x16x32_bf16 v[84:87], v[124:127], v[128:131], v[84:87]
ds_read_b128 v[164:167], v6 offset:43008
v_mfma_f32_16x16x32_bf16 v[28:31], v[112:115], v[132:135], v[28:31]
ds_read_b128 v[168:171], v6 offset:45056
v_mfma_f32_16x16x32_bf16 v[48:51], v[116:119], v[132:135], v[48:51]
ds_read_b128 v[172:175], v6 offset:47104
v_mfma_f32_16x16x32_bf16 v[68:71], v[120:123], v[132:135], v[68:71]
ds_read_b64_tr_b16 v[180:181], v9 offset:62472
v_mfma_f32_16x16x32_bf16 v[88:91], v[124:127], v[132:135], v[88:91]
ds_read_b64_tr_b16 v[182:183], v9 offset:63752
v_mfma_f32_16x16x32_bf16 v[32:35], v[112:115], v[136:139], v[32:35]
ds_read_b64_tr_b16 v[184:185], v9 offset:62480
v_mfma_f32_16x16x32_bf16 v[52:55], v[116:119], v[136:139], v[52:55]
ds_read_b64_tr_b16 v[186:187], v9 offset:63760
v_mfma_f32_16x16x32_bf16 v[72:75], v[120:123], v[136:139], v[72:75]
ds_read_b64_tr_b16 v[188:189], v9 offset:62488
v_mfma_f32_16x16x32_bf16 v[92:95], v[124:127], v[136:139], v[92:95]
ds_read_b64_tr_b16 v[190:191], v9 offset:63768
v_mfma_f32_16x16x32_bf16 v[36:39], v[112:115], v[140:143], v[36:39]
ds_read_b64_tr_b16 v[192:193], v9 offset:62496
v_mfma_f32_16x16x32_bf16 v[56:59], v[116:119], v[140:143], v[56:59]
ds_read_b64_tr_b16 v[194:195], v9 offset:63776
v_mfma_f32_16x16x32_bf16 v[76:79], v[120:123], v[140:143], v[76:79]
v_mfma_f32_16x16x32_bf16 v[96:99], v[124:127], v[140:143], v[96:99]
v_mfma_f32_16x16x32_bf16 v[40:43], v[112:115], v[144:147], v[40:43]
v_mfma_f32_16x16x32_bf16 v[60:63], v[116:119], v[144:147], v[60:63]
v_mfma_f32_16x16x32_bf16 v[80:83], v[120:123], v[144:147], v[80:83]
v_mfma_f32_16x16x32_bf16 v[100:103], v[124:127], v[144:147], v[100:103]
s_waitcnt lgkmcnt(0)
s_barrier
v_mfma_f32_16x16x32_bf16 v[24:27], v[160:163], v[176:179], v[24:27]
ds_read_b64_tr_b16 v[128:129], v10 offset:16384
v_mfma_f32_16x16x32_bf16 v[44:47], v[164:167], v[176:179], v[44:47]
ds_read_b64_tr_b16 v[130:131], v10 offset:17664
v_mfma_f32_16x16x32_bf16 v[64:67], v[168:171], v[176:179], v[64:67]
ds_read_b128 v[112:115], v7 offset:0
v_mfma_f32_16x16x32_bf16 v[84:87], v[172:175], v[176:179], v[84:87]
ds_read_b128 v[116:119], v7 offset:2048
v_mfma_f32_16x16x32_bf16 v[28:31], v[160:163], v[180:183], v[28:31]
ds_read_b128 v[120:123], v7 offset:4096
v_mfma_f32_16x16x32_bf16 v[48:51], v[164:167], v[180:183], v[48:51]
ds_read_b128 v[124:127], v7 offset:6144
v_mfma_f32_16x16x32_bf16 v[68:71], v[168:171], v[180:183], v[68:71]
ds_read_b64_tr_b16 v[132:133], v10 offset:16392
v_mfma_f32_16x16x32_bf16 v[88:91], v[172:175], v[180:183], v[88:91]
ds_read_b64_tr_b16 v[134:135], v10 offset:17672
v_mfma_f32_16x16x32_bf16 v[32:35], v[160:163], v[184:187], v[32:35]
ds_read_b64_tr_b16 v[136:137], v10 offset:16400
v_mfma_f32_16x16x32_bf16 v[52:55], v[164:167], v[184:187], v[52:55]
ds_read_b64_tr_b16 v[138:139], v10 offset:17680
v_mfma_f32_16x16x32_bf16 v[72:75], v[168:171], v[184:187], v[72:75]
ds_read_b64_tr_b16 v[140:141], v10 offset:16408
v_mfma_f32_16x16x32_bf16 v[92:95], v[172:175], v[184:187], v[92:95]
ds_read_b64_tr_b16 v[142:143], v10 offset:17688
v_mfma_f32_16x16x32_bf16 v[36:39], v[160:163], v[188:191], v[36:39]
ds_read_b64_tr_b16 v[144:145], v10 offset:16416
v_mfma_f32_16x16x32_bf16 v[56:59], v[164:167], v[188:191], v[56:59]
ds_read_b64_tr_b16 v[146:147], v10 offset:17696
v_mfma_f32_16x16x32_bf16 v[76:79], v[168:171], v[188:191], v[76:79]
v_mfma_f32_16x16x32_bf16 v[96:99], v[172:175], v[188:191], v[96:99]
v_mfma_f32_16x16x32_bf16 v[40:43], v[160:163], v[192:195], v[40:43]
v_mfma_f32_16x16x32_bf16 v[60:63], v[164:167], v[192:195], v[60:63]
v_mfma_f32_16x16x32_bf16 v[80:83], v[168:171], v[192:195], v[80:83]
v_mfma_f32_16x16x32_bf16 v[100:103], v[172:175], v[192:195], v[100:103]
s_waitcnt lgkmcnt(0)
v_mfma_f32_16x16x32_bf16 v[24:27], v[112:115], v[128:131], v[24:27]
ds_read_b64_tr_b16 v[176:177], v10 offset:21504
v_mfma_f32_16x16x32_bf16 v[44:47], v[116:119], v[128:131], v[44:47]
ds_read_b64_tr_b16 v[178:179], v10 offset:22784
v_mfma_f32_16x16x32_bf16 v[64:67], v[120:123], v[128:131], v[64:67]
ds_read_b128 v[160:163], v8 offset:0
v_mfma_f32_16x16x32_bf16 v[84:87], v[124:127], v[128:131], v[84:87]
ds_read_b128 v[164:167], v8 offset:2048
v_mfma_f32_16x16x32_bf16 v[28:31], v[112:115], v[132:135], v[28:31]
ds_read_b128 v[168:171], v8 offset:4096
v_mfma_f32_16x16x32_bf16 v[48:51], v[116:119], v[132:135], v[48:51]
ds_read_b128 v[172:175], v8 offset:6144
v_mfma_f32_16x16x32_bf16 v[68:71], v[120:123], v[132:135], v[68:71]
ds_read_b64_tr_b16 v[180:181], v10 offset:21512
v_mfma_f32_16x16x32_bf16 v[88:91], v[124:127], v[132:135], v[88:91]
ds_read_b64_tr_b16 v[182:183], v10 offset:22792
v_mfma_f32_16x16x32_bf16 v[32:35], v[112:115], v[136:139], v[32:35]
ds_read_b64_tr_b16 v[184:185], v10 offset:21520
v_mfma_f32_16x16x32_bf16 v[52:55], v[116:119], v[136:139], v[52:55]
ds_read_b64_tr_b16 v[186:187], v10 offset:22800
v_mfma_f32_16x16x32_bf16 v[72:75], v[120:123], v[136:139], v[72:75]
ds_read_b64_tr_b16 v[188:189], v10 offset:21528
v_mfma_f32_16x16x32_bf16 v[92:95], v[124:127], v[136:139], v[92:95]
ds_read_b64_tr_b16 v[190:191], v10 offset:22808
v_mfma_f32_16x16x32_bf16 v[36:39], v[112:115], v[140:143], v[36:39]
ds_read_b64_tr_b16 v[192:193], v10 offset:21536
v_mfma_f32_16x16x32_bf16 v[56:59], v[116:119], v[140:143], v[56:59]
ds_read_b64_tr_b16 v[194:195], v10 offset:22816
v_mfma_f32_16x16x32_bf16 v[76:79], v[120:123], v[140:143], v[76:79]
v_mfma_f32_16x16x32_bf16 v[96:99], v[124:127], v[140:143], v[96:99]
v_mfma_f32_16x16x32_bf16 v[40:43], v[112:115], v[144:147], v[40:43]
v_mfma_f32_16x16x32_bf16 v[60:63], v[116:119], v[144:147], v[60:63]
v_mfma_f32_16x16x32_bf16 v[80:83], v[120:123], v[144:147], v[80:83]
v_mfma_f32_16x16x32_bf16 v[100:103], v[124:127], v[144:147], v[100:103]
s_waitcnt lgkmcnt(0)
s_barrier
v_mfma_f32_16x16x32_bf16 v[24:27], v[160:163], v[176:179], v[24:27]
ds_read_b64_tr_b16 v[128:129], v10 offset:57344
v_mfma_f32_16x16x32_bf16 v[44:47], v[164:167], v[176:179], v[44:47]
ds_read_b64_tr_b16 v[130:131], v10 offset:58624
v_mfma_f32_16x16x32_bf16 v[64:67], v[168:171], v[176:179], v[64:67]
ds_read_b128 v[112:115], v7 offset:40960
v_mfma_f32_16x16x32_bf16 v[84:87], v[172:175], v[176:179], v[84:87]
ds_read_b128 v[116:119], v7 offset:43008
v_mfma_f32_16x16x32_bf16 v[28:31], v[160:163], v[180:183], v[28:31]
ds_read_b128 v[120:123], v7 offset:45056
v_mfma_f32_16x16x32_bf16 v[48:51], v[164:167], v[180:183], v[48:51]
ds_read_b128 v[124:127], v7 offset:47104
v_mfma_f32_16x16x32_bf16 v[68:71], v[168:171], v[180:183], v[68:71]
ds_read_b64_tr_b16 v[132:133], v10 offset:57352
v_mfma_f32_16x16x32_bf16 v[88:91], v[172:175], v[180:183], v[88:91]
ds_read_b64_tr_b16 v[134:135], v10 offset:58632
v_mfma_f32_16x16x32_bf16 v[32:35], v[160:163], v[184:187], v[32:35]
ds_read_b64_tr_b16 v[136:137], v10 offset:57360
v_mfma_f32_16x16x32_bf16 v[52:55], v[164:167], v[184:187], v[52:55]
ds_read_b64_tr_b16 v[138:139], v10 offset:58640
v_mfma_f32_16x16x32_bf16 v[72:75], v[168:171], v[184:187], v[72:75]
ds_read_b64_tr_b16 v[140:141], v10 offset:57368
v_mfma_f32_16x16x32_bf16 v[92:95], v[172:175], v[184:187], v[92:95]
ds_read_b64_tr_b16 v[142:143], v10 offset:58648
v_mfma_f32_16x16x32_bf16 v[36:39], v[160:163], v[188:191], v[36:39]
ds_read_b64_tr_b16 v[144:145], v10 offset:57376
v_mfma_f32_16x16x32_bf16 v[56:59], v[164:167], v[188:191], v[56:59]
ds_read_b64_tr_b16 v[146:147], v10 offset:58656
v_mfma_f32_16x16x32_bf16 v[76:79], v[168:171], v[188:191], v[76:79]
v_mfma_f32_16x16x32_bf16 v[96:99], v[172:175], v[188:191], v[96:99]
v_mfma_f32_16x16x32_bf16 v[40:43], v[160:163], v[192:195], v[40:43]
v_mfma_f32_16x16x32_bf16 v[60:63], v[164:167], v[192:195], v[60:63]
v_mfma_f32_16x16x32_bf16 v[80:83], v[168:171], v[192:195], v[80:83]
v_mfma_f32_16x16x32_bf16 v[100:103], v[172:175], v[192:195], v[100:103]
s_waitcnt lgkmcnt(0)
v_mfma_f32_16x16x32_bf16 v[24:27], v[112:115], v[128:131], v[24:27]
ds_read_b64_tr_b16 v[176:177], v10 offset:62464
v_mfma_f32_16x16x32_bf16 v[44:47], v[116:119], v[128:131], v[44:47]
ds_read_b64_tr_b16 v[178:179], v10 offset:63744
v_mfma_f32_16x16x32_bf16 v[64:67], v[120:123], v[128:131], v[64:67]
ds_read_b128 v[160:163], v8 offset:40960
v_mfma_f32_16x16x32_bf16 v[84:87], v[124:127], v[128:131], v[84:87]
ds_read_b128 v[164:167], v8 offset:43008
v_mfma_f32_16x16x32_bf16 v[28:31], v[112:115], v[132:135], v[28:31]
ds_read_b128 v[168:171], v8 offset:45056
v_mfma_f32_16x16x32_bf16 v[48:51], v[116:119], v[132:135], v[48:51]
ds_read_b128 v[172:175], v8 offset:47104
v_mfma_f32_16x16x32_bf16 v[68:71], v[120:123], v[132:135], v[68:71]
ds_read_b64_tr_b16 v[180:181], v10 offset:62472
v_mfma_f32_16x16x32_bf16 v[88:91], v[124:127], v[132:135], v[88:91]
ds_read_b64_tr_b16 v[182:183], v10 offset:63752
v_mfma_f32_16x16x32_bf16 v[32:35], v[112:115], v[136:139], v[32:35]
ds_read_b64_tr_b16 v[184:185], v10 offset:62480
v_mfma_f32_16x16x32_bf16 v[52:55], v[116:119], v[136:139], v[52:55]
ds_read_b64_tr_b16 v[186:187], v10 offset:63760
v_mfma_f32_16x16x32_bf16 v[72:75], v[120:123], v[136:139], v[72:75]
ds_read_b64_tr_b16 v[188:189], v10 offset:62488
v_mfma_f32_16x16x32_bf16 v[92:95], v[124:127], v[136:139], v[92:95]
ds_read_b64_tr_b16 v[190:191], v10 offset:63768
v_mfma_f32_16x16x32_bf16 v[36:39], v[112:115], v[140:143], v[36:39]
ds_read_b64_tr_b16 v[192:193], v10 offset:62496
v_mfma_f32_16x16x32_bf16 v[56:59], v[116:119], v[140:143], v[56:59]
ds_read_b64_tr_b16 v[194:195], v10 offset:63776
v_mfma_f32_16x16x32_bf16 v[76:79], v[120:123], v[140:143], v[76:79]
v_mfma_f32_16x16x32_bf16 v[96:99], v[124:127], v[140:143], v[96:99]
v_mfma_f32_16x16x32_bf16 v[40:43], v[112:115], v[144:147], v[40:43]
v_mfma_f32_16x16x32_bf16 v[60:63], v[116:119], v[144:147], v[60:63]
v_mfma_f32_16x16x32_bf16 v[80:83], v[120:123], v[144:147], v[80:83]
v_mfma_f32_16x16x32_bf16 v[100:103], v[124:127], v[144:147], v[100:103]
s_waitcnt lgkmcnt(0)
s_barrier
v_mfma_f32_16x16x32_bf16 v[24:27], v[160:163], v[176:179], v[24:27]
ds_read_b64_tr_b16 v[128:129], v9 offset:16384
v_mfma_f32_16x16x32_bf16 v[44:47], v[164:167], v[176:179], v[44:47]
ds_read_b64_tr_b16 v[130:131], v9 offset:17664
v_mfma_f32_16x16x32_bf16 v[64:67], v[168:171], v[176:179], v[64:67]
ds_read_b128 v[112:115], v5 offset:0
v_mfma_f32_16x16x32_bf16 v[84:87], v[172:175], v[176:179], v[84:87]
ds_read_b128 v[116:119], v5 offset:2048
v_mfma_f32_16x16x32_bf16 v[28:31], v[160:163], v[180:183], v[28:31]
ds_read_b128 v[120:123], v5 offset:4096
v_mfma_f32_16x16x32_bf16 v[48:51], v[164:167], v[180:183], v[48:51]
ds_read_b128 v[124:127], v5 offset:6144
v_mfma_f32_16x16x32_bf16 v[68:71], v[168:171], v[180:183], v[68:71]
ds_read_b64_tr_b16 v[132:133], v9 offset:16392
v_mfma_f32_16x16x32_bf16 v[88:91], v[172:175], v[180:183], v[88:91]
ds_read_b64_tr_b16 v[134:135], v9 offset:17672
v_mfma_f32_16x16x32_bf16 v[32:35], v[160:163], v[184:187], v[32:35]
ds_read_b64_tr_b16 v[136:137], v9 offset:16400
v_mfma_f32_16x16x32_bf16 v[52:55], v[164:167], v[184:187], v[52:55]
ds_read_b64_tr_b16 v[138:139], v9 offset:17680
v_mfma_f32_16x16x32_bf16 v[72:75], v[168:171], v[184:187], v[72:75]
ds_read_b64_tr_b16 v[140:141], v9 offset:16408
v_mfma_f32_16x16x32_bf16 v[92:95], v[172:175], v[184:187], v[92:95]
ds_read_b64_tr_b16 v[142:143], v9 offset:17688
v_mfma_f32_16x16x32_bf16 v[36:39], v[160:163], v[188:191], v[36:39]
ds_read_b64_tr_b16 v[144:145], v9 offset:16416
v_mfma_f32_16x16x32_bf16 v[56:59], v[164:167], v[188:191], v[56:59]
ds_read_b64_tr_b16 v[146:147], v9 offset:17696
v_mfma_f32_16x16x32_bf16 v[76:79], v[168:171], v[188:191], v[76:79]
v_mfma_f32_16x16x32_bf16 v[96:99], v[172:175], v[188:191], v[96:99]
v_mfma_f32_16x16x32_bf16 v[40:43], v[160:163], v[192:195], v[40:43]
v_mfma_f32_16x16x32_bf16 v[60:63], v[164:167], v[192:195], v[60:63]
v_mfma_f32_16x16x32_bf16 v[80:83], v[168:171], v[192:195], v[80:83]
v_mfma_f32_16x16x32_bf16 v[100:103], v[172:175], v[192:195], v[100:103]
s_waitcnt lgkmcnt(0)
v_mfma_f32_16x16x32_bf16 v[24:27], v[112:115], v[128:131], v[24:27]
ds_read_b64_tr_b16 v[176:177], v9 offset:21504
v_mfma_f32_16x16x32_bf16 v[44:47], v[116:119], v[128:131], v[44:47]
ds_read_b64_tr_b16 v[178:179], v9 offset:22784
v_mfma_f32_16x16x32_bf16 v[64:67], v[120:123], v[128:131], v[64:67]
ds_read_b128 v[160:163], v6 offset:0
v_mfma_f32_16x16x32_bf16 v[84:87], v[124:127], v[128:131], v[84:87]
ds_read_b128 v[164:167], v6 offset:2048
v_mfma_f32_16x16x32_bf16 v[28:31], v[112:115], v[132:135], v[28:31]
ds_read_b128 v[168:171], v6 offset:4096
v_mfma_f32_16x16x32_bf16 v[48:51], v[116:119], v[132:135], v[48:51]
ds_read_b128 v[172:175], v6 offset:6144
v_mfma_f32_16x16x32_bf16 v[68:71], v[120:123], v[132:135], v[68:71]
ds_read_b64_tr_b16 v[180:181], v9 offset:21512
v_mfma_f32_16x16x32_bf16 v[88:91], v[124:127], v[132:135], v[88:91]
ds_read_b64_tr_b16 v[182:183], v9 offset:22792
v_mfma_f32_16x16x32_bf16 v[32:35], v[112:115], v[136:139], v[32:35]
ds_read_b64_tr_b16 v[184:185], v9 offset:21520
v_mfma_f32_16x16x32_bf16 v[52:55], v[116:119], v[136:139], v[52:55]
ds_read_b64_tr_b16 v[186:187], v9 offset:22800
v_mfma_f32_16x16x32_bf16 v[72:75], v[120:123], v[136:139], v[72:75]
ds_read_b64_tr_b16 v[188:189], v9 offset:21528
v_mfma_f32_16x16x32_bf16 v[92:95], v[124:127], v[136:139], v[92:95]
ds_read_b64_tr_b16 v[190:191], v9 offset:22808
v_mfma_f32_16x16x32_bf16 v[36:39], v[112:115], v[140:143], v[36:39]
ds_read_b64_tr_b16 v[192:193], v9 offset:21536
v_mfma_f32_16x16x32_bf16 v[56:59], v[116:119], v[140:143], v[56:59]
ds_read_b64_tr_b16 v[194:195], v9 offset:22816
v_mfma_f32_16x16x32_bf16 v[76:79], v[120:123], v[140:143], v[76:79]
v_mfma_f32_16x16x32_bf16 v[96:99], v[124:127], v[140:143], v[96:99]
v_mfma_f32_16x16x32_bf16 v[40:43], v[112:115], v[144:147], v[40:43]
v_mfma_f32_16x16x32_bf16 v[60:63], v[116:119], v[144:147], v[60:63]
v_mfma_f32_16x16x32_bf16 v[80:83], v[120:123], v[144:147], v[80:83]
v_mfma_f32_16x16x32_bf16 v[100:103], v[124:127], v[144:147], v[100:103]
s_waitcnt lgkmcnt(0)
s_barrier
v_mfma_f32_16x16x32_bf16 v[24:27], v[160:163], v[176:179], v[24:27]
ds_read_b64_tr_b16 v[128:129], v9 offset:57344
v_mfma_f32_16x16x32_bf16 v[44:47], v[164:167], v[176:179], v[44:47]
ds_read_b64_tr_b16 v[130:131], v9 offset:58624
v_mfma_f32_16x16x32_bf16 v[64:67], v[168:171], v[176:179], v[64:67]
ds_read_b128 v[112:115], v5 offset:40960
v_mfma_f32_16x16x32_bf16 v[84:87], v[172:175], v[176:179], v[84:87]
ds_read_b128 v[116:119], v5 offset:43008
v_mfma_f32_16x16x32_bf16 v[28:31], v[160:163], v[180:183], v[28:31]
ds_read_b128 v[120:123], v5 offset:45056
v_mfma_f32_16x16x32_bf16 v[48:51], v[164:167], v[180:183], v[48:51]
ds_read_b128 v[124:127], v5 offset:47104
v_mfma_f32_16x16x32_bf16 v[68:71], v[168:171], v[180:183], v[68:71]
ds_read_b64_tr_b16 v[132:133], v9 offset:57352
v_mfma_f32_16x16x32_bf16 v[88:91], v[172:175], v[180:183], v[88:91]
ds_read_b64_tr_b16 v[134:135], v9 offset:58632
v_mfma_f32_16x16x32_bf16 v[32:35], v[160:163], v[184:187], v[32:35]
ds_read_b64_tr_b16 v[136:137], v9 offset:57360
v_mfma_f32_16x16x32_bf16 v[52:55], v[164:167], v[184:187], v[52:55]
ds_read_b64_tr_b16 v[138:139], v9 offset:58640
v_mfma_f32_16x16x32_bf16 v[72:75], v[168:171], v[184:187], v[72:75]
ds_read_b64_tr_b16 v[140:141], v9 offset:57368
v_mfma_f32_16x16x32_bf16 v[92:95], v[172:175], v[184:187], v[92:95]
ds_read_b64_tr_b16 v[142:143], v9 offset:58648
v_mfma_f32_16x16x32_bf16 v[36:39], v[160:163], v[188:191], v[36:39]
ds_read_b64_tr_b16 v[144:145], v9 offset:57376
v_mfma_f32_16x16x32_bf16 v[56:59], v[164:167], v[188:191], v[56:59]
ds_read_b64_tr_b16 v[146:147], v9 offset:58656
v_mfma_f32_16x16x32_bf16 v[76:79], v[168:171], v[188:191], v[76:79]
v_mfma_f32_16x16x32_bf16 v[96:99], v[172:175], v[188:191], v[96:99]
v_mfma_f32_16x16x32_bf16 v[40:43], v[160:163], v[192:195], v[40:43]
v_mfma_f32_16x16x32_bf16 v[60:63], v[164:167], v[192:195], v[60:63]
v_mfma_f32_16x16x32_bf16 v[80:83], v[168:171], v[192:195], v[80:83]
v_mfma_f32_16x16x32_bf16 v[100:103], v[172:175], v[192:195], v[100:103]
s_waitcnt lgkmcnt(0)
v_mfma_f32_16x16x32_bf16 v[24:27], v[112:115], v[128:131], v[24:27]
ds_read_b64_tr_b16 v[176:177], v9 offset:62464
v_mfma_f32_16x16x32_bf16 v[44:47], v[116:119], v[128:131], v[44:47]
ds_read_b64_tr_b16 v[178:179], v9 offset:63744
v_mfma_f32_16x16x32_bf16 v[64:67], v[120:123], v[128:131], v[64:67]
ds_read_b128 v[160:163], v6 offset:40960
v_mfma_f32_16x16x32_bf16 v[84:87], v[124:127], v[128:131], v[84:87]
ds_read_b128 v[164:167], v6 offset:43008
v_mfma_f32_16x16x32_bf16 v[28:31], v[112:115], v[132:135], v[28:31]
ds_read_b128 v[168:171], v6 offset:45056
v_mfma_f32_16x16x32_bf16 v[48:51], v[116:119], v[132:135], v[48:51]
ds_read_b128 v[172:175], v6 offset:47104
v_mfma_f32_16x16x32_bf16 v[68:71], v[120:123], v[132:135], v[68:71]
ds_read_b64_tr_b16 v[180:181], v9 offset:62472
v_mfma_f32_16x16x32_bf16 v[88:91], v[124:127], v[132:135], v[88:91]
ds_read_b64_tr_b16 v[182:183], v9 offset:63752
v_mfma_f32_16x16x32_bf16 v[32:35], v[112:115], v[136:139], v[32:35]
ds_read_b64_tr_b16 v[184:185], v9 offset:62480
v_mfma_f32_16x16x32_bf16 v[52:55], v[116:119], v[136:139], v[52:55]
ds_read_b64_tr_b16 v[186:187], v9 offset:63760
v_mfma_f32_16x16x32_bf16 v[72:75], v[120:123], v[136:139], v[72:75]
ds_read_b64_tr_b16 v[188:189], v9 offset:62488
v_mfma_f32_16x16x32_bf16 v[92:95], v[124:127], v[136:139], v[92:95]
ds_read_b64_tr_b16 v[190:191], v9 offset:63768
v_mfma_f32_16x16x32_bf16 v[36:39], v[112:115], v[140:143], v[36:39]
ds_read_b64_tr_b16 v[192:193], v9 offset:62496
v_mfma_f32_16x16x32_bf16 v[56:59], v[116:119], v[140:143], v[56:59]
ds_read_b64_tr_b16 v[194:195], v9 offset:63776
v_mfma_f32_16x16x32_bf16 v[76:79], v[120:123], v[140:143], v[76:79]
v_mfma_f32_16x16x32_bf16 v[96:99], v[124:127], v[140:143], v[96:99]
v_mfma_f32_16x16x32_bf16 v[40:43], v[112:115], v[144:147], v[40:43]
v_mfma_f32_16x16x32_bf16 v[60:63], v[116:119], v[144:147], v[60:63]
v_mfma_f32_16x16x32_bf16 v[80:83], v[120:123], v[144:147], v[80:83]
v_mfma_f32_16x16x32_bf16 v[100:103], v[124:127], v[144:147], v[100:103]
s_waitcnt lgkmcnt(0)
s_barrier
v_mfma_f32_16x16x32_bf16 v[24:27], v[160:163], v[176:179], v[24:27]
ds_read_b64_tr_b16 v[128:129], v10 offset:16384
v_mfma_f32_16x16x32_bf16 v[44:47], v[164:167], v[176:179], v[44:47]
ds_read_b64_tr_b16 v[130:131], v10 offset:17664
v_mfma_f32_16x16x32_bf16 v[64:67], v[168:171], v[176:179], v[64:67]
ds_read_b128 v[112:115], v7 offset:0
v_mfma_f32_16x16x32_bf16 v[84:87], v[172:175], v[176:179], v[84:87]
ds_read_b128 v[116:119], v7 offset:2048
v_mfma_f32_16x16x32_bf16 v[28:31], v[160:163], v[180:183], v[28:31]
ds_read_b128 v[120:123], v7 offset:4096
v_mfma_f32_16x16x32_bf16 v[48:51], v[164:167], v[180:183], v[48:51]
ds_read_b128 v[124:127], v7 offset:6144
v_mfma_f32_16x16x32_bf16 v[68:71], v[168:171], v[180:183], v[68:71]
ds_read_b64_tr_b16 v[132:133], v10 offset:16392
v_mfma_f32_16x16x32_bf16 v[88:91], v[172:175], v[180:183], v[88:91]
ds_read_b64_tr_b16 v[134:135], v10 offset:17672
v_mfma_f32_16x16x32_bf16 v[32:35], v[160:163], v[184:187], v[32:35]
ds_read_b64_tr_b16 v[136:137], v10 offset:16400
v_mfma_f32_16x16x32_bf16 v[52:55], v[164:167], v[184:187], v[52:55]
ds_read_b64_tr_b16 v[138:139], v10 offset:17680
v_mfma_f32_16x16x32_bf16 v[72:75], v[168:171], v[184:187], v[72:75]
ds_read_b64_tr_b16 v[140:141], v10 offset:16408
v_mfma_f32_16x16x32_bf16 v[92:95], v[172:175], v[184:187], v[92:95]
ds_read_b64_tr_b16 v[142:143], v10 offset:17688
v_mfma_f32_16x16x32_bf16 v[36:39], v[160:163], v[188:191], v[36:39]
ds_read_b64_tr_b16 v[144:145], v10 offset:16416
v_mfma_f32_16x16x32_bf16 v[56:59], v[164:167], v[188:191], v[56:59]
ds_read_b64_tr_b16 v[146:147], v10 offset:17696
v_mfma_f32_16x16x32_bf16 v[76:79], v[168:171], v[188:191], v[76:79]
v_mfma_f32_16x16x32_bf16 v[96:99], v[172:175], v[188:191], v[96:99]
v_mfma_f32_16x16x32_bf16 v[40:43], v[160:163], v[192:195], v[40:43]
v_mfma_f32_16x16x32_bf16 v[60:63], v[164:167], v[192:195], v[60:63]
v_mfma_f32_16x16x32_bf16 v[80:83], v[168:171], v[192:195], v[80:83]
v_mfma_f32_16x16x32_bf16 v[100:103], v[172:175], v[192:195], v[100:103]
s_waitcnt lgkmcnt(0)
v_mfma_f32_16x16x32_bf16 v[24:27], v[112:115], v[128:131], v[24:27]
ds_read_b64_tr_b16 v[176:177], v10 offset:21504
v_mfma_f32_16x16x32_bf16 v[44:47], v[116:119], v[128:131], v[44:47]
ds_read_b64_tr_b16 v[178:179], v10 offset:22784
v_mfma_f32_16x16x32_bf16 v[64:67], v[120:123], v[128:131], v[64:67]
ds_read_b128 v[160:163], v8 offset:0
v_mfma_f32_16x16x32_bf16 v[84:87], v[124:127], v[128:131], v[84:87]
ds_read_b128 v[164:167], v8 offset:2048
v_mfma_f32_16x16x32_bf16 v[28:31], v[112:115], v[132:135], v[28:31]
ds_read_b128 v[168:171], v8 offset:4096
v_mfma_f32_16x16x32_bf16 v[48:51], v[116:119], v[132:135], v[48:51]
ds_read_b128 v[172:175], v8 offset:6144
v_mfma_f32_16x16x32_bf16 v[68:71], v[120:123], v[132:135], v[68:71]
ds_read_b64_tr_b16 v[180:181], v10 offset:21512
v_mfma_f32_16x16x32_bf16 v[88:91], v[124:127], v[132:135], v[88:91]
ds_read_b64_tr_b16 v[182:183], v10 offset:22792
v_mfma_f32_16x16x32_bf16 v[32:35], v[112:115], v[136:139], v[32:35]
ds_read_b64_tr_b16 v[184:185], v10 offset:21520
v_mfma_f32_16x16x32_bf16 v[52:55], v[116:119], v[136:139], v[52:55]
ds_read_b64_tr_b16 v[186:187], v10 offset:22800
v_mfma_f32_16x16x32_bf16 v[72:75], v[120:123], v[136:139], v[72:75]
ds_read_b64_tr_b16 v[188:189], v10 offset:21528
v_mfma_f32_16x16x32_bf16 v[92:95], v[124:127], v[136:139], v[92:95]
ds_read_b64_tr_b16 v[190:191], v10 offset:22808
v_mfma_f32_16x16x32_bf16 v[36:39], v[112:115], v[140:143], v[36:39]
ds_read_b64_tr_b16 v[192:193], v10 offset:21536
v_mfma_f32_16x16x32_bf16 v[56:59], v[116:119], v[140:143], v[56:59]
ds_read_b64_tr_b16 v[194:195], v10 offset:22816
v_mfma_f32_16x16x32_bf16 v[76:79], v[120:123], v[140:143], v[76:79]
v_mfma_f32_16x16x32_bf16 v[96:99], v[124:127], v[140:143], v[96:99]
v_mfma_f32_16x16x32_bf16 v[40:43], v[112:115], v[144:147], v[40:43]
v_mfma_f32_16x16x32_bf16 v[60:63], v[116:119], v[144:147], v[60:63]
v_mfma_f32_16x16x32_bf16 v[80:83], v[120:123], v[144:147], v[80:83]
v_mfma_f32_16x16x32_bf16 v[100:103], v[124:127], v[144:147], v[100:103]
s_waitcnt lgkmcnt(0)
s_barrier
v_mfma_f32_16x16x32_bf16 v[24:27], v[160:163], v[176:179], v[24:27]
ds_read_b64_tr_b16 v[128:129], v10 offset:57344
v_mfma_f32_16x16x32_bf16 v[44:47], v[164:167], v[176:179], v[44:47]
ds_read_b64_tr_b16 v[130:131], v10 offset:58624
v_mfma_f32_16x16x32_bf16 v[64:67], v[168:171], v[176:179], v[64:67]
ds_read_b128 v[112:115], v7 offset:40960
v_mfma_f32_16x16x32_bf16 v[84:87], v[172:175], v[176:179], v[84:87]
ds_read_b128 v[116:119], v7 offset:43008
v_mfma_f32_16x16x32_bf16 v[28:31], v[160:163], v[180:183], v[28:31]
ds_read_b128 v[120:123], v7 offset:45056
v_mfma_f32_16x16x32_bf16 v[48:51], v[164:167], v[180:183], v[48:51]
ds_read_b128 v[124:127], v7 offset:47104
v_mfma_f32_16x16x32_bf16 v[68:71], v[168:171], v[180:183], v[68:71]
ds_read_b64_tr_b16 v[132:133], v10 offset:57352
v_mfma_f32_16x16x32_bf16 v[88:91], v[172:175], v[180:183], v[88:91]
ds_read_b64_tr_b16 v[134:135], v10 offset:58632
v_mfma_f32_16x16x32_bf16 v[32:35], v[160:163], v[184:187], v[32:35]
ds_read_b64_tr_b16 v[136:137], v10 offset:57360
v_mfma_f32_16x16x32_bf16 v[52:55], v[164:167], v[184:187], v[52:55]
ds_read_b64_tr_b16 v[138:139], v10 offset:58640
v_mfma_f32_16x16x32_bf16 v[72:75], v[168:171], v[184:187], v[72:75]
ds_read_b64_tr_b16 v[140:141], v10 offset:57368
v_mfma_f32_16x16x32_bf16 v[92:95], v[172:175], v[184:187], v[92:95]
ds_read_b64_tr_b16 v[142:143], v10 offset:58648
v_mfma_f32_16x16x32_bf16 v[36:39], v[160:163], v[188:191], v[36:39]
ds_read_b64_tr_b16 v[144:145], v10 offset:57376
v_mfma_f32_16x16x32_bf16 v[56:59], v[164:167], v[188:191], v[56:59]
ds_read_b64_tr_b16 v[146:147], v10 offset:58656
v_mfma_f32_16x16x32_bf16 v[76:79], v[168:171], v[188:191], v[76:79]
v_mfma_f32_16x16x32_bf16 v[96:99], v[172:175], v[188:191], v[96:99]
v_mfma_f32_16x16x32_bf16 v[40:43], v[160:163], v[192:195], v[40:43]
v_mfma_f32_16x16x32_bf16 v[60:63], v[164:167], v[192:195], v[60:63]
v_mfma_f32_16x16x32_bf16 v[80:83], v[168:171], v[192:195], v[80:83]
v_mfma_f32_16x16x32_bf16 v[100:103], v[172:175], v[192:195], v[100:103]
s_waitcnt lgkmcnt(0)
v_mfma_f32_16x16x32_bf16 v[24:27], v[112:115], v[128:131], v[24:27]
ds_read_b64_tr_b16 v[176:177], v10 offset:62464
v_mfma_f32_16x16x32_bf16 v[44:47], v[116:119], v[128:131], v[44:47]
ds_read_b64_tr_b16 v[178:179], v10 offset:63744
v_mfma_f32_16x16x32_bf16 v[64:67], v[120:123], v[128:131], v[64:67]
ds_read_b128 v[160:163], v8 offset:40960
v_mfma_f32_16x16x32_bf16 v[84:87], v[124:127], v[128:131], v[84:87]
ds_read_b128 v[164:167], v8 offset:43008
v_mfma_f32_16x16x32_bf16 v[28:31], v[112:115], v[132:135], v[28:31]
ds_read_b128 v[168:171], v8 offset:45056
v_mfma_f32_16x16x32_bf16 v[48:51], v[116:119], v[132:135], v[48:51]
ds_read_b128 v[172:175], v8 offset:47104
v_mfma_f32_16x16x32_bf16 v[68:71], v[120:123], v[132:135], v[68:71]
ds_read_b64_tr_b16 v[180:181], v10 offset:62472
v_mfma_f32_16x16x32_bf16 v[88:91], v[124:127], v[132:135], v[88:91]
ds_read_b64_tr_b16 v[182:183], v10 offset:63752
v_mfma_f32_16x16x32_bf16 v[32:35], v[112:115], v[136:139], v[32:35]
ds_read_b64_tr_b16 v[184:185], v10 offset:62480
v_mfma_f32_16x16x32_bf16 v[52:55], v[116:119], v[136:139], v[52:55]
ds_read_b64_tr_b16 v[186:187], v10 offset:63760
v_mfma_f32_16x16x32_bf16 v[72:75], v[120:123], v[136:139], v[72:75]
ds_read_b64_tr_b16 v[188:189], v10 offset:62488
v_mfma_f32_16x16x32_bf16 v[92:95], v[124:127], v[136:139], v[92:95]
ds_read_b64_tr_b16 v[190:191], v10 offset:63768
v_mfma_f32_16x16x32_bf16 v[36:39], v[112:115], v[140:143], v[36:39]
ds_read_b64_tr_b16 v[192:193], v10 offset:62496
v_mfma_f32_16x16x32_bf16 v[56:59], v[116:119], v[140:143], v[56:59]
ds_read_b64_tr_b16 v[194:195], v10 offset:63776
v_mfma_f32_16x16x32_bf16 v[76:79], v[120:123], v[140:143], v[76:79]
v_mfma_f32_16x16x32_bf16 v[96:99], v[124:127], v[140:143], v[96:99]
v_mfma_f32_16x16x32_bf16 v[40:43], v[112:115], v[144:147], v[40:43]
v_mfma_f32_16x16x32_bf16 v[60:63], v[116:119], v[144:147], v[60:63]
v_mfma_f32_16x16x32_bf16 v[80:83], v[120:123], v[144:147], v[80:83]
v_mfma_f32_16x16x32_bf16 v[100:103], v[124:127], v[144:147], v[100:103]
s_waitcnt lgkmcnt(0)
s_barrier
v_mfma_f32_16x16x32_bf16 v[24:27], v[160:163], v[176:179], v[24:27]
ds_read_b64_tr_b16 v[128:129], v9 offset:16384
v_mfma_f32_16x16x32_bf16 v[44:47], v[164:167], v[176:179], v[44:47]
ds_read_b64_tr_b16 v[130:131], v9 offset:17664
v_mfma_f32_16x16x32_bf16 v[64:67], v[168:171], v[176:179], v[64:67]
ds_read_b128 v[112:115], v5 offset:0
v_mfma_f32_16x16x32_bf16 v[84:87], v[172:175], v[176:179], v[84:87]
ds_read_b128 v[116:119], v5 offset:2048
v_mfma_f32_16x16x32_bf16 v[28:31], v[160:163], v[180:183], v[28:31]
ds_read_b128 v[120:123], v5 offset:4096
v_mfma_f32_16x16x32_bf16 v[48:51], v[164:167], v[180:183], v[48:51]
ds_read_b128 v[124:127], v5 offset:6144
v_mfma_f32_16x16x32_bf16 v[68:71], v[168:171], v[180:183], v[68:71]
ds_read_b64_tr_b16 v[132:133], v9 offset:16392
v_mfma_f32_16x16x32_bf16 v[88:91], v[172:175], v[180:183], v[88:91]
ds_read_b64_tr_b16 v[134:135], v9 offset:17672
v_mfma_f32_16x16x32_bf16 v[32:35], v[160:163], v[184:187], v[32:35]
ds_read_b64_tr_b16 v[136:137], v9 offset:16400
v_mfma_f32_16x16x32_bf16 v[52:55], v[164:167], v[184:187], v[52:55]
ds_read_b64_tr_b16 v[138:139], v9 offset:17680
v_mfma_f32_16x16x32_bf16 v[72:75], v[168:171], v[184:187], v[72:75]
ds_read_b64_tr_b16 v[140:141], v9 offset:16408
v_mfma_f32_16x16x32_bf16 v[92:95], v[172:175], v[184:187], v[92:95]
ds_read_b64_tr_b16 v[142:143], v9 offset:17688
v_mfma_f32_16x16x32_bf16 v[36:39], v[160:163], v[188:191], v[36:39]
ds_read_b64_tr_b16 v[144:145], v9 offset:16416
v_mfma_f32_16x16x32_bf16 v[56:59], v[164:167], v[188:191], v[56:59]
ds_read_b64_tr_b16 v[146:147], v9 offset:17696
v_mfma_f32_16x16x32_bf16 v[76:79], v[168:171], v[188:191], v[76:79]
v_mfma_f32_16x16x32_bf16 v[96:99], v[172:175], v[188:191], v[96:99]
v_mfma_f32_16x16x32_bf16 v[40:43], v[160:163], v[192:195], v[40:43]
v_mfma_f32_16x16x32_bf16 v[60:63], v[164:167], v[192:195], v[60:63]
v_mfma_f32_16x16x32_bf16 v[80:83], v[168:171], v[192:195], v[80:83]
v_mfma_f32_16x16x32_bf16 v[100:103], v[172:175], v[192:195], v[100:103]
s_waitcnt lgkmcnt(0)
v_mfma_f32_16x16x32_bf16 v[24:27], v[112:115], v[128:131], v[24:27]
ds_read_b64_tr_b16 v[176:177], v9 offset:21504
v_mfma_f32_16x16x32_bf16 v[44:47], v[116:119], v[128:131], v[44:47]
ds_read_b64_tr_b16 v[178:179], v9 offset:22784
v_mfma_f32_16x16x32_bf16 v[64:67], v[120:123], v[128:131], v[64:67]
ds_read_b128 v[160:163], v6 offset:0
v_mfma_f32_16x16x32_bf16 v[84:87], v[124:127], v[128:131], v[84:87]
ds_read_b128 v[164:167], v6 offset:2048
v_mfma_f32_16x16x32_bf16 v[28:31], v[112:115], v[132:135], v[28:31]
ds_read_b128 v[168:171], v6 offset:4096
v_mfma_f32_16x16x32_bf16 v[48:51], v[116:119], v[132:135], v[48:51]
ds_read_b128 v[172:175], v6 offset:6144
v_mfma_f32_16x16x32_bf16 v[68:71], v[120:123], v[132:135], v[68:71]
ds_read_b64_tr_b16 v[180:181], v9 offset:21512
v_mfma_f32_16x16x32_bf16 v[88:91], v[124:127], v[132:135], v[88:91]
ds_read_b64_tr_b16 v[182:183], v9 offset:22792
v_mfma_f32_16x16x32_bf16 v[32:35], v[112:115], v[136:139], v[32:35]
ds_read_b64_tr_b16 v[184:185], v9 offset:21520
v_mfma_f32_16x16x32_bf16 v[52:55], v[116:119], v[136:139], v[52:55]
ds_read_b64_tr_b16 v[186:187], v9 offset:22800
v_mfma_f32_16x16x32_bf16 v[72:75], v[120:123], v[136:139], v[72:75]
ds_read_b64_tr_b16 v[188:189], v9 offset:21528
v_mfma_f32_16x16x32_bf16 v[92:95], v[124:127], v[136:139], v[92:95]
ds_read_b64_tr_b16 v[190:191], v9 offset:22808
v_mfma_f32_16x16x32_bf16 v[36:39], v[112:115], v[140:143], v[36:39]
ds_read_b64_tr_b16 v[192:193], v9 offset:21536
v_mfma_f32_16x16x32_bf16 v[56:59], v[116:119], v[140:143], v[56:59]
ds_read_b64_tr_b16 v[194:195], v9 offset:22816
v_mfma_f32_16x16x32_bf16 v[76:79], v[120:123], v[140:143], v[76:79]
v_mfma_f32_16x16x32_bf16 v[96:99], v[124:127], v[140:143], v[96:99]
v_mfma_f32_16x16x32_bf16 v[40:43], v[112:115], v[144:147], v[40:43]
v_mfma_f32_16x16x32_bf16 v[60:63], v[116:119], v[144:147], v[60:63]
v_mfma_f32_16x16x32_bf16 v[80:83], v[120:123], v[144:147], v[80:83]
v_mfma_f32_16x16x32_bf16 v[100:103], v[124:127], v[144:147], v[100:103]
s_waitcnt lgkmcnt(0)
s_barrier
v_mfma_f32_16x16x32_bf16 v[24:27], v[160:163], v[176:179], v[24:27]
ds_read_b64_tr_b16 v[128:129], v9 offset:57344
v_mfma_f32_16x16x32_bf16 v[44:47], v[164:167], v[176:179], v[44:47]
ds_read_b64_tr_b16 v[130:131], v9 offset:58624
v_mfma_f32_16x16x32_bf16 v[64:67], v[168:171], v[176:179], v[64:67]
ds_read_b128 v[112:115], v5 offset:40960
v_mfma_f32_16x16x32_bf16 v[84:87], v[172:175], v[176:179], v[84:87]
ds_read_b128 v[116:119], v5 offset:43008
v_mfma_f32_16x16x32_bf16 v[28:31], v[160:163], v[180:183], v[28:31]
ds_read_b128 v[120:123], v5 offset:45056
v_mfma_f32_16x16x32_bf16 v[48:51], v[164:167], v[180:183], v[48:51]
ds_read_b128 v[124:127], v5 offset:47104
v_mfma_f32_16x16x32_bf16 v[68:71], v[168:171], v[180:183], v[68:71]
ds_read_b64_tr_b16 v[132:133], v9 offset:57352
v_mfma_f32_16x16x32_bf16 v[88:91], v[172:175], v[180:183], v[88:91]
ds_read_b64_tr_b16 v[134:135], v9 offset:58632
v_mfma_f32_16x16x32_bf16 v[32:35], v[160:163], v[184:187], v[32:35]
ds_read_b64_tr_b16 v[136:137], v9 offset:57360
v_mfma_f32_16x16x32_bf16 v[52:55], v[164:167], v[184:187], v[52:55]
ds_read_b64_tr_b16 v[138:139], v9 offset:58640
v_mfma_f32_16x16x32_bf16 v[72:75], v[168:171], v[184:187], v[72:75]
ds_read_b64_tr_b16 v[140:141], v9 offset:57368
v_mfma_f32_16x16x32_bf16 v[92:95], v[172:175], v[184:187], v[92:95]
ds_read_b64_tr_b16 v[142:143], v9 offset:58648
v_mfma_f32_16x16x32_bf16 v[36:39], v[160:163], v[188:191], v[36:39]
ds_read_b64_tr_b16 v[144:145], v9 offset:57376
v_mfma_f32_16x16x32_bf16 v[56:59], v[164:167], v[188:191], v[56:59]
ds_read_b64_tr_b16 v[146:147], v9 offset:58656
v_mfma_f32_16x16x32_bf16 v[76:79], v[168:171], v[188:191], v[76:79]
v_mfma_f32_16x16x32_bf16 v[96:99], v[172:175], v[188:191], v[96:99]
v_mfma_f32_16x16x32_bf16 v[40:43], v[160:163], v[192:195], v[40:43]
v_mfma_f32_16x16x32_bf16 v[60:63], v[164:167], v[192:195], v[60:63]
v_mfma_f32_16x16x32_bf16 v[80:83], v[168:171], v[192:195], v[80:83]
v_mfma_f32_16x16x32_bf16 v[100:103], v[172:175], v[192:195], v[100:103]
s_waitcnt lgkmcnt(0)
v_mfma_f32_16x16x32_bf16 v[24:27], v[112:115], v[128:131], v[24:27]
ds_read_b64_tr_b16 v[176:177], v9 offset:62464
v_mfma_f32_16x16x32_bf16 v[44:47], v[116:119], v[128:131], v[44:47]
ds_read_b64_tr_b16 v[178:179], v9 offset:63744
v_mfma_f32_16x16x32_bf16 v[64:67], v[120:123], v[128:131], v[64:67]
ds_read_b128 v[160:163], v6 offset:40960
v_mfma_f32_16x16x32_bf16 v[84:87], v[124:127], v[128:131], v[84:87]
ds_read_b128 v[164:167], v6 offset:43008
v_mfma_f32_16x16x32_bf16 v[28:31], v[112:115], v[132:135], v[28:31]
ds_read_b128 v[168:171], v6 offset:45056
v_mfma_f32_16x16x32_bf16 v[48:51], v[116:119], v[132:135], v[48:51]
ds_read_b128 v[172:175], v6 offset:47104
v_mfma_f32_16x16x32_bf16 v[68:71], v[120:123], v[132:135], v[68:71]
ds_read_b64_tr_b16 v[180:181], v9 offset:62472
v_mfma_f32_16x16x32_bf16 v[88:91], v[124:127], v[132:135], v[88:91]
ds_read_b64_tr_b16 v[182:183], v9 offset:63752
v_mfma_f32_16x16x32_bf16 v[32:35], v[112:115], v[136:139], v[32:35]
ds_read_b64_tr_b16 v[184:185], v9 offset:62480
v_mfma_f32_16x16x32_bf16 v[52:55], v[116:119], v[136:139], v[52:55]
ds_read_b64_tr_b16 v[186:187], v9 offset:63760
v_mfma_f32_16x16x32_bf16 v[72:75], v[120:123], v[136:139], v[72:75]
ds_read_b64_tr_b16 v[188:189], v9 offset:62488
v_mfma_f32_16x16x32_bf16 v[92:95], v[124:127], v[136:139], v[92:95]
ds_read_b64_tr_b16 v[190:191], v9 offset:63768
v_mfma_f32_16x16x32_bf16 v[36:39], v[112:115], v[140:143], v[36:39]
ds_read_b64_tr_b16 v[192:193], v9 offset:62496
v_mfma_f32_16x16x32_bf16 v[56:59], v[116:119], v[140:143], v[56:59]
ds_read_b64_tr_b16 v[194:195], v9 offset:63776
v_mfma_f32_16x16x32_bf16 v[76:79], v[120:123], v[140:143], v[76:79]
v_mfma_f32_16x16x32_bf16 v[96:99], v[124:127], v[140:143], v[96:99]
v_mfma_f32_16x16x32_bf16 v[40:43], v[112:115], v[144:147], v[40:43]
v_mfma_f32_16x16x32_bf16 v[60:63], v[116:119], v[144:147], v[60:63]
v_mfma_f32_16x16x32_bf16 v[80:83], v[120:123], v[144:147], v[80:83]
v_mfma_f32_16x16x32_bf16 v[100:103], v[124:127], v[144:147], v[100:103]
s_waitcnt lgkmcnt(0)
v_mfma_f32_16x16x32_bf16 v[24:27], v[160:163], v[176:179], v[24:27]
v_mfma_f32_16x16x32_bf16 v[44:47], v[164:167], v[176:179], v[44:47]
v_mfma_f32_16x16x32_bf16 v[64:67], v[168:171], v[176:179], v[64:67]
v_mfma_f32_16x16x32_bf16 v[84:87], v[172:175], v[176:179], v[84:87]
v_mfma_f32_16x16x32_bf16 v[28:31], v[160:163], v[180:183], v[28:31]
v_mfma_f32_16x16x32_bf16 v[48:51], v[164:167], v[180:183], v[48:51]
v_mfma_f32_16x16x32_bf16 v[68:71], v[168:171], v[180:183], v[68:71]
v_mfma_f32_16x16x32_bf16 v[88:91], v[172:175], v[180:183], v[88:91]
v_mfma_f32_16x16x32_bf16 v[32:35], v[160:163], v[184:187], v[32:35]
v_mfma_f32_16x16x32_bf16 v[52:55], v[164:167], v[184:187], v[52:55]
v_mfma_f32_16x16x32_bf16 v[72:75], v[168:171], v[184:187], v[72:75]
v_mfma_f32_16x16x32_bf16 v[92:95], v[172:175], v[184:187], v[92:95]
v_mfma_f32_16x16x32_bf16 v[36:39], v[160:163], v[188:191], v[36:39]
v_mfma_f32_16x16x32_bf16 v[56:59], v[164:167], v[188:191], v[56:59]
v_mfma_f32_16x16x32_bf16 v[76:79], v[168:171], v[188:191], v[76:79]
v_mfma_f32_16x16x32_bf16 v[96:99], v[172:175], v[188:191], v[96:99]
v_mfma_f32_16x16x32_bf16 v[40:43], v[160:163], v[192:195], v[40:43]
v_mfma_f32_16x16x32_bf16 v[60:63], v[164:167], v[192:195], v[60:63]
v_mfma_f32_16x16x32_bf16 v[80:83], v[168:171], v[192:195], v[80:83]
v_mfma_f32_16x16x32_bf16 v[100:103], v[172:175], v[192:195], v[100:103]
s_mul_i32 s50, s58, 163840
s_mul_i32 s51, s56, 2560
s_add_u32 s50, s50, s51
s_mov_b32 s48, 163840
v_lshrrev_b32 v17, 2, v2
v_mul_lo_u32 v17, v17, s48
v_mul_u32_u24 v18, 320, v3
v_add_u32 v17, v17, v18
v_and_b32 v18, 3, v2
v_lshl_add_u32 v17, v18, 4, v17
v_cvt_pk_bf16_f32 v112, v24, v25
v_cvt_pk_bf16_f32 v113, v26, v27
v_cvt_pk_bf16_f32 v114, v44, v45
v_cvt_pk_bf16_f32 v115, v46, v47
buffer_store_dwordx4 v[112:115], v17, s[44:47], s50 offen offset:1280 sc1
v_cvt_pk_bf16_f32 v116, v28, v29
v_cvt_pk_bf16_f32 v117, v30, v31
v_cvt_pk_bf16_f32 v118, v48, v49
v_cvt_pk_bf16_f32 v119, v50, v51
buffer_store_dwordx4 v[116:119], v17, s[44:47], s50 offen offset:1344 sc1
v_cvt_pk_bf16_f32 v120, v32, v33
v_cvt_pk_bf16_f32 v121, v34, v35
v_cvt_pk_bf16_f32 v122, v52, v53
v_cvt_pk_bf16_f32 v123, v54, v55
buffer_store_dwordx4 v[120:123], v17, s[44:47], s50 offen offset:1408 sc1
v_cvt_pk_bf16_f32 v124, v36, v37
v_cvt_pk_bf16_f32 v125, v38, v39
v_cvt_pk_bf16_f32 v126, v56, v57
v_cvt_pk_bf16_f32 v127, v58, v59
buffer_store_dwordx4 v[124:127], v17, s[44:47], s50 offen offset:1472 sc1
v_cvt_pk_bf16_f32 v128, v40, v41
v_cvt_pk_bf16_f32 v129, v42, v43
v_cvt_pk_bf16_f32 v130, v60, v61
v_cvt_pk_bf16_f32 v131, v62, v63
buffer_store_dwordx4 v[128:131], v17, s[44:47], s50 offen offset:1536 sc1
s_add_u32 s50, s50, 2560
v_cvt_pk_bf16_f32 v132, v64, v65
v_cvt_pk_bf16_f32 v133, v66, v67
v_cvt_pk_bf16_f32 v134, v84, v85
v_cvt_pk_bf16_f32 v135, v86, v87
buffer_store_dwordx4 v[132:135], v17, s[44:47], s50 offen offset:1280 sc1
v_cvt_pk_bf16_f32 v136, v68, v69
v_cvt_pk_bf16_f32 v137, v70, v71
v_cvt_pk_bf16_f32 v138, v88, v89
v_cvt_pk_bf16_f32 v139, v90, v91
buffer_store_dwordx4 v[136:139], v17, s[44:47], s50 offen offset:1344 sc1
v_cvt_pk_bf16_f32 v140, v72, v73
v_cvt_pk_bf16_f32 v141, v74, v75
v_cvt_pk_bf16_f32 v142, v92, v93
v_cvt_pk_bf16_f32 v143, v94, v95
buffer_store_dwordx4 v[140:143], v17, s[44:47], s50 offen offset:1408 sc1
v_cvt_pk_bf16_f32 v144, v76, v77
v_cvt_pk_bf16_f32 v145, v78, v79
v_cvt_pk_bf16_f32 v146, v96, v97
v_cvt_pk_bf16_f32 v147, v98, v99
buffer_store_dwordx4 v[144:147], v17, s[44:47], s50 offen offset:1472 sc1
v_cvt_pk_bf16_f32 v148, v80, v81
v_cvt_pk_bf16_f32 v149, v82, v83
v_cvt_pk_bf16_f32 v150, v100, v101
v_cvt_pk_bf16_f32 v151, v102, v103
buffer_store_dwordx4 v[148:151], v17, s[44:47], s50 offen offset:1536 sc1
s_nop 1
s_branch attn
concat_heads__mha_block__grouped_kv_mqa__prompt_kernel_end:
s_endpgm
attn:
s_load_dwordx2 s[68:69], s[0:1], 16
s_load_dwordx4 s[72:75], s[0:1], 56
s_load_dwordx2 s[84:85], s[0:1], 72
v_lshrrev_b32 v4, 6, v0
v_and_b32 v141, 63, v0
v_readfirstlane_b32 s11, v4
s_and_b32 s6, s2, 7
s_lshr_b32 s7, s2, 3
s_and_b32 s8, s6, 1
s_xor_b32 s8, s8, 1
s_lshr_b32 s9, s6, 1
s_lshr_b32 s10, s7, 2
s_lshl3_add_u32 s9, s9, s10
s_and_b32 s10, s7, 3
s_mov_b32 s16, s4
s_and_b32 s17, s5, 0xffff
s_mov_b32 s18, 0x10000000
s_mov_b32 s19, 0x00020000
s_movk_i32 s86, 256
s_mov_b32 s87, 0x00020000
s_mov_b32 s78, 819200
s_mov_b32 s79, 0x00020000
s_mov_b32 s82, 5242880
s_mov_b32 s83, 0x00020000
v_mov_b32 v5, 0
v_lshlrev_b32 v135, 4, v141
s_bitcmp1_b32 s2, 2
s_waitcnt lgkmcnt(0)
s_cselect_b32 s76, s72, s68
s_cselect_b32 s77, s73, s69
s_and_b32 s77, s77, 0xffff
s_mov_b32 s80, s74
s_and_b32 s81, s75, 0xffff
s_mov_b32 s72, s84
s_and_b32 s73, s85, 0xffff
s_movk_i32 s74, 256
s_mov_b32 s75, 0x00020000
buffer_load_dword v140, v5, s[72:75], 0 offen sc1
s_mov_b32 s30, 0
v_mov_b32 v64, 121856
attn_nonce:
s_waitcnt vmcnt(0)
v_readfirstlane_b32 s100, v140
s_add_u32 s30, s30, 1
s_cmp_gt_u32 s30, 0x8000
s_cbranch_scc1 attn_nonce1
s_cmp_lg_u32 s100, 0
s_cbranch_scc1 attn_nonce1
buffer_load_dword v140, v5, s[72:75], 0 offen sc1
s_branch attn_nonce
attn_nonce1:
s_cmp_ge_u32 s11, 4
s_cbranch_scc1 attn_nosig
s_mov_b64 exec, 1
v_mov_b32 v65, 1
ds_add_rtn_u32 v65, v64, v65
s_waitcnt lgkmcnt(0)
v_readfirstlane_b32 s32, v65
s_cmp_lg_u32 s32, 3
s_cbranch_scc1 attn_nosig
buffer_store_dword v140, v5, s[16:19], s3 offen sc1
attn_nosig:
s_mov_b64 exec, -1
s_and_b32 s87, s7, 7
s_mul_i32 s87, s87, 160
s_and_b32 s88, s6, 3
s_lshl_b32 s88, s88, 2
s_lshr_b32 s89, s7, 3
s_add_u32 s88, s88, s89
s_lshr_b32 s89, s6, 2
v_and_b32 v6, 31, v141
v_lshrrev_b32 v7, 5, v141
v_and_b32 v139, 15, v141
s_cmp_lt_u32 s11, 4
s_cbranch_scc1 attn_cold
s_lshl4_add_u32 s92, s89, s88
s_lshl_b32 s92, s92, 13
s_add_u32 s92, s92, 18874368
s_and_b32 s98, s11, 3
s_mul_i32 s88, s98, 40960
s_add_u32 s88, s88, s87
v_mul_u32_u24 v246, 52429, v141
v_lshrrev_b32 v246, 19, v246
v_mul_u32_u24 v246, 1120, v246
v_lshl_add_u32 v251, v141, 4, v246
v_add_u32 v250, 64, v141
v_mul_u32_u24 v246, 52429, v250
v_lshrrev_b32 v246, 19, v246
v_mul_u32_u24 v246, 1120, v246
v_lshl_add_u32 v252, v250, 4, v246
v_add_u32 v250, 128, v141
v_mul_u32_u24 v246, 52429, v250
v_lshrrev_b32 v246, 19, v246
v_mul_u32_u24 v246, 1120, v246
v_lshl_add_u32 v253, v250, 4, v246
v_add_u32 v250, 192, v141
v_mul_u32_u24 v246, 52429, v250
v_lshrrev_b32 v246, 19, v246
v_mul_u32_u24 v246, 1120, v246
v_lshl_add_u32 v254, v250, 4, v246
v_add_u32 v250, 256, v141
v_mul_u32_u24 v246, 52429, v250
v_lshrrev_b32 v246, 19, v246
v_mul_u32_u24 v246, 1120, v246
v_lshl_add_u32 v255, v250, 4, v246
s_mul_i32 s98, s98, 5120
v_add_u32 v244, s98, v135
v_add_u32 v245, 61440, v244
s_mov_b32 s34, 7
s_branch attn_setup
attn_cold:
s_lshl2_add_u32 s88, s88, s11
s_mul_i32 s90, s88, 81920
s_mul_i32 s91, s89, 1280
s_add_u32 s90, s90, s91
s_add_u32 s90, s90, s87
s_lshl_b32 s91, s89, 6
s_add_u32 s91, s91, s88
s_mul_i32 s91, s91, 40960
s_add_u32 s91, s91, 12582912
s_mov_b32 s93, s7
s_and_b32 s93, s93, 3
s_mul_i32 s94, s93, 25600
s_mul_i32 s84, s93, 5120
s_add_u32 s84, s84, s91
s_add_u32 s93, s93, 1
s_and_b32 s93, s93, 3
s_mul_i32 s95, s93, 25600
s_mul_i32 s85, s93, 5120
s_add_u32 s85, s85, s91
s_add_u32 s93, s93, 1
s_and_b32 s93, s93, 3
s_mul_i32 s96, s93, 25600
s_mul_i32 s86, s93, 5120
s_add_u32 s86, s86, s91
s_add_u32 s93, s93, 1
s_and_b32 s93, s93, 3
s_mul_i32 s97, s93, 25600
s_mul_i32 s87, s93, 5120
s_add_u32 s87, s87, s91
v_add_u32 v244, 20480, v135
v_bfe_u32 v130, v141, 2, 2
v_mul_u32_u24 v130, 160, v130
v_and_b32 v131, 3, v141
v_mad_u32_u24 v130, v131, 40, v130
v_bfe_u32 v132, v141, 4, 1
v_mul_u32_u24 v133, 3200, v7
v_mul_u32_u24 v131, 640, v132
v_add3_u32 v247, v130, v133, v131
v_mul_u32_u24 v133, 12800, v7
v_mul_u32_u24 v131, 3200, v132
v_add3_u32 v248, v130, v133, v131
v_lshlrev_b32 v130, 9, v7
v_lshl_add_u32 v130, v132, 7, v130
v_lshl_add_u32 v130, v139, 3, v130
v_add_u32 v245, 4096, v130
v_add_u32 v246, 24576, v130
s_mul_i32 s98, s11, 5120
s_add_u32 s98, s98, 102400
v_lshrrev_b32 v131, 4, v141
v_mul_u32_u24 v130, 160, v139
v_mul_u32_u24 v131, 40, v131
v_add3_u32 v249, v130, v131, s98
v_add_u32 v250, s98, v135
v_mul_u32_u24 v132, 52429, v141
v_lshrrev_b32 v132, 19, v132
v_mul_u32_u24 v132, 2400, v132
v_lshl_add_u32 v251, v141, 4, v132
v_add_u32 v133, 64, v141
v_mul_u32_u24 v132, 52429, v133
v_lshrrev_b32 v132, 19, v132
v_mul_u32_u24 v132, 2400, v132
v_lshl_add_u32 v252, v133, 4, v132
v_add_u32 v133, 128, v141
v_mul_u32_u24 v132, 52429, v133
v_lshrrev_b32 v132, 19, v132
v_mul_u32_u24 v132, 2400, v132
v_lshl_add_u32 v253, v133, 4, v132
v_add_u32 v133, 192, v141
v_mul_u32_u24 v132, 52429, v133
v_lshrrev_b32 v132, 19, v132
v_mul_u32_u24 v132, 2400, v132
v_lshl_add_u32 v254, v133, 4, v132
v_add_u32 v133, 256, v141
v_mul_u32_u24 v132, 52429, v133
v_lshrrev_b32 v132, 19, v132
v_mul_u32_u24 v132, 2400, v132
v_lshl_add_u32 v255, v133, 4, v132
s_mov_b32 s34, 1
attn_setup:
s_cmp_eq_u32 s8, 0
s_cselect_b32 s12, s9, 32
s_mul_i32 s12, s12, 163840
s_lshl_b32 s13, s8, 5
s_add_u32 s13, s13, s9
s_lshl2_add_u32 s13, s13, s10
s_lshl3_add_u32 s13, s13, s11
s_mul_i32 s13, s13, 2560
s_add_u32 s13, s13, 6291456
s_lshl_b32 s15, s11, 10
v_add_u32 v4, s15, v135
s_mov_b32 s20, s12
s_mov_b32 s21, s15
s_mov_b32 s22, 0x000fffff
s_mov_b32 s23, 0x000fffff
s_mov_b32 s24, -1
s_mov_b32 s25, 0
s_mov_b32 s26, 0
s_mov_b32 s27, -1
s_mov_b32 s28, 0x11000000
s_mov_b32 s29, 0x11000000
v_mov_b32 v32, 0x3f803f80
v_mov_b32 v33, 0x00003f80
v_mov_b32 v34, 0x3f803f80
v_mov_b32 v35, 0x00003f80
v_mov_b64 v[12:13], 0
v_mov_b64 v[14:15], 0
v_cndmask_b32 v24, 0, v32, s[28:29]
v_mov_b32 v25, v24
v_mov_b64 v[26:27], v[24:25]
v_mov_b64 v[28:29], v[24:25]
v_mov_b64 v[30:31], v[24:25]
v_mov_b64 v[40:41], v[24:25]
v_mov_b64 v[42:43], v[24:25]
v_mov_b64 v[44:45], v[24:25]
v_mov_b64 v[46:47], v[24:25]
v_lshlrev_b32 v136, 3, v6
v_mul_u32_u24 v137, 320, v7
v_lshl_add_u32 v137, v6, 4, v137
v_bfe_u32 v138, v141, 4, 1
v_mul_u32_u24 v138, 20480, v138
v_lshl_add_u32 v134, v139, 3, v138
v_lshl_add_u32 v138, v139, 4, v138
v_lshl_add_u32 v138, v7, 8, v138
s_lshl2_add_u32 s31, s8, s10
s_lshl3_add_u32 s31, s31, s11
s_lshl_b32 s39, s31, 5
s_add_u32 s39, s39, s9
s_lshl_b32 s39, s39, 7
s_add_u32 s39, s39, 18874368
s_mul_i32 s31, s31, 81920
s_lshr_b32 s32, s9, 3
s_mul_i32 s32, s32, 5120
s_add_u32 s31, s31, s32
s_add_u32 s31, s31, 12582912
s_and_b32 s32, s9, 7
s_lshl_b32 s38, s32, 7
s_add_u32 s38, s38, s31
s_add_u32 s38, s38, 4096
s_lshl_b32 s32, s32, 9
s_add_u32 s31, s31, s32
s_mov_b32 s33, 1
s_mov_b32 s35, 0
v_mov_b64 v[56:57], 0
v_mov_b64 v[58:59], 0
v_mov_b64 v[60:61], 0
v_mov_b32 v1, v135
v_mov_b64 v[2:3], v[136:137]
v_mov_b32 v128, 0xff800000
v_mov_b32 v129, 0xff800000
v_mfma_f32_32x32x16_bf16 v[96:111], v[56:59], v[56:59], 0
v_mfma_f32_32x32x16_bf16 v[112:127], v[56:59], v[56:59], 0
v_mov_b32 v48, 0xdddddddd
s_cmp_lg_u32 s11, 4
s_cbranch_scc1 attn_bx
attn_poller:
v_and_b32 v65, 16, v141
v_lshl_add_u32 v66, v65, 2, v139
v_add_u32 v66, 64, v66
v_and_b32 v65, 3, v141
s_lshl_b32 s32, s10, 2
v_add_u32 v65, s32, v65
v_cndmask_b32 v66, v65, v66, s[24:25]
s_lshr_b32 s32, s9, 3
s_lshl_b32 s32, s32, 4
v_add_u32 v66, s32, v66
v_add_u32 v65, 192, v141
s_cmp_eq_u32 s8, 0
s_cselect_b64 vcc, -1, 0
v_cndmask_b32 v66, v65, v66, vcc
v_lshlrev_b32 v66, 7, v66
s_mov_b32 s32, 19398656
attn_lw:
s_sleep 2
ds_read_b32 v65, v64
s_waitcnt lgkmcnt(0)
v_readfirstlane_b32 s36, v65
s_cmp_lt_u32 s36, 4
s_cbranch_scc1 attn_lw
attn_poll1:
buffer_load_dword v65, v66, s[16:19], s32 offen sc1
s_add_u32 s30, s30, 1
s_waitcnt vmcnt(0)
v_cmp_ne_u32 vcc, s100, v65
s_cmp_gt_u32 s30, 0x8000
s_cbranch_scc1 attn_bx
s_nop 1
s_cbranch_vccz attn_bx
s_mov_b64 exec, vcc
s_sleep 12
s_branch attn_poll1
attn_bx:
s_mov_b64 exec, -1
s_mov_b32 s30, 0
s_cmp_ge_u32 s11, 4
s_barrier
s_cbranch_scc1 attn_noq
buffer_load_dwordx4 v[36:39], v135, s[16:19], s12 offen sc1
buffer_load_dwordx4 v[8:11], v135, s[16:19], s13 offen sc1
buffer_load_dwordx4 v[16:19], v135, s[16:19], s13 offen offset:1280 sc1
s_mov_b64 exec, s[24:25]
buffer_load_dwordx2 v[34:35], v136, s[16:19], s12 offen offset:1024 sc1
buffer_load_dwordx2 v[12:13], v136, s[16:19], s13 offen offset:1024 sc1
buffer_load_dwordx2 v[14:15], v136, s[16:19], s13 offen offset:2304 sc1
s_mov_b64 exec, -1
attn_noq:
s_mov_b32 m0, s21
s_add_u32 s21, s21, 8192
buffer_load_dwordx4 v4, s[16:19], s20 offen sc1 lds
s_add_u32 s20, s20, 8192
s_mov_b32 m0, s21
s_add_u32 s21, s21, 8192
buffer_load_dwordx4 v4, s[16:19], s20 offen sc1 lds
s_add_u32 s20, s20, 8192
s_mov_b32 m0, s21
s_add_u32 s21, s21, 8192
buffer_load_dwordx4 v4, s[16:19], s20 offen sc1 lds
s_add_u32 s20, s20, 8192
s_cmp_ge_u32 s11, 4
s_cbranch_scc1 attn_young
s_waitcnt vmcnt(3)
attn_maxbody:
v_mfma_f32_32x32x16_bf16 v[64:79], v[36:39], v[8:11], 0
v_mfma_f32_32x32x8_bf16 v[64:79], v[34:35], v[12:13], v[64:79]
v_mfma_f32_32x32x16_bf16 v[80:95], v[36:39], v[16:19], 0
v_mfma_f32_32x32x8_bf16 v[80:95], v[34:35], v[14:15], v[80:95]
s_nop 10
v_max3_f32 v128, v64, v65, v128
v_max3_f32 v128, v66, v67, v128
v_max3_f32 v128, v68, v69, v128
v_max3_f32 v128, v70, v71, v128
v_max3_f32 v128, v72, v73, v128
v_max3_f32 v128, v74, v75, v128
v_max3_f32 v128, v76, v77, v128
v_max3_f32 v128, v78, v79, v128
s_nop 3
v_max3_f32 v129, v80, v81, v129
v_max3_f32 v129, v82, v83, v129
v_max3_f32 v129, v84, v85, v129
v_max3_f32 v129, v86, v87, v129
v_max3_f32 v129, v88, v89, v129
v_max3_f32 v129, v90, v91, v129
v_max3_f32 v129, v92, v93, v129
v_max3_f32 v129, v94, v95, v129
s_sub_u32 s35, s35, 1
s_cmp_ge_i32 s35, 0
s_cbranch_scc1 attn_maxloop
v_mov_b32 v130, v128
s_nop 1
v_permlane32_swap_b32 v128, v130
s_nop 1
v_max_f32 v128, v128, v130
v_sub_f32 v128, 0, v128
v_and_b32 v130, 0xffff0000, v128
v_sub_f32 v131, v128, v130
v_and_b32 v132, 0xffff0000, v131
v_sub_f32 v133, v131, v132
v_lshrrev_b32 v130, 16, v130
v_or_b32 v130, v130, v132
v_lshrrev_b32 v133, 16, v133
v_cndmask_b32 v12, v12, v130, s[26:27]
v_cndmask_b32 v13, v13, v133, s[26:27]
v_mov_b32 v130, v129
s_nop 1
v_permlane32_swap_b32 v129, v130
s_nop 1
v_max_f32 v129, v129, v130
v_sub_f32 v129, 0, v129
v_and_b32 v130, 0xffff0000, v129
v_sub_f32 v131, v129, v130
v_and_b32 v132, 0xffff0000, v131
v_sub_f32 v133, v131, v132
v_lshrrev_b32 v130, 16, v130
v_or_b32 v130, v130, v132
v_lshrrev_b32 v133, 16, v133
v_cndmask_b32 v14, v14, v130, s[26:27]
v_cndmask_b32 v15, v15, v133, s[26:27]
v_mov_b64 v[88:89], 0
v_mov_b64 v[90:91], 0
v_mov_b64 v[92:93], 0
v_mov_b64 v[94:95], 0
v_mfma_f32_32x32x16_bf16 v[64:79], v[36:39], v[8:11], 0
v_mfma_f32_32x32x8_bf16 v[64:79], v[34:35], v[12:13], v[64:79]
s_mov_b32 s35, 0
s_cmp_eq_u32 s33, 1
s_cbranch_scc0 attn_enter
s_waitcnt vmcnt(0)
s_barrier
attn_enter:
ds_read_b128 v[20:23], v1 offset:2560
s_mov_b64 exec, s[24:25]
ds_read_b64 v[32:33], v2 offset:3584
s_mov_b64 exec, s[22:23]
ds_read_b128 v[24:27], v3 offset:1280
ds_read_b128 v[28:31], v3 offset:1920
s_mov_b64 exec, -1
s_nop 2
.p2align 6
attn_loop:
v_exp_f32 v64, v64
v_exp_f32 v65, v65
v_smfmac_f32_32x32x32_bf16 v[112:127], v[44:47], v[88:95], v48
v_exp_f32 v66, v66
v_exp_f32 v67, v67
v_exp_f32 v68, v68
v_mfma_f32_32x32x8_bf16 v[80:95], v[34:35], v[14:15], 0
v_exp_f32 v69, v69
v_exp_f32 v70, v70
v_exp_f32 v71, v71
v_exp_f32 v72, v72
v_mfma_f32_32x32x16_bf16 v[80:95], v[36:39], v[16:19], v[80:95]
v_exp_f32 v73, v73
v_exp_f32 v74, v74
v_exp_f32 v75, v75
s_waitcnt lgkmcnt(0)
v_smfmac_f32_32x32x32_bf16 v[96:111], v[24:27], v[64:71], v48
v_exp_f32 v76, v76
v_exp_f32 v77, v77
ds_read_b128 v[36:39], v1 offset:5120
v_exp_f32 v78, v78
s_mov_b64 exec, s[24:25]
ds_read_b64 v[34:35], v2 offset:6144
s_mov_b64 exec, -1
v_exp_f32 v79, v79
v_exp_f32 v80, v80
v_exp_f32 v81, v81
v_smfmac_f32_32x32x32_bf16 v[96:111], v[28:31], v[72:79], v48
v_exp_f32 v82, v82
v_exp_f32 v83, v83
v_exp_f32 v84, v84
v_mfma_f32_32x32x8_bf16 v[64:79], v[32:33], v[12:13], 0
v_exp_f32 v85, v85
v_exp_f32 v86, v86
v_exp_f32 v87, v87
v_exp_f32 v88, v88
v_mfma_f32_32x32x16_bf16 v[64:79], v[20:23], v[8:11], v[64:79]
v_exp_f32 v89, v89
v_exp_f32 v90, v90
v_exp_f32 v91, v91
v_smfmac_f32_32x32x32_bf16 v[112:127], v[24:27], v[80:87], v48
v_exp_f32 v92, v92
v_exp_f32 v93, v93
s_mov_b64 exec, s[22:23]
ds_read_b128 v[40:43], v3 offset:3840
ds_read_b128 v[44:47], v3 offset:4480
s_mov_b64 exec, -1
v_exp_f32 v94, v94
v_exp_f32 v95, v95
v_exp_f32 v64, v64
v_exp_f32 v65, v65
v_smfmac_f32_32x32x32_bf16 v[112:127], v[28:31], v[88:95], v48
v_exp_f32 v66, v66
v_exp_f32 v67, v67
v_exp_f32 v68, v68
v_mfma_f32_32x32x8_bf16 v[80:95], v[32:33], v[14:15], 0
v_exp_f32 v69, v69
v_exp_f32 v70, v70
v_exp_f32 v71, v71
v_exp_f32 v72, v72
v_mfma_f32_32x32x16_bf16 v[80:95], v[20:23], v[16:19], v[80:95]
v_exp_f32 v73, v73
v_exp_f32 v74, v74
v_exp_f32 v75, v75
s_waitcnt lgkmcnt(0)
v_smfmac_f32_32x32x32_bf16 v[96:111], v[40:43], v[64:71], v48
v_exp_f32 v76, v76
v_exp_f32 v77, v77
ds_read_b128 v[20:23], v1 offset:7680
v_exp_f32 v78, v78
s_mov_b64 exec, s[24:25]
ds_read_b64 v[32:33], v2 offset:8704
s_mov_b64 exec, -1
v_exp_f32 v79, v79
v_exp_f32 v80, v80
v_exp_f32 v81, v81
v_smfmac_f32_32x32x32_bf16 v[96:111], v[44:47], v[72:79], v48
v_exp_f32 v82, v82
v_exp_f32 v83, v83
v_exp_f32 v84, v84
v_mfma_f32_32x32x8_bf16 v[64:79], v[34:35], v[12:13], 0
v_exp_f32 v85, v85
v_exp_f32 v86, v86
v_exp_f32 v87, v87
v_exp_f32 v88, v88
v_mfma_f32_32x32x16_bf16 v[64:79], v[36:39], v[8:11], v[64:79]
v_exp_f32 v89, v89
v_exp_f32 v90, v90
v_exp_f32 v91, v91
v_smfmac_f32_32x32x32_bf16 v[112:127], v[40:43], v[80:87], v48
v_exp_f32 v92, v92
v_exp_f32 v93, v93
s_mov_b64 exec, s[22:23]
ds_read_b128 v[24:27], v3 offset:6400
ds_read_b128 v[28:31], v3 offset:7040
s_mov_b64 exec, -1
v_exp_f32 v94, v94
v_exp_f32 v95, v95
v_exp_f32 v64, v64
v_exp_f32 v65, v65
v_smfmac_f32_32x32x32_bf16 v[112:127], v[44:47], v[88:95], v48
v_exp_f32 v66, v66
v_exp_f32 v67, v67
v_exp_f32 v68, v68
v_mfma_f32_32x32x8_bf16 v[80:95], v[34:35], v[14:15], 0
v_exp_f32 v69, v69
v_exp_f32 v70, v70
v_exp_f32 v71, v71
v_exp_f32 v72, v72
v_mfma_f32_32x32x16_bf16 v[80:95], v[36:39], v[16:19], v[80:95]
v_exp_f32 v73, v73
v_exp_f32 v74, v74
v_exp_f32 v75, v75
s_waitcnt lgkmcnt(0)
v_smfmac_f32_32x32x32_bf16 v[96:111], v[24:27], v[64:71], v48
v_exp_f32 v76, v76
v_exp_f32 v77, v77
ds_read_b128 v[36:39], v1 offset:10240
v_exp_f32 v78, v78
s_mov_b64 exec, s[24:25]
ds_read_b64 v[34:35], v2 offset:11264
s_mov_b64 exec, -1
v_exp_f32 v79, v79
v_exp_f32 v80, v80
v_exp_f32 v81, v81
v_smfmac_f32_32x32x32_bf16 v[96:111], v[28:31], v[72:79], v48
v_exp_f32 v82, v82
v_exp_f32 v83, v83
v_exp_f32 v84, v84
v_mfma_f32_32x32x8_bf16 v[64:79], v[32:33], v[12:13], 0
v_exp_f32 v85, v85
v_exp_f32 v86, v86
v_exp_f32 v87, v87
v_exp_f32 v88, v88
v_mfma_f32_32x32x16_bf16 v[64:79], v[20:23], v[8:11], v[64:79]
v_exp_f32 v89, v89
v_exp_f32 v90, v90
v_exp_f32 v91, v91
v_smfmac_f32_32x32x32_bf16 v[112:127], v[24:27], v[80:87], v48
v_exp_f32 v92, v92
v_exp_f32 v93, v93
s_mov_b64 exec, s[22:23]
ds_read_b128 v[40:43], v3 offset:8960
ds_read_b128 v[44:47], v3 offset:9600
s_mov_b64 exec, -1
v_exp_f32 v94, v94
v_exp_f32 v95, v95
v_exp_f32 v64, v64
v_exp_f32 v65, v65
v_smfmac_f32_32x32x32_bf16 v[112:127], v[28:31], v[88:95], v48
v_exp_f32 v66, v66
v_exp_f32 v67, v67
v_exp_f32 v68, v68
v_mfma_f32_32x32x8_bf16 v[80:95], v[32:33], v[14:15], 0
v_exp_f32 v69, v69
v_exp_f32 v70, v70
v_exp_f32 v71, v71
v_exp_f32 v72, v72
v_mfma_f32_32x32x16_bf16 v[80:95], v[20:23], v[16:19], v[80:95]
v_exp_f32 v73, v73
v_exp_f32 v74, v74
v_exp_f32 v75, v75
s_waitcnt lgkmcnt(0)
v_smfmac_f32_32x32x32_bf16 v[96:111], v[40:43], v[64:71], v48
v_exp_f32 v76, v76
v_exp_f32 v77, v77
ds_read_b128 v[20:23], v1 offset:12800
v_exp_f32 v78, v78
s_mov_b64 exec, s[24:25]
ds_read_b64 v[32:33], v2 offset:13824
s_mov_b64 exec, -1
v_exp_f32 v79, v79
v_exp_f32 v80, v80
v_exp_f32 v81, v81
v_smfmac_f32_32x32x32_bf16 v[96:111], v[44:47], v[72:79], v48
v_exp_f32 v82, v82
v_exp_f32 v83, v83
v_exp_f32 v84, v84
v_mfma_f32_32x32x8_bf16 v[64:79], v[34:35], v[12:13], 0
v_exp_f32 v85, v85
v_exp_f32 v86, v86
v_exp_f32 v87, v87
v_exp_f32 v88, v88
v_mfma_f32_32x32x16_bf16 v[64:79], v[36:39], v[8:11], v[64:79]
v_exp_f32 v89, v89
v_exp_f32 v90, v90
v_exp_f32 v91, v91
v_smfmac_f32_32x32x32_bf16 v[112:127], v[40:43], v[80:87], v48
v_exp_f32 v92, v92
v_exp_f32 v93, v93
s_mov_b64 exec, s[22:23]
ds_read_b128 v[24:27], v3 offset:11520
ds_read_b128 v[28:31], v3 offset:12160
s_mov_b64 exec, -1
v_exp_f32 v94, v94
v_exp_f32 v95, v95
v_exp_f32 v64, v64
v_exp_f32 v65, v65
v_smfmac_f32_32x32x32_bf16 v[112:127], v[44:47], v[88:95], v48
v_exp_f32 v66, v66
v_exp_f32 v67, v67
v_exp_f32 v68, v68
v_mfma_f32_32x32x8_bf16 v[80:95], v[34:35], v[14:15], 0
v_exp_f32 v69, v69
v_exp_f32 v70, v70
v_exp_f32 v71, v71
v_exp_f32 v72, v72
v_mfma_f32_32x32x16_bf16 v[80:95], v[36:39], v[16:19], v[80:95]
v_exp_f32 v73, v73
v_exp_f32 v74, v74
v_exp_f32 v75, v75
s_waitcnt lgkmcnt(0)
v_smfmac_f32_32x32x32_bf16 v[96:111], v[24:27], v[64:71], v48
v_exp_f32 v76, v76
v_exp_f32 v77, v77
ds_read_b128 v[36:39], v1 offset:15360
v_exp_f32 v78, v78
s_mov_b64 exec, s[24:25]
ds_read_b64 v[34:35], v2 offset:16384
s_mov_b64 exec, -1
v_exp_f32 v79, v79
v_exp_f32 v80, v80
v_exp_f32 v81, v81
v_smfmac_f32_32x32x32_bf16 v[96:111], v[28:31], v[72:79], v48
v_exp_f32 v82, v82
v_exp_f32 v83, v83
v_exp_f32 v84, v84
v_mfma_f32_32x32x8_bf16 v[64:79], v[32:33], v[12:13], 0
v_exp_f32 v85, v85
v_exp_f32 v86, v86
v_exp_f32 v87, v87
v_exp_f32 v88, v88
v_mfma_f32_32x32x16_bf16 v[64:79], v[20:23], v[8:11], v[64:79]
v_exp_f32 v89, v89
v_exp_f32 v90, v90
v_exp_f32 v91, v91
v_smfmac_f32_32x32x32_bf16 v[112:127], v[24:27], v[80:87], v48
v_exp_f32 v92, v92
v_exp_f32 v93, v93
s_mov_b64 exec, s[22:23]
ds_read_b128 v[40:43], v3 offset:14080
ds_read_b128 v[44:47], v3 offset:14720
s_mov_b64 exec, -1
v_exp_f32 v94, v94
v_exp_f32 v95, v95
v_exp_f32 v64, v64
v_exp_f32 v65, v65
v_smfmac_f32_32x32x32_bf16 v[112:127], v[28:31], v[88:95], v48
v_exp_f32 v66, v66
v_exp_f32 v67, v67
v_exp_f32 v68, v68
v_mfma_f32_32x32x8_bf16 v[80:95], v[32:33], v[14:15], 0
v_exp_f32 v69, v69
v_exp_f32 v70, v70
v_exp_f32 v71, v71
v_exp_f32 v72, v72
v_mfma_f32_32x32x16_bf16 v[80:95], v[20:23], v[16:19], v[80:95]
v_exp_f32 v73, v73
v_exp_f32 v74, v74
v_exp_f32 v75, v75
s_waitcnt lgkmcnt(0)
v_smfmac_f32_32x32x32_bf16 v[96:111], v[40:43], v[64:71], v48
v_exp_f32 v76, v76
v_exp_f32 v77, v77
ds_read_b128 v[20:23], v1 offset:17920
v_exp_f32 v78, v78
s_mov_b64 exec, s[24:25]
ds_read_b64 v[32:33], v2 offset:18944
s_mov_b64 exec, -1
v_exp_f32 v79, v79
v_exp_f32 v80, v80
v_exp_f32 v81, v81
v_smfmac_f32_32x32x32_bf16 v[96:111], v[44:47], v[72:79], v48
v_exp_f32 v82, v82
v_exp_f32 v83, v83
v_exp_f32 v84, v84
v_mfma_f32_32x32x8_bf16 v[64:79], v[34:35], v[12:13], 0
v_exp_f32 v85, v85
v_exp_f32 v86, v86
v_exp_f32 v87, v87
v_exp_f32 v88, v88
v_mfma_f32_32x32x16_bf16 v[64:79], v[36:39], v[8:11], v[64:79]
v_exp_f32 v89, v89
v_exp_f32 v90, v90
v_exp_f32 v91, v91
v_smfmac_f32_32x32x32_bf16 v[112:127], v[40:43], v[80:87], v48
v_exp_f32 v92, v92
v_exp_f32 v93, v93
s_mov_b64 exec, s[22:23]
ds_read_b128 v[24:27], v3 offset:16640
ds_read_b128 v[28:31], v3 offset:17280
s_mov_b64 exec, -1
v_exp_f32 v94, v94
v_exp_f32 v95, v95
v_exp_f32 v64, v64
v_exp_f32 v65, v65
v_smfmac_f32_32x32x32_bf16 v[112:127], v[44:47], v[88:95], v48
v_exp_f32 v66, v66
v_exp_f32 v67, v67
v_exp_f32 v68, v68
v_mfma_f32_32x32x8_bf16 v[80:95], v[34:35], v[14:15], 0
v_exp_f32 v69, v69
v_exp_f32 v70, v70
v_exp_f32 v71, v71
v_exp_f32 v72, v72
v_mfma_f32_32x32x16_bf16 v[80:95], v[36:39], v[16:19], v[80:95]
v_exp_f32 v73, v73
v_exp_f32 v74, v74
v_exp_f32 v75, v75
s_waitcnt lgkmcnt(0)
v_smfmac_f32_32x32x32_bf16 v[96:111], v[24:27], v[64:71], v48
v_exp_f32 v76, v76
v_exp_f32 v77, v77
ds_read_b128 v[36:39], v1 offset:20480
v_exp_f32 v78, v78
s_mov_b64 exec, s[24:25]
ds_read_b64 v[34:35], v2 offset:21504
s_mov_b64 exec, -1
v_exp_f32 v79, v79
v_exp_f32 v80, v80
v_exp_f32 v81, v81
v_smfmac_f32_32x32x32_bf16 v[96:111], v[28:31], v[72:79], v48
v_exp_f32 v82, v82
v_exp_f32 v83, v83
v_exp_f32 v84, v84
v_mfma_f32_32x32x8_bf16 v[64:79], v[32:33], v[12:13], 0
v_exp_f32 v85, v85
v_exp_f32 v86, v86
v_exp_f32 v87, v87
v_exp_f32 v88, v88
v_mfma_f32_32x32x16_bf16 v[64:79], v[20:23], v[8:11], v[64:79]
v_exp_f32 v89, v89
v_exp_f32 v90, v90
v_exp_f32 v91, v91
v_smfmac_f32_32x32x32_bf16 v[112:127], v[24:27], v[80:87], v48
v_exp_f32 v92, v92
v_exp_f32 v93, v93
s_mov_b64 exec, s[22:23]
ds_read_b128 v[40:43], v3 offset:19200
ds_read_b128 v[44:47], v3 offset:19840
s_mov_b64 exec, -1
v_exp_f32 v94, v94
v_exp_f32 v95, v95
v_exp_f32 v64, v64
v_exp_f32 v65, v65
v_smfmac_f32_32x32x32_bf16 v[112:127], v[28:31], v[88:95], v48
v_exp_f32 v66, v66
v_exp_f32 v67, v67
v_exp_f32 v68, v68
v_mfma_f32_32x32x8_bf16 v[80:95], v[32:33], v[14:15], 0
v_exp_f32 v69, v69
v_exp_f32 v70, v70
v_exp_f32 v71, v71
v_exp_f32 v72, v72
v_mfma_f32_32x32x16_bf16 v[80:95], v[20:23], v[16:19], v[80:95]
v_exp_f32 v73, v73
v_exp_f32 v74, v74
v_exp_f32 v75, v75
s_waitcnt lgkmcnt(0)
v_smfmac_f32_32x32x32_bf16 v[96:111], v[40:43], v[64:71], v48
v_exp_f32 v76, v76
v_exp_f32 v77, v77
ds_read_b128 v[20:23], v1 offset:23040
v_exp_f32 v78, v78
s_mov_b64 exec, s[24:25]
ds_read_b64 v[32:33], v2 offset:24064
s_mov_b64 exec, -1
v_exp_f32 v79, v79
v_exp_f32 v80, v80
v_exp_f32 v81, v81
v_smfmac_f32_32x32x32_bf16 v[96:111], v[44:47], v[72:79], v48
v_exp_f32 v82, v82
v_exp_f32 v83, v83
v_exp_f32 v84, v84
v_mfma_f32_32x32x8_bf16 v[64:79], v[34:35], v[12:13], 0
v_exp_f32 v85, v85
v_exp_f32 v86, v86
v_exp_f32 v87, v87
v_exp_f32 v88, v88
v_mfma_f32_32x32x16_bf16 v[64:79], v[36:39], v[8:11], v[64:79]
v_exp_f32 v89, v89
v_exp_f32 v90, v90
v_exp_f32 v91, v91
v_smfmac_f32_32x32x32_bf16 v[112:127], v[40:43], v[80:87], v48
v_exp_f32 v92, v92
v_exp_f32 v93, v93
s_mov_b64 exec, s[22:23]
ds_read_b128 v[24:27], v3 offset:21760
ds_read_b128 v[28:31], v3 offset:22400
s_mov_b64 exec, -1
v_exp_f32 v94, v94
v_add_u32 v1, 20480, v1
v_add_u32 v2, 20480, v2
v_add_u32 v3, 20480, v3
s_add_u32 s35, s35, 1
s_cmp_lg_u32 s35, s34
v_exp_f32 v95, v95
s_cbranch_scc1 attn_loop
s_cmp_lg_u32 s34, 8
s_cbranch_scc1 attn_event
s_mov_b32 s36, 0x5f800000
v_smfmac_f32_32x32x32_bf16 v[112:127], v[44:47], v[88:95], v48
v_rcp_f32 v131, v108
s_nop 0
v_mul_f32 v64, v96, v131
v_mul_f32 v65, v97, v131
v_mul_f32 v66, v98, v131
v_mul_f32 v67, v99, v131
v_mul_f32 v68, v100, v131
v_mul_f32 v69, v101, v131
v_mul_f32 v70, v102, v131
v_mul_f32 v71, v103, v131
v_mul_f32 v72, v104, v131
v_mul_f32 v73, v105, v131
v_mul_f32 v74, v106, v131
v_mul_f32 v75, v107, v131
v_cvt_pk_bf16_f32 v64, v64, v65
v_cvt_pk_bf16_f32 v65, v66, v67
v_cvt_pk_bf16_f32 v66, v68, v69
v_cvt_pk_bf16_f32 v67, v70, v71
v_cvt_pk_bf16_f32 v68, v72, v73
v_cvt_pk_bf16_f32 v69, v74, v75
v_add_f32 v130, v108, v124
v_rcp_f32 v132, v124
v_cmp_ngt_f32 vcc, s36, v130
s_cmp_eq_u32 s33, 64
s_cbranch_scc1 attn_store
s_nop 2
s_cbranch_vccnz attn_restart
attn_store:
buffer_store_dwordx4 v[64:67], v138, s[16:19], s31 offen sc1
s_mov_b64 exec, s[24:25]
buffer_store_dwordx2 v[68:69], v134, s[16:19], s38 offen sc1
s_mov_b64 exec, -1
v_mul_f32 v80, v112, v132
v_mul_f32 v81, v113, v132
v_mul_f32 v82, v114, v132
v_mul_f32 v83, v115, v132
v_mul_f32 v84, v116, v132
v_mul_f32 v85, v117, v132
v_mul_f32 v86, v118, v132
v_mul_f32 v87, v119, v132
v_mul_f32 v88, v120, v132
v_mul_f32 v89, v121, v132
v_mul_f32 v90, v122, v132
v_mul_f32 v91, v123, v132
v_cvt_pk_bf16_f32 v80, v80, v81
v_cvt_pk_bf16_f32 v81, v82, v83
v_cvt_pk_bf16_f32 v82, v84, v85
v_cvt_pk_bf16_f32 v83, v86, v87
v_cvt_pk_bf16_f32 v84, v88, v89
v_cvt_pk_bf16_f32 v85, v90, v91
s_add_u32 s31, s31, 40960
s_add_u32 s38, s38, 40960
buffer_store_dwordx4 v[80:83], v138, s[16:19], s31 offen sc1
s_mov_b64 exec, s[24:25]
buffer_store_dwordx2 v[84:85], v134, s[16:19], s38 offen sc1
s_mov_b64 exec, -1
v_mov_b32 v4, s100
v_lshlrev_b32 v5, 7, v141
s_waitcnt vmcnt(4)
s_barrier
s_cmp_lt_u32 s11, 4
s_cbranch_scc1 attn_old3
ds_write_b128 v244, v[144:147] offset:0
ds_write_b128 v244, v[148:151] offset:1024
ds_write_b128 v244, v[152:155] offset:2048
ds_write_b128 v244, v[156:159] offset:3072
ds_write_b128 v244, v[160:163] offset:4096
ds_write_b128 v244, v[164:167] offset:20480
ds_write_b128 v244, v[168:171] offset:21504
ds_write_b128 v244, v[172:175] offset:22528
s_waitcnt lgkmcnt(6)
ds_write_b128 v244, v[176:179] offset:23552
ds_write_b128 v244, v[180:183] offset:24576
s_waitcnt vmcnt(0)
s_mov_b64 exec, 1
buffer_store_dword v4, v5, s[16:19], s39 offen sc1
s_mov_b64 exec, -1
ds_write_b128 v244, v[184:187] offset:40960
ds_write_b128 v244, v[188:191] offset:41984
ds_write_b128 v244, v[192:195] offset:43008
ds_write_b128 v244, v[196:199] offset:44032
ds_write_b128 v244, v[200:203] offset:45056
ds_write_b128 v245, v[204:207] offset:0
s_waitcnt lgkmcnt(6)
ds_write_b128 v245, v[208:211] offset:1024
ds_write_b128 v245, v[212:215] offset:2048
ds_write_b128 v245, v[216:219] offset:3072
ds_write_b128 v245, v[220:223] offset:4096
ds_write_b128 v245, v[224:227] offset:20480
ds_write_b128 v245, v[228:231] offset:21504
ds_write_b128 v245, v[232:235] offset:22528
ds_write_b128 v245, v[236:239] offset:23552
s_waitcnt lgkmcnt(6)
ds_write_b128 v245, v[240:243] offset:24576
s_cmp_lg_u32 s11, 4
s_cbranch_scc1 attn_b2
attn_poll:
buffer_load_dword v3, v5, s[16:19], s92 offen sc1
s_add_u32 s30, s30, 1
s_waitcnt vmcnt(0)
v_cmp_ne_u32 vcc, s100, v3
s_cmp_gt_u32 s30, 0x8000
s_cbranch_scc1 attn_b2
s_nop 1
s_cbranch_vccz attn_b2
s_mov_b64 exec, vcc
s_sleep 8
s_branch attn_poll
attn_b2:
s_mov_b64 exec, -1
s_waitcnt lgkmcnt(0)
s_barrier
s_branch attn_fin
attn_old3:
v_add_u32 v1, s94, v247
v_add_u32 v2, s94, v248
s_waitcnt vmcnt(0)
s_mov_b64 exec, 1
buffer_store_dword v4, v5, s[16:19], s39 offen sc1
s_mov_b64 exec, -1
s_barrier
buffer_load_dwordx4 v[48:51], v135, s[16:19], s84 offen offset:0 sc1
buffer_load_dwordx4 v[52:55], v244, s[16:19], s84 offen offset:0 sc1
buffer_load_dwordx4 v[56:59], v135, s[16:19], s84 offen offset:1024 sc1
buffer_load_dwordx4 v[60:63], v244, s[16:19], s84 offen offset:1024 sc1
buffer_load_dwordx4 v[64:67], v135, s[16:19], s84 offen offset:2048 sc1
buffer_load_dwordx4 v[68:71], v244, s[16:19], s84 offen offset:2048 sc1
buffer_load_dwordx4 v[72:75], v135, s[16:19], s84 offen offset:3072 sc1
buffer_load_dwordx4 v[76:79], v244, s[16:19], s84 offen offset:3072 sc1
buffer_load_dwordx2 v[80:81], v245, s[16:19], s84 offen offset:0 sc1
buffer_load_dwordx2 v[82:83], v245, s[16:19], s84 offen offset:256 sc1
buffer_load_dwordx2 v[84:85], v246, s[16:19], s84 offen offset:0 sc1
buffer_load_dwordx2 v[86:87], v246, s[16:19], s84 offen offset:256 sc1
buffer_load_dwordx4 v[88:91], v135, s[16:19], s85 offen offset:0 sc1
buffer_load_dwordx4 v[92:95], v244, s[16:19], s85 offen offset:0 sc1
buffer_load_dwordx4 v[96:99], v135, s[16:19], s85 offen offset:1024 sc1
buffer_load_dwordx4 v[100:103], v244, s[16:19], s85 offen offset:1024 sc1
buffer_load_dwordx4 v[104:107], v135, s[16:19], s85 offen offset:2048 sc1
buffer_load_dwordx4 v[108:111], v244, s[16:19], s85 offen offset:2048 sc1
ds_read_b64_tr_b16 v[8:9], v1 offset:0
ds_read_b64_tr_b16 v[10:11], v1 offset:1280
ds_read_b64_tr_b16 v[12:13], v1 offset:8
ds_read_b64_tr_b16 v[14:15], v1 offset:1288
ds_read_b64_tr_b16 v[16:17], v1 offset:16
ds_read_b64_tr_b16 v[18:19], v1 offset:1296
ds_read_b64_tr_b16 v[20:21], v1 offset:24
ds_read_b64_tr_b16 v[22:23], v1 offset:1304
ds_read_b64_tr_b16 v[24:25], v1 offset:32
ds_read_b64_tr_b16 v[26:27], v1 offset:1312
s_waitcnt vmcnt(16) lgkmcnt(0)
v_add_u32 v128, s95, v247
v_add_u32 v129, s95, v248
v_mfma_f32_16x16x32_bf16 v[144:147], v[8:11], v[48:51], 0
ds_read_b64_tr_b16 v[28:29], v1 offset:6400
ds_read_b64_tr_b16 v[30:31], v1 offset:7680
v_mfma_f32_16x16x32_bf16 v[164:167], v[8:11], v[52:55], 0
ds_read_b64_tr_b16 v[32:33], v1 offset:6408
ds_read_b64_tr_b16 v[34:35], v1 offset:7688
v_mfma_f32_16x16x32_bf16 v[148:151], v[12:15], v[48:51], 0
ds_read_b64_tr_b16 v[36:37], v1 offset:6416
ds_read_b64_tr_b16 v[38:39], v1 offset:7696
v_mfma_f32_16x16x32_bf16 v[168:171], v[12:15], v[52:55], 0
ds_read_b64_tr_b16 v[40:41], v1 offset:6424
ds_read_b64_tr_b16 v[42:43], v1 offset:7704
v_mfma_f32_16x16x32_bf16 v[152:155], v[16:19], v[48:51], 0
ds_read_b64_tr_b16 v[44:45], v1 offset:6432
ds_read_b64_tr_b16 v[46:47], v1 offset:7712
v_mfma_f32_16x16x32_bf16 v[172:175], v[16:19], v[52:55], 0
v_mfma_f32_16x16x32_bf16 v[156:159], v[20:23], v[48:51], 0
v_mfma_f32_16x16x32_bf16 v[176:179], v[20:23], v[52:55], 0
buffer_load_dwordx4 v[112:115], v135, s[16:19], s85 offen offset:3072 sc1
buffer_load_dwordx4 v[116:119], v244, s[16:19], s85 offen offset:3072 sc1
v_mfma_f32_16x16x32_bf16 v[160:163], v[24:27], v[48:51], 0
v_mfma_f32_16x16x32_bf16 v[180:183], v[24:27], v[52:55], 0
s_waitcnt vmcnt(16) lgkmcnt(0)
v_mfma_f32_16x16x32_bf16 v[144:147], v[28:31], v[56:59], v[144:147]
ds_read_b64_tr_b16 v[8:9], v1 offset:12800
ds_read_b64_tr_b16 v[10:11], v1 offset:14080
v_mfma_f32_16x16x32_bf16 v[164:167], v[28:31], v[60:63], v[164:167]
ds_read_b64_tr_b16 v[12:13], v1 offset:12808
ds_read_b64_tr_b16 v[14:15], v1 offset:14088
v_mfma_f32_16x16x32_bf16 v[148:151], v[32:35], v[56:59], v[148:151]
ds_read_b64_tr_b16 v[16:17], v1 offset:12816
ds_read_b64_tr_b16 v[18:19], v1 offset:14096
v_mfma_f32_16x16x32_bf16 v[168:171], v[32:35], v[60:63], v[168:171]
ds_read_b64_tr_b16 v[20:21], v1 offset:12824
ds_read_b64_tr_b16 v[22:23], v1 offset:14104
v_mfma_f32_16x16x32_bf16 v[152:155], v[36:39], v[56:59], v[152:155]
ds_read_b64_tr_b16 v[24:25], v1 offset:12832
ds_read_b64_tr_b16 v[26:27], v1 offset:14112
v_mfma_f32_16x16x32_bf16 v[172:175], v[36:39], v[60:63], v[172:175]
v_mfma_f32_16x16x32_bf16 v[156:159], v[40:43], v[56:59], v[156:159]
v_mfma_f32_16x16x32_bf16 v[176:179], v[40:43], v[60:63], v[176:179]
buffer_load_dwordx2 v[120:121], v245, s[16:19], s85 offen offset:0 sc1
buffer_load_dwordx2 v[122:123], v245, s[16:19], s85 offen offset:256 sc1
buffer_load_dwordx2 v[124:125], v246, s[16:19], s85 offen offset:0 sc1
buffer_load_dwordx2 v[126:127], v246, s[16:19], s85 offen offset:256 sc1
v_mfma_f32_16x16x32_bf16 v[160:163], v[44:47], v[56:59], v[160:163]
v_mfma_f32_16x16x32_bf16 v[180:183], v[44:47], v[60:63], v[180:183]
s_waitcnt vmcnt(18) lgkmcnt(0)
v_mfma_f32_16x16x32_bf16 v[144:147], v[8:11], v[64:67], v[144:147]
ds_read_b64_tr_b16 v[28:29], v1 offset:19200
ds_read_b64_tr_b16 v[30:31], v1 offset:20480
v_mfma_f32_16x16x32_bf16 v[164:167], v[8:11], v[68:71], v[164:167]
ds_read_b64_tr_b16 v[32:33], v1 offset:19208
ds_read_b64_tr_b16 v[34:35], v1 offset:20488
v_mfma_f32_16x16x32_bf16 v[148:151], v[12:15], v[64:67], v[148:151]
ds_read_b64_tr_b16 v[36:37], v1 offset:19216
ds_read_b64_tr_b16 v[38:39], v1 offset:20496
v_mfma_f32_16x16x32_bf16 v[168:171], v[12:15], v[68:71], v[168:171]
ds_read_b64_tr_b16 v[40:41], v1 offset:19224
ds_read_b64_tr_b16 v[42:43], v1 offset:20504
v_mfma_f32_16x16x32_bf16 v[152:155], v[16:19], v[64:67], v[152:155]
ds_read_b64_tr_b16 v[44:45], v1 offset:19232
ds_read_b64_tr_b16 v[46:47], v1 offset:20512
v_mfma_f32_16x16x32_bf16 v[172:175], v[16:19], v[68:71], v[172:175]
v_mfma_f32_16x16x32_bf16 v[156:159], v[20:23], v[64:67], v[156:159]
v_mfma_f32_16x16x32_bf16 v[176:179], v[20:23], v[68:71], v[176:179]
buffer_load_dwordx4 v[184:187], v135, s[16:19], s86 offen offset:0 sc1
buffer_load_dwordx4 v[188:191], v244, s[16:19], s86 offen offset:0 sc1
v_mfma_f32_16x16x32_bf16 v[160:163], v[24:27], v[64:67], v[160:163]
v_mfma_f32_16x16x32_bf16 v[180:183], v[24:27], v[68:71], v[180:183]
s_waitcnt vmcnt(18) lgkmcnt(0)
v_mfma_f32_16x16x32_bf16 v[144:147], v[28:31], v[72:75], v[144:147]
ds_read_b64_tr_b16 v[8:9], v2 offset:2560
ds_read_b64_tr_b16 v[10:11], v2 offset:8960
v_mfma_f32_16x16x32_bf16 v[164:167], v[28:31], v[76:79], v[164:167]
ds_read_b64_tr_b16 v[12:13], v2 offset:2568
ds_read_b64_tr_b16 v[14:15], v2 offset:8968
v_mfma_f32_16x16x32_bf16 v[148:151], v[32:35], v[72:75], v[148:151]
ds_read_b64_tr_b16 v[16:17], v2 offset:2576
ds_read_b64_tr_b16 v[18:19], v2 offset:8976
v_mfma_f32_16x16x32_bf16 v[168:171], v[32:35], v[76:79], v[168:171]
ds_read_b64_tr_b16 v[20:21], v2 offset:2584
ds_read_b64_tr_b16 v[22:23], v2 offset:8984
v_mfma_f32_16x16x32_bf16 v[152:155], v[36:39], v[72:75], v[152:155]
ds_read_b64_tr_b16 v[24:25], v2 offset:2592
ds_read_b64_tr_b16 v[26:27], v2 offset:8992
v_mfma_f32_16x16x32_bf16 v[172:175], v[36:39], v[76:79], v[172:175]
v_mfma_f32_16x16x32_bf16 v[156:159], v[40:43], v[72:75], v[156:159]
v_mfma_f32_16x16x32_bf16 v[176:179], v[40:43], v[76:79], v[176:179]
buffer_load_dwordx4 v[192:195], v135, s[16:19], s86 offen offset:1024 sc1
buffer_load_dwordx4 v[196:199], v244, s[16:19], s86 offen offset:1024 sc1
v_mfma_f32_16x16x32_bf16 v[160:163], v[44:47], v[72:75], v[160:163]
v_mfma_f32_16x16x32_bf16 v[180:183], v[44:47], v[76:79], v[180:183]
s_waitcnt vmcnt(16) lgkmcnt(0)
v_mfma_f32_16x16x32_bf16 v[144:147], v[8:11], v[80:83], v[144:147]
ds_read_b64_tr_b16 v[28:29], v128 offset:0
ds_read_b64_tr_b16 v[30:31], v128 offset:1280
v_mfma_f32_16x16x32_bf16 v[164:167], v[8:11], v[84:87], v[164:167]
ds_read_b64_tr_b16 v[32:33], v128 offset:8
ds_read_b64_tr_b16 v[34:35], v128 offset:1288
v_mfma_f32_16x16x32_bf16 v[148:151], v[12:15], v[80:83], v[148:151]
ds_read_b64_tr_b16 v[36:37], v128 offset:16
ds_read_b64_tr_b16 v[38:39], v128 offset:1296
v_mfma_f32_16x16x32_bf16 v[168:171], v[12:15], v[84:87], v[168:171]
ds_read_b64_tr_b16 v[40:41], v128 offset:24
ds_read_b64_tr_b16 v[42:43], v128 offset:1304
v_mfma_f32_16x16x32_bf16 v[152:155], v[16:19], v[80:83], v[152:155]
ds_read_b64_tr_b16 v[44:45], v128 offset:32
ds_read_b64_tr_b16 v[46:47], v128 offset:1312
v_mfma_f32_16x16x32_bf16 v[172:175], v[16:19], v[84:87], v[172:175]
v_mfma_f32_16x16x32_bf16 v[156:159], v[20:23], v[80:83], v[156:159]
v_mfma_f32_16x16x32_bf16 v[176:179], v[20:23], v[84:87], v[176:179]
buffer_load_dwordx4 v[200:203], v135, s[16:19], s86 offen offset:2048 sc1
buffer_load_dwordx4 v[204:207], v244, s[16:19], s86 offen offset:2048 sc1
v_mfma_f32_16x16x32_bf16 v[160:163], v[24:27], v[80:83], v[160:163]
v_mfma_f32_16x16x32_bf16 v[180:183], v[24:27], v[84:87], v[180:183]
s_waitcnt vmcnt(16) lgkmcnt(0)
v_add_u32 v1, s96, v247
v_add_u32 v2, s96, v248
v_mfma_f32_16x16x32_bf16 v[144:147], v[28:31], v[88:91], v[144:147]
ds_read_b64_tr_b16 v[8:9], v128 offset:6400
ds_read_b64_tr_b16 v[10:11], v128 offset:7680
v_mfma_f32_16x16x32_bf16 v[164:167], v[28:31], v[92:95], v[164:167]
ds_read_b64_tr_b16 v[12:13], v128 offset:6408
ds_read_b64_tr_b16 v[14:15], v128 offset:7688
v_mfma_f32_16x16x32_bf16 v[148:151], v[32:35], v[88:91], v[148:151]
ds_read_b64_tr_b16 v[16:17], v128 offset:6416
ds_read_b64_tr_b16 v[18:19], v128 offset:7696
v_mfma_f32_16x16x32_bf16 v[168:171], v[32:35], v[92:95], v[168:171]
ds_read_b64_tr_b16 v[20:21], v128 offset:6424
ds_read_b64_tr_b16 v[22:23], v128 offset:7704
v_mfma_f32_16x16x32_bf16 v[152:155], v[36:39], v[88:91], v[152:155]
ds_read_b64_tr_b16 v[24:25], v128 offset:6432
ds_read_b64_tr_b16 v[26:27], v128 offset:7712
v_mfma_f32_16x16x32_bf16 v[172:175], v[36:39], v[92:95], v[172:175]
v_mfma_f32_16x16x32_bf16 v[156:159], v[40:43], v[88:91], v[156:159]
v_mfma_f32_16x16x32_bf16 v[176:179], v[40:43], v[92:95], v[176:179]
buffer_load_dwordx4 v[208:211], v135, s[16:19], s86 offen offset:3072 sc1
buffer_load_dwordx4 v[212:215], v244, s[16:19], s86 offen offset:3072 sc1
v_mfma_f32_16x16x32_bf16 v[160:163], v[44:47], v[88:91], v[160:163]
v_mfma_f32_16x16x32_bf16 v[180:183], v[44:47], v[92:95], v[180:183]
s_waitcnt vmcnt(16) lgkmcnt(0)
v_mfma_f32_16x16x32_bf16 v[144:147], v[8:11], v[96:99], v[144:147]
ds_read_b64_tr_b16 v[28:29], v128 offset:12800
ds_read_b64_tr_b16 v[30:31], v128 offset:14080
v_mfma_f32_16x16x32_bf16 v[164:167], v[8:11], v[100:103], v[164:167]
ds_read_b64_tr_b16 v[32:33], v128 offset:12808
ds_read_b64_tr_b16 v[34:35], v128 offset:14088
v_mfma_f32_16x16x32_bf16 v[148:151], v[12:15], v[96:99], v[148:151]
ds_read_b64_tr_b16 v[36:37], v128 offset:12816
ds_read_b64_tr_b16 v[38:39], v128 offset:14096
v_mfma_f32_16x16x32_bf16 v[168:171], v[12:15], v[100:103], v[168:171]
ds_read_b64_tr_b16 v[40:41], v128 offset:12824
ds_read_b64_tr_b16 v[42:43], v128 offset:14104
v_mfma_f32_16x16x32_bf16 v[152:155], v[16:19], v[96:99], v[152:155]
ds_read_b64_tr_b16 v[44:45], v128 offset:12832
ds_read_b64_tr_b16 v[46:47], v128 offset:14112
v_mfma_f32_16x16x32_bf16 v[172:175], v[16:19], v[100:103], v[172:175]
v_mfma_f32_16x16x32_bf16 v[156:159], v[20:23], v[96:99], v[156:159]
v_mfma_f32_16x16x32_bf16 v[176:179], v[20:23], v[100:103], v[176:179]
buffer_load_dwordx2 v[216:217], v245, s[16:19], s86 offen offset:0 sc1
buffer_load_dwordx2 v[218:219], v245, s[16:19], s86 offen offset:256 sc1
buffer_load_dwordx2 v[220:221], v246, s[16:19], s86 offen offset:0 sc1
buffer_load_dwordx2 v[222:223], v246, s[16:19], s86 offen offset:256 sc1
v_mfma_f32_16x16x32_bf16 v[160:163], v[24:27], v[96:99], v[160:163]
v_mfma_f32_16x16x32_bf16 v[180:183], v[24:27], v[100:103], v[180:183]
s_waitcnt vmcnt(18) lgkmcnt(0)
v_mfma_f32_16x16x32_bf16 v[144:147], v[28:31], v[104:107], v[144:147]
ds_read_b64_tr_b16 v[8:9], v128 offset:19200
ds_read_b64_tr_b16 v[10:11], v128 offset:20480
v_mfma_f32_16x16x32_bf16 v[164:167], v[28:31], v[108:111], v[164:167]
ds_read_b64_tr_b16 v[12:13], v128 offset:19208
ds_read_b64_tr_b16 v[14:15], v128 offset:20488
v_mfma_f32_16x16x32_bf16 v[148:151], v[32:35], v[104:107], v[148:151]
ds_read_b64_tr_b16 v[16:17], v128 offset:19216
ds_read_b64_tr_b16 v[18:19], v128 offset:20496
v_mfma_f32_16x16x32_bf16 v[168:171], v[32:35], v[108:111], v[168:171]
ds_read_b64_tr_b16 v[20:21], v128 offset:19224
ds_read_b64_tr_b16 v[22:23], v128 offset:20504
v_mfma_f32_16x16x32_bf16 v[152:155], v[36:39], v[104:107], v[152:155]
ds_read_b64_tr_b16 v[24:25], v128 offset:19232
ds_read_b64_tr_b16 v[26:27], v128 offset:20512
v_mfma_f32_16x16x32_bf16 v[172:175], v[36:39], v[108:111], v[172:175]
v_mfma_f32_16x16x32_bf16 v[156:159], v[40:43], v[104:107], v[156:159]
v_mfma_f32_16x16x32_bf16 v[176:179], v[40:43], v[108:111], v[176:179]
buffer_load_dwordx4 v[224:227], v135, s[16:19], s87 offen offset:0 sc1
buffer_load_dwordx4 v[228:231], v244, s[16:19], s87 offen offset:0 sc1
v_mfma_f32_16x16x32_bf16 v[160:163], v[44:47], v[104:107], v[160:163]
v_mfma_f32_16x16x32_bf16 v[180:183], v[44:47], v[108:111], v[180:183]
s_waitcnt vmcnt(18) lgkmcnt(0)
v_mfma_f32_16x16x32_bf16 v[144:147], v[8:11], v[112:115], v[144:147]
ds_read_b64_tr_b16 v[28:29], v129 offset:2560
ds_read_b64_tr_b16 v[30:31], v129 offset:8960
v_mfma_f32_16x16x32_bf16 v[164:167], v[8:11], v[116:119], v[164:167]
ds_read_b64_tr_b16 v[32:33], v129 offset:2568
ds_read_b64_tr_b16 v[34:35], v129 offset:8968
v_mfma_f32_16x16x32_bf16 v[148:151], v[12:15], v[112:115], v[148:151]
ds_read_b64_tr_b16 v[36:37], v129 offset:2576
ds_read_b64_tr_b16 v[38:39], v129 offset:8976
v_mfma_f32_16x16x32_bf16 v[168:171], v[12:15], v[116:119], v[168:171]
ds_read_b64_tr_b16 v[40:41], v129 offset:2584
ds_read_b64_tr_b16 v[42:43], v129 offset:8984
v_mfma_f32_16x16x32_bf16 v[152:155], v[16:19], v[112:115], v[152:155]
ds_read_b64_tr_b16 v[44:45], v129 offset:2592
ds_read_b64_tr_b16 v[46:47], v129 offset:8992
v_mfma_f32_16x16x32_bf16 v[172:175], v[16:19], v[116:119], v[172:175]
v_mfma_f32_16x16x32_bf16 v[156:159], v[20:23], v[112:115], v[156:159]
v_mfma_f32_16x16x32_bf16 v[176:179], v[20:23], v[116:119], v[176:179]
buffer_load_dwordx4 v[232:235], v135, s[16:19], s87 offen offset:1024 sc1
buffer_load_dwordx4 v[236:239], v244, s[16:19], s87 offen offset:1024 sc1
v_mfma_f32_16x16x32_bf16 v[160:163], v[24:27], v[112:115], v[160:163]
v_mfma_f32_16x16x32_bf16 v[180:183], v[24:27], v[116:119], v[180:183]
s_waitcnt vmcnt(16) lgkmcnt(0)
v_mfma_f32_16x16x32_bf16 v[144:147], v[28:31], v[120:123], v[144:147]
ds_read_b64_tr_b16 v[8:9], v1 offset:0
ds_read_b64_tr_b16 v[10:11], v1 offset:1280
v_mfma_f32_16x16x32_bf16 v[164:167], v[28:31], v[124:127], v[164:167]
ds_read_b64_tr_b16 v[12:13], v1 offset:8
ds_read_b64_tr_b16 v[14:15], v1 offset:1288
v_mfma_f32_16x16x32_bf16 v[148:151], v[32:35], v[120:123], v[148:151]
ds_read_b64_tr_b16 v[16:17], v1 offset:16
ds_read_b64_tr_b16 v[18:19], v1 offset:1296
v_mfma_f32_16x16x32_bf16 v[168:171], v[32:35], v[124:127], v[168:171]
ds_read_b64_tr_b16 v[20:21], v1 offset:24
ds_read_b64_tr_b16 v[22:23], v1 offset:1304
v_mfma_f32_16x16x32_bf16 v[152:155], v[36:39], v[120:123], v[152:155]
ds_read_b64_tr_b16 v[24:25], v1 offset:32
ds_read_b64_tr_b16 v[26:27], v1 offset:1312
v_mfma_f32_16x16x32_bf16 v[172:175], v[36:39], v[124:127], v[172:175]
v_mfma_f32_16x16x32_bf16 v[156:159], v[40:43], v[120:123], v[156:159]
v_mfma_f32_16x16x32_bf16 v[176:179], v[40:43], v[124:127], v[176:179]
buffer_load_dwordx4 v[48:51], v135, s[16:19], s87 offen offset:2048 sc1
buffer_load_dwordx4 v[52:55], v244, s[16:19], s87 offen offset:2048 sc1
v_mfma_f32_16x16x32_bf16 v[160:163], v[44:47], v[120:123], v[160:163]
v_mfma_f32_16x16x32_bf16 v[180:183], v[44:47], v[124:127], v[180:183]
s_waitcnt vmcnt(16) lgkmcnt(0)
v_add_u32 v128, s97, v247
v_add_u32 v129, s97, v248
v_mfma_f32_16x16x32_bf16 v[144:147], v[8:11], v[184:187], v[144:147]
ds_read_b64_tr_b16 v[28:29], v1 offset:6400
ds_read_b64_tr_b16 v[30:31], v1 offset:7680
v_mfma_f32_16x16x32_bf16 v[164:167], v[8:11], v[188:191], v[164:167]
ds_read_b64_tr_b16 v[32:33], v1 offset:6408
ds_read_b64_tr_b16 v[34:35], v1 offset:7688
v_mfma_f32_16x16x32_bf16 v[148:151], v[12:15], v[184:187], v[148:151]
ds_read_b64_tr_b16 v[36:37], v1 offset:6416
ds_read_b64_tr_b16 v[38:39], v1 offset:7696
v_mfma_f32_16x16x32_bf16 v[168:171], v[12:15], v[188:191], v[168:171]
ds_read_b64_tr_b16 v[40:41], v1 offset:6424
ds_read_b64_tr_b16 v[42:43], v1 offset:7704
v_mfma_f32_16x16x32_bf16 v[152:155], v[16:19], v[184:187], v[152:155]
ds_read_b64_tr_b16 v[44:45], v1 offset:6432
ds_read_b64_tr_b16 v[46:47], v1 offset:7712
v_mfma_f32_16x16x32_bf16 v[172:175], v[16:19], v[188:191], v[172:175]
v_mfma_f32_16x16x32_bf16 v[156:159], v[20:23], v[184:187], v[156:159]
v_mfma_f32_16x16x32_bf16 v[176:179], v[20:23], v[188:191], v[176:179]
buffer_load_dwordx4 v[56:59], v135, s[16:19], s87 offen offset:3072 sc1
buffer_load_dwordx4 v[60:63], v244, s[16:19], s87 offen offset:3072 sc1
v_mfma_f32_16x16x32_bf16 v[160:163], v[24:27], v[184:187], v[160:163]
v_mfma_f32_16x16x32_bf16 v[180:183], v[24:27], v[188:191], v[180:183]
s_waitcnt vmcnt(16) lgkmcnt(0)
v_mfma_f32_16x16x32_bf16 v[144:147], v[28:31], v[192:195], v[144:147]
ds_read_b64_tr_b16 v[8:9], v1 offset:12800
ds_read_b64_tr_b16 v[10:11], v1 offset:14080
v_mfma_f32_16x16x32_bf16 v[164:167], v[28:31], v[196:199], v[164:167]
ds_read_b64_tr_b16 v[12:13], v1 offset:12808
ds_read_b64_tr_b16 v[14:15], v1 offset:14088
v_mfma_f32_16x16x32_bf16 v[148:151], v[32:35], v[192:195], v[148:151]
ds_read_b64_tr_b16 v[16:17], v1 offset:12816
ds_read_b64_tr_b16 v[18:19], v1 offset:14096
v_mfma_f32_16x16x32_bf16 v[168:171], v[32:35], v[196:199], v[168:171]
ds_read_b64_tr_b16 v[20:21], v1 offset:12824
ds_read_b64_tr_b16 v[22:23], v1 offset:14104
v_mfma_f32_16x16x32_bf16 v[152:155], v[36:39], v[192:195], v[152:155]
ds_read_b64_tr_b16 v[24:25], v1 offset:12832
ds_read_b64_tr_b16 v[26:27], v1 offset:14112
v_mfma_f32_16x16x32_bf16 v[172:175], v[36:39], v[196:199], v[172:175]
v_mfma_f32_16x16x32_bf16 v[156:159], v[40:43], v[192:195], v[156:159]
v_mfma_f32_16x16x32_bf16 v[176:179], v[40:43], v[196:199], v[176:179]
buffer_load_dwordx2 v[64:65], v245, s[16:19], s87 offen offset:0 sc1
buffer_load_dwordx2 v[66:67], v245, s[16:19], s87 offen offset:256 sc1
buffer_load_dwordx2 v[68:69], v246, s[16:19], s87 offen offset:0 sc1
buffer_load_dwordx2 v[70:71], v246, s[16:19], s87 offen offset:256 sc1
v_mfma_f32_16x16x32_bf16 v[160:163], v[44:47], v[192:195], v[160:163]
v_mfma_f32_16x16x32_bf16 v[180:183], v[44:47], v[196:199], v[180:183]
s_waitcnt vmcnt(18) lgkmcnt(0)
v_mfma_f32_16x16x32_bf16 v[144:147], v[8:11], v[200:203], v[144:147]
ds_read_b64_tr_b16 v[28:29], v1 offset:19200
ds_read_b64_tr_b16 v[30:31], v1 offset:20480
v_mfma_f32_16x16x32_bf16 v[164:167], v[8:11], v[204:207], v[164:167]
ds_read_b64_tr_b16 v[32:33], v1 offset:19208
ds_read_b64_tr_b16 v[34:35], v1 offset:20488
v_mfma_f32_16x16x32_bf16 v[148:151], v[12:15], v[200:203], v[148:151]
ds_read_b64_tr_b16 v[36:37], v1 offset:19216
ds_read_b64_tr_b16 v[38:39], v1 offset:20496
v_mfma_f32_16x16x32_bf16 v[168:171], v[12:15], v[204:207], v[168:171]
ds_read_b64_tr_b16 v[40:41], v1 offset:19224
ds_read_b64_tr_b16 v[42:43], v1 offset:20504
v_mfma_f32_16x16x32_bf16 v[152:155], v[16:19], v[200:203], v[152:155]
ds_read_b64_tr_b16 v[44:45], v1 offset:19232
ds_read_b64_tr_b16 v[46:47], v1 offset:20512
v_mfma_f32_16x16x32_bf16 v[172:175], v[16:19], v[204:207], v[172:175]
v_mfma_f32_16x16x32_bf16 v[156:159], v[20:23], v[200:203], v[156:159]
v_mfma_f32_16x16x32_bf16 v[176:179], v[20:23], v[204:207], v[176:179]
v_mfma_f32_16x16x32_bf16 v[160:163], v[24:27], v[200:203], v[160:163]
v_mfma_f32_16x16x32_bf16 v[180:183], v[24:27], v[204:207], v[180:183]
s_waitcnt vmcnt(16) lgkmcnt(0)
v_mfma_f32_16x16x32_bf16 v[144:147], v[28:31], v[208:211], v[144:147]
ds_read_b64_tr_b16 v[8:9], v2 offset:2560
ds_read_b64_tr_b16 v[10:11], v2 offset:8960
v_mfma_f32_16x16x32_bf16 v[164:167], v[28:31], v[212:215], v[164:167]
ds_read_b64_tr_b16 v[12:13], v2 offset:2568
ds_read_b64_tr_b16 v[14:15], v2 offset:8968
v_mfma_f32_16x16x32_bf16 v[148:151], v[32:35], v[208:211], v[148:151]
ds_read_b64_tr_b16 v[16:17], v2 offset:2576
ds_read_b64_tr_b16 v[18:19], v2 offset:8976
v_mfma_f32_16x16x32_bf16 v[168:171], v[32:35], v[212:215], v[168:171]
ds_read_b64_tr_b16 v[20:21], v2 offset:2584
ds_read_b64_tr_b16 v[22:23], v2 offset:8984
v_mfma_f32_16x16x32_bf16 v[152:155], v[36:39], v[208:211], v[152:155]
ds_read_b64_tr_b16 v[24:25], v2 offset:2592
ds_read_b64_tr_b16 v[26:27], v2 offset:8992
v_mfma_f32_16x16x32_bf16 v[172:175], v[36:39], v[212:215], v[172:175]
v_mfma_f32_16x16x32_bf16 v[156:159], v[40:43], v[208:211], v[156:159]
v_mfma_f32_16x16x32_bf16 v[176:179], v[40:43], v[212:215], v[176:179]
v_mfma_f32_16x16x32_bf16 v[160:163], v[44:47], v[208:211], v[160:163]
v_mfma_f32_16x16x32_bf16 v[180:183], v[44:47], v[212:215], v[180:183]
s_waitcnt vmcnt(12) lgkmcnt(0)
v_mfma_f32_16x16x32_bf16 v[144:147], v[8:11], v[216:219], v[144:147]
ds_read_b64_tr_b16 v[28:29], v128 offset:0
ds_read_b64_tr_b16 v[30:31], v128 offset:1280
v_mfma_f32_16x16x32_bf16 v[164:167], v[8:11], v[220:223], v[164:167]
ds_read_b64_tr_b16 v[32:33], v128 offset:8
ds_read_b64_tr_b16 v[34:35], v128 offset:1288
v_mfma_f32_16x16x32_bf16 v[148:151], v[12:15], v[216:219], v[148:151]
ds_read_b64_tr_b16 v[36:37], v128 offset:16
ds_read_b64_tr_b16 v[38:39], v128 offset:1296
v_mfma_f32_16x16x32_bf16 v[168:171], v[12:15], v[220:223], v[168:171]
ds_read_b64_tr_b16 v[40:41], v128 offset:24
ds_read_b64_tr_b16 v[42:43], v128 offset:1304
v_mfma_f32_16x16x32_bf16 v[152:155], v[16:19], v[216:219], v[152:155]
ds_read_b64_tr_b16 v[44:45], v128 offset:32
ds_read_b64_tr_b16 v[46:47], v128 offset:1312
v_mfma_f32_16x16x32_bf16 v[172:175], v[16:19], v[220:223], v[172:175]
v_mfma_f32_16x16x32_bf16 v[156:159], v[20:23], v[216:219], v[156:159]
v_mfma_f32_16x16x32_bf16 v[176:179], v[20:23], v[220:223], v[176:179]
v_mfma_f32_16x16x32_bf16 v[160:163], v[24:27], v[216:219], v[160:163]
v_mfma_f32_16x16x32_bf16 v[180:183], v[24:27], v[220:223], v[180:183]
s_waitcnt vmcnt(10) lgkmcnt(0)
v_mfma_f32_16x16x32_bf16 v[144:147], v[28:31], v[224:227], v[144:147]
ds_read_b64_tr_b16 v[8:9], v128 offset:6400
ds_read_b64_tr_b16 v[10:11], v128 offset:7680
v_mfma_f32_16x16x32_bf16 v[164:167], v[28:31], v[228:231], v[164:167]
ds_read_b64_tr_b16 v[12:13], v128 offset:6408
ds_read_b64_tr_b16 v[14:15], v128 offset:7688
v_mfma_f32_16x16x32_bf16 v[148:151], v[32:35], v[224:227], v[148:151]
ds_read_b64_tr_b16 v[16:17], v128 offset:6416
ds_read_b64_tr_b16 v[18:19], v128 offset:7696
v_mfma_f32_16x16x32_bf16 v[168:171], v[32:35], v[228:231], v[168:171]
ds_read_b64_tr_b16 v[20:21], v128 offset:6424
ds_read_b64_tr_b16 v[22:23], v128 offset:7704
v_mfma_f32_16x16x32_bf16 v[152:155], v[36:39], v[224:227], v[152:155]
ds_read_b64_tr_b16 v[24:25], v128 offset:6432
ds_read_b64_tr_b16 v[26:27], v128 offset:7712
v_mfma_f32_16x16x32_bf16 v[172:175], v[36:39], v[228:231], v[172:175]
v_mfma_f32_16x16x32_bf16 v[156:159], v[40:43], v[224:227], v[156:159]
v_mfma_f32_16x16x32_bf16 v[176:179], v[40:43], v[228:231], v[176:179]
v_mfma_f32_16x16x32_bf16 v[160:163], v[44:47], v[224:227], v[160:163]
v_mfma_f32_16x16x32_bf16 v[180:183], v[44:47], v[228:231], v[180:183]
s_waitcnt vmcnt(8) lgkmcnt(0)
v_mfma_f32_16x16x32_bf16 v[144:147], v[8:11], v[232:235], v[144:147]
ds_read_b64_tr_b16 v[28:29], v128 offset:12800
ds_read_b64_tr_b16 v[30:31], v128 offset:14080
v_mfma_f32_16x16x32_bf16 v[164:167], v[8:11], v[236:239], v[164:167]
ds_read_b64_tr_b16 v[32:33], v128 offset:12808
ds_read_b64_tr_b16 v[34:35], v128 offset:14088
v_mfma_f32_16x16x32_bf16 v[148:151], v[12:15], v[232:235], v[148:151]
ds_read_b64_tr_b16 v[36:37], v128 offset:12816
ds_read_b64_tr_b16 v[38:39], v128 offset:14096
v_mfma_f32_16x16x32_bf16 v[168:171], v[12:15], v[236:239], v[168:171]
ds_read_b64_tr_b16 v[40:41], v128 offset:12824
ds_read_b64_tr_b16 v[42:43], v128 offset:14104
v_mfma_f32_16x16x32_bf16 v[152:155], v[16:19], v[232:235], v[152:155]
ds_read_b64_tr_b16 v[44:45], v128 offset:12832
ds_read_b64_tr_b16 v[46:47], v128 offset:14112
v_mfma_f32_16x16x32_bf16 v[172:175], v[16:19], v[236:239], v[172:175]
v_mfma_f32_16x16x32_bf16 v[156:159], v[20:23], v[232:235], v[156:159]
v_mfma_f32_16x16x32_bf16 v[176:179], v[20:23], v[236:239], v[176:179]
v_mfma_f32_16x16x32_bf16 v[160:163], v[24:27], v[232:235], v[160:163]
v_mfma_f32_16x16x32_bf16 v[180:183], v[24:27], v[236:239], v[180:183]
s_waitcnt vmcnt(6) lgkmcnt(0)
v_mfma_f32_16x16x32_bf16 v[144:147], v[28:31], v[48:51], v[144:147]
ds_read_b64_tr_b16 v[8:9], v128 offset:19200
ds_read_b64_tr_b16 v[10:11], v128 offset:20480
v_mfma_f32_16x16x32_bf16 v[164:167], v[28:31], v[52:55], v[164:167]
ds_read_b64_tr_b16 v[12:13], v128 offset:19208
ds_read_b64_tr_b16 v[14:15], v128 offset:20488
v_mfma_f32_16x16x32_bf16 v[148:151], v[32:35], v[48:51], v[148:151]
ds_read_b64_tr_b16 v[16:17], v128 offset:19216
ds_read_b64_tr_b16 v[18:19], v128 offset:20496
v_mfma_f32_16x16x32_bf16 v[168:171], v[32:35], v[52:55], v[168:171]
ds_read_b64_tr_b16 v[20:21], v128 offset:19224
ds_read_b64_tr_b16 v[22:23], v128 offset:20504
v_mfma_f32_16x16x32_bf16 v[152:155], v[36:39], v[48:51], v[152:155]
ds_read_b64_tr_b16 v[24:25], v128 offset:19232
ds_read_b64_tr_b16 v[26:27], v128 offset:20512
v_mfma_f32_16x16x32_bf16 v[172:175], v[36:39], v[52:55], v[172:175]
v_mfma_f32_16x16x32_bf16 v[156:159], v[40:43], v[48:51], v[156:159]
v_mfma_f32_16x16x32_bf16 v[176:179], v[40:43], v[52:55], v[176:179]
v_mfma_f32_16x16x32_bf16 v[160:163], v[44:47], v[48:51], v[160:163]
v_mfma_f32_16x16x32_bf16 v[180:183], v[44:47], v[52:55], v[180:183]
s_waitcnt vmcnt(4) lgkmcnt(0)
v_mfma_f32_16x16x32_bf16 v[144:147], v[8:11], v[56:59], v[144:147]
ds_read_b64_tr_b16 v[28:29], v129 offset:2560
ds_read_b64_tr_b16 v[30:31], v129 offset:8960
v_mfma_f32_16x16x32_bf16 v[164:167], v[8:11], v[60:63], v[164:167]
ds_read_b64_tr_b16 v[32:33], v129 offset:2568
ds_read_b64_tr_b16 v[34:35], v129 offset:8968
v_mfma_f32_16x16x32_bf16 v[148:151], v[12:15], v[56:59], v[148:151]
ds_read_b64_tr_b16 v[36:37], v129 offset:2576
ds_read_b64_tr_b16 v[38:39], v129 offset:8976
v_mfma_f32_16x16x32_bf16 v[168:171], v[12:15], v[60:63], v[168:171]
ds_read_b64_tr_b16 v[40:41], v129 offset:2584
ds_read_b64_tr_b16 v[42:43], v129 offset:8984
v_mfma_f32_16x16x32_bf16 v[152:155], v[16:19], v[56:59], v[152:155]
ds_read_b64_tr_b16 v[44:45], v129 offset:2592
ds_read_b64_tr_b16 v[46:47], v129 offset:8992
v_mfma_f32_16x16x32_bf16 v[172:175], v[16:19], v[60:63], v[172:175]
v_mfma_f32_16x16x32_bf16 v[156:159], v[20:23], v[56:59], v[156:159]
v_mfma_f32_16x16x32_bf16 v[176:179], v[20:23], v[60:63], v[176:179]
v_mfma_f32_16x16x32_bf16 v[160:163], v[24:27], v[56:59], v[160:163]
v_mfma_f32_16x16x32_bf16 v[180:183], v[24:27], v[60:63], v[180:183]
s_waitcnt vmcnt(0) lgkmcnt(0)
v_mfma_f32_16x16x32_bf16 v[144:147], v[28:31], v[64:67], v[144:147]
v_mfma_f32_16x16x32_bf16 v[164:167], v[28:31], v[68:71], v[164:167]
v_mfma_f32_16x16x32_bf16 v[148:151], v[32:35], v[64:67], v[148:151]
v_mfma_f32_16x16x32_bf16 v[168:171], v[32:35], v[68:71], v[168:171]
v_mfma_f32_16x16x32_bf16 v[152:155], v[36:39], v[64:67], v[152:155]
v_mfma_f32_16x16x32_bf16 v[172:175], v[36:39], v[68:71], v[172:175]
v_mfma_f32_16x16x32_bf16 v[156:159], v[40:43], v[64:67], v[156:159]
v_mfma_f32_16x16x32_bf16 v[176:179], v[40:43], v[68:71], v[176:179]
v_mfma_f32_16x16x32_bf16 v[160:163], v[44:47], v[64:67], v[160:163]
v_mfma_f32_16x16x32_bf16 v[180:183], v[44:47], v[68:71], v[180:183]
v_cvt_pk_bf16_f32 v144, v144, v145
v_cvt_pk_bf16_f32 v145, v146, v147
ds_write_b64 v249, v[144:145] offset:0
v_cvt_pk_bf16_f32 v148, v148, v149
v_cvt_pk_bf16_f32 v149, v150, v151
ds_write_b64 v249, v[148:149] offset:8
v_cvt_pk_bf16_f32 v152, v152, v153
v_cvt_pk_bf16_f32 v153, v154, v155
ds_write_b64 v249, v[152:153] offset:16
v_cvt_pk_bf16_f32 v156, v156, v157
v_cvt_pk_bf16_f32 v157, v158, v159
ds_write_b64 v249, v[156:157] offset:24
v_cvt_pk_bf16_f32 v160, v160, v161
v_cvt_pk_bf16_f32 v161, v162, v163
ds_write_b64 v249, v[160:161] offset:32
v_cvt_pk_bf16_f32 v164, v164, v165
v_cvt_pk_bf16_f32 v165, v166, v167
ds_write_b64 v249, v[164:165] offset:2560
v_cvt_pk_bf16_f32 v168, v168, v169
v_cvt_pk_bf16_f32 v169, v170, v171
ds_write_b64 v249, v[168:169] offset:2568
v_cvt_pk_bf16_f32 v172, v172, v173
v_cvt_pk_bf16_f32 v173, v174, v175
ds_write_b64 v249, v[172:173] offset:2576
v_cvt_pk_bf16_f32 v176, v176, v177
v_cvt_pk_bf16_f32 v177, v178, v179
ds_write_b64 v249, v[176:177] offset:2584
v_cvt_pk_bf16_f32 v180, v180, v181
v_cvt_pk_bf16_f32 v181, v182, v183
ds_write_b64 v249, v[180:181] offset:2592
s_waitcnt lgkmcnt(0)
ds_read_b128 v[48:51], v250 offset:0
ds_read_b128 v[52:55], v250 offset:1024
ds_read_b128 v[56:59], v250 offset:2048
ds_read_b128 v[60:63], v250 offset:3072
ds_read_b128 v[64:67], v250 offset:4096
s_waitcnt lgkmcnt(4)
buffer_store_dwordx4 v[48:51], v251, s[80:83], s90 offen nt
s_waitcnt lgkmcnt(3)
buffer_store_dwordx4 v[52:55], v252, s[80:83], s90 offen nt
s_waitcnt lgkmcnt(2)
buffer_store_dwordx4 v[56:59], v253, s[80:83], s90 offen nt
s_waitcnt lgkmcnt(1)
buffer_store_dwordx4 v[60:63], v254, s[80:83], s90 offen nt
s_waitcnt lgkmcnt(0)
buffer_store_dwordx4 v[64:67], v255, s[80:83], s90 offen nt
attn_fin:
attn_end:
s_endpgm
attn_young:
v_subrev_u32 v4, 4096, v4
s_sub_u32 s21, s21, 4096
s_mov_b32 s36, 34
s_waitcnt vmcnt(0)
s_barrier
buffer_load_dwordx4 v[36:39], v135, s[16:19], s12 offen sc1
buffer_load_dwordx4 v[8:11], v135, s[16:19], s13 offen sc1
buffer_load_dwordx4 v[16:19], v135, s[16:19], s13 offen offset:1280 sc1
s_mov_b64 exec, s[24:25]
buffer_load_dwordx2 v[34:35], v136, s[16:19], s12 offen offset:1024 sc1
buffer_load_dwordx2 v[12:13], v136, s[16:19], s13 offen offset:1024 sc1
buffer_load_dwordx2 v[14:15], v136, s[16:19], s13 offen offset:2304 sc1
s_mov_b64 exec, -1
attn_dma:
s_mov_b32 m0, s21
s_add_u32 s21, s21, 4096
buffer_load_dwordx4 v4, s[16:19], s20 offen sc1 lds
s_add_u32 s20, s20, 4096
s_sub_u32 s36, s36, 1
s_cmp_lg_u32 s36, 0
s_cbranch_scc1 attn_dma
s_waitcnt vmcnt(34)
s_setprio 1
s_branch attn_maxbody
attn_event:
s_mov_b32 s34, 8
s_setprio 0
s_cmp_ge_u32 s11, 4
s_cbranch_scc1 attn_ev2
s_barrier
s_lshl2_add_u32 s36, s7, s11
s_mul_i32 s36, s36, 6400
v_lshlrev_b32 v142, 3, v135
buffer_load_dword v143, v142, s[76:79], s36 offen
s_branch attn_loop
attn_ev2:
buffer_load_dwordx4 v[144:147], v251, s[76:79], s88 offen
buffer_load_dwordx4 v[148:151], v252, s[76:79], s88 offen
buffer_load_dwordx4 v[152:155], v253, s[76:79], s88 offen
buffer_load_dwordx4 v[156:159], v254, s[76:79], s88 offen
buffer_load_dwordx4 v[160:163], v255, s[76:79], s88 offen
s_add_u32 s88, s88, 163840
buffer_load_dwordx4 v[164:167], v251, s[76:79], s88 offen
buffer_load_dwordx4 v[168:171], v252, s[76:79], s88 offen
buffer_load_dwordx4 v[172:175], v253, s[76:79], s88 offen
buffer_load_dwordx4 v[176:179], v254, s[76:79], s88 offen
buffer_load_dwordx4 v[180:183], v255, s[76:79], s88 offen
s_add_u32 s88, s88, 163840
buffer_load_dwordx4 v[184:187], v251, s[76:79], s88 offen
buffer_load_dwordx4 v[188:191], v252, s[76:79], s88 offen
buffer_load_dwordx4 v[192:195], v253, s[76:79], s88 offen
buffer_load_dwordx4 v[196:199], v254, s[76:79], s88 offen
buffer_load_dwordx4 v[200:203], v255, s[76:79], s88 offen
s_add_u32 s88, s88, 163840
buffer_load_dwordx4 v[204:207], v251, s[76:79], s88 offen
buffer_load_dwordx4 v[208:211], v252, s[76:79], s88 offen
buffer_load_dwordx4 v[212:215], v253, s[76:79], s88 offen
buffer_load_dwordx4 v[216:219], v254, s[76:79], s88 offen
buffer_load_dwordx4 v[220:223], v255, s[76:79], s88 offen
s_add_u32 s88, s88, 163840
buffer_load_dwordx4 v[224:227], v251, s[76:79], s88 offen
buffer_load_dwordx4 v[228:231], v252, s[76:79], s88 offen
buffer_load_dwordx4 v[232:235], v253, s[76:79], s88 offen
buffer_load_dwordx4 v[236:239], v254, s[76:79], s88 offen
buffer_load_dwordx4 v[240:243], v255, s[76:79], s88 offen
s_branch attn_loop
attn_restart:
s_mov_b32 s33, 64
v_mov_b64 v[56:57], 0
v_mov_b64 v[58:59], 0
v_mov_b64 v[60:61], 0
v_mov_b32 v1, v135
v_mov_b64 v[2:3], v[136:137]
v_mov_b32 v128, 0xff800000
v_mov_b32 v129, 0xff800000
v_mfma_f32_32x32x16_bf16 v[96:111], v[56:59], v[56:59], 0
v_mfma_f32_32x32x16_bf16 v[112:127], v[56:59], v[56:59], 0
s_mov_b64 exec, s[26:27]
v_mov_b32 v12, 0
v_mov_b32 v13, 0
v_mov_b32 v14, 0
v_mov_b32 v15, 0
s_mov_b64 exec, -1
s_mov_b32 s35, 63
v_add_u32 v4, 161280, v1
v_add_u32 v5, 161280, v2
attn_maxloop:
ds_read_b128 v[36:39], v4
s_mov_b64 exec, s[24:25]
ds_read_b64 v[34:35], v5 offset:1024
s_mov_b64 exec, -1
v_subrev_u32 v4, 2560, v4
v_subrev_u32 v5, 2560, v5
s_waitcnt lgkmcnt(0)
attn_last:
s_branch attn_maxbody
.section .rodata,"a"
.p2align 6
.amdhsa_kernel concat_heads__mha_block__grouped_kv_mqa__prompt_kernel
  .amdhsa_next_free_vgpr 256
  .amdhsa_next_free_sgpr 102
  .amdhsa_accum_offset 256
  .amdhsa_group_segment_fixed_size 0
  .amdhsa_kernarg_size 88
  .amdhsa_user_sgpr_count 2
  .amdhsa_user_sgpr_kernarg_segment_ptr 1
  .amdhsa_system_sgpr_workgroup_id_x 1
.end_amdhsa_kernel
```
